```python
import torch

def _softmax(x, axis=-1):
    return torch.softmax(x, dim=axis)
def _gelu(x):
    return torch.nn.functional.gelu(x, approximate="tanh")
def _silu(x):
    return torch.nn.functional.silu(x)
def _sigmoid(x):
    return torch.sigmoid(x)
def _layernorm(x, axis=-1, eps=1e-5):
    m = x.mean(dim=axis, keepdim=True)
    v = x.var(dim=axis, keepdim=True, unbiased=False)
    return (x - m) / torch.sqrt(v + eps)
def _scatter_add(tgt, idx, src, axis=0):
    return tgt.clone().index_add_(axis, idx, src)
def _segment_sum(src, seg, n):
    out = torch.zeros((n,) + src.shape[1:], dtype=src.dtype)
    return out.index_add_(0, seg, src)
def _pad(x, pw):
    flat = tuple(v for pair in reversed(pw) for v in pair)
    return torch.nn.functional.pad(x, flat)

kernel_name = 'standalone__glu_gated_swiglu__prompt'

def setup_inputs():

    _w = (lambda a: (lambda t: t.to(torch.bfloat16) if t.is_floating_point() else t)(torch.as_tensor(a)))
    B, S, D, F = 1, 2048, 1024, 3584
    return {
        "x": _w((lambda *s: torch.randn(*s, dtype=torch.bfloat16) * 0.05)(B, S, D)),
        "w1": _w((lambda *s: torch.randn(*s, dtype=torch.bfloat16) * 0.05)(D, F) * (2.0 / D) ** 0.5),
        "w3": _w((lambda *s: torch.randn(*s, dtype=torch.bfloat16) * 0.05)(D, F) * (2.0 / D) ** 0.5),
        "w2": _w((lambda *s: torch.randn(*s, dtype=torch.bfloat16) * 0.05)(F, D) * (2.0 / F) ** 0.5),
    }

def reference(x, w1, w3, w2):
    gate = torch.einsum("bsd,df->bsf", x, w1)
    up = torch.einsum("bsd,df->bsf", x, w3)
    h = _silu(gate) * up
    out = torch.einsum("bsf,fd->bsd", h, w2)
    return out
```

```asm
; @launch grid=(256,1,1) block=(256,1,1) lds=163840
.amdgcn_target "amdgcn-amd-amdhsa--gfx950"
.text
.globl standalone__glu_gated_swiglu__prompt_kernel
.p2align 8
.type standalone__glu_gated_swiglu__prompt_kernel,@function
standalone__glu_gated_swiglu__prompt_kernel:
    s_cmp_ge_u32 s2, 256
    s_cbranch_scc1 k_done
    s_load_dwordx8 s[4:11], s[0:1], 0
    s_load_dwordx2 s[12:13], s[0:1], 48
    s_load_dwordx4 s[84:87], s[0:1], 32
    v_lshrrev_b32 v16, 6, v0
    v_and_b32 v15, 63, v0
    v_readfirstlane_b32 s32, v16
    s_and_b32 s43, s2, 7
    s_lshr_b32 s3, s2, 3
    s_and_b32 s33, s43, 1
    s_lshl_b32 s33, s33, 2
    s_and_b32 s34, s3, 3
    s_add_u32 s33, s33, s34
    s_lshr_b32 s34, s43, 1
    s_lshl_b32 s34, s34, 3
    s_lshr_b32 s48, s3, 2
    s_add_u32 s34, s34, s48
    v_lshrrev_b32 v16, 3, v15
    v_and_b32 v17, 7, v15
    v_lshrrev_b32 v18, 4, v15
    v_xor_b32 v19, v17, v18
    v_lshlrev_b32 v19, 4, v19
    v_lshl_add_u32 v1, v16, 11, v19
    v_xor_b32 v19, 64, v19
    v_lshl_add_u32 v2, v16, 11, v19
    v_add_u32 v2, 15360, v2
    v_add_u32 v3, 30720, v1
    v_add_u32 v4, 30720, v2
    v_bfe_u32 v18, v0, 6, 1
    v_lshlrev_b32 v18, 3, v18
    v_sub_u32 v18, v15, v18
    v_and_b32 v18, 63, v18
    v_mul_u32_u24 v16, 37, v18
    v_lshrrev_b32 v16, 9, v16
    v_mul_u32_u24 v17, 14, v16
    v_sub_u32 v17, v18, v17
    s_and_b32 s49, s34, 2
    s_lshl_b32 s49, s49, 1
    v_add_u32 v5, s49, v17
    v_subrev_u32 v19, 12, v5
    v_min_u32 v5, v5, v19
    v_cmp_gt_u32 vcc, 12, v17
    v_cndmask_b32 v17, v17, v5, vcc
    s_and_b32 s49, s34, 1
    s_lshl_b32 s49, s49, 1
    v_add_u32 v17, s49, v17
    v_subrev_u32 v19, 14, v17
    v_min_u32 v17, v17, v19
    v_mul_u32_u24 v16, 7168, v16
    v_cmp_gt_u32 vcc, 56, v18
    v_lshl_add_u32 v5, v17, 4, v16
    v_mov_b32 v19, 0x40000000
    v_cndmask_b32 v5, v19, v5, vcc
    v_add_u32 v6, 27648, v5
    s_lshl_b32 s35, s33, 19
    s_lshl_b32 s48, s32, 17
    s_add_u32 s35, s35, s48
    v_add_u32 v24, 0x10000, v1
    v_add_u32 v25, 0x10000, v2
    v_add_u32 v26, 0x10000, v3
    v_add_u32 v27, 0x10000, v4
    s_mul_i32 s37, s32, 57344
    s_mul_i32 s48, s34, 224
    s_add_u32 s37, s37, s48
    s_and_b32 s48, s3, 3
    s_lshr_b32 s49, s3, 2
    s_add_u32 s48, s48, s49
    s_and_b32 s48, s48, 3
    s_mov_b32 s60, 1699164688
    s_mov_b32 s61, 3989809547
    s_cmp_eq_u32 s48, 1
    s_cselect_b32 s60, 1703092289, s60
    s_cselect_b32 s61, 4275808711, s61
    s_cmp_eq_u32 s48, 2
    s_cselect_b32 s60, 1766003970, s60
    s_cselect_b32 s61, 4274761095, s61
    s_cmp_eq_u32 s48, 3
    s_cselect_b32 s60, 2772590851, s60
    s_cselect_b32 s61, 4257999239, s61
    s_lshl_b32 s38, s32, 13
    s_add_u32 s38, s38, 65536
    s_lshl_b32 s39, s32, 12
    s_waitcnt lgkmcnt(0)
    s_mov_b32 s16, s4
    s_and_b32 s17, s5, 0xffff
    s_mov_b32 s18, 4194304
    s_mov_b32 s19, 0x00020000
    s_mov_b32 s20, s6
    s_and_b32 s21, s7, 0xffff
    s_mov_b32 s22, 7340032
    s_mov_b32 s23, 0x00020000
    s_mov_b32 s24, s8
    s_and_b32 s25, s9, 0xffff
    s_mov_b32 s26, 7340032
    s_mov_b32 s27, 0x00020000
    s_bfe_u32 s80, s60, 262144
    s_lshl_b32 s80, s80, 7
    s_add_u32 s80, s80, s35
    s_add_u32 m0, s38, 0
    s_nop 0
    buffer_load_dwordx4 v1, s[16:19], s80 offen offset:0 lds
    buffer_load_dwordx4 v2, s[16:19], s80 offen offset:1024 lds
    buffer_load_dwordx4 v3, s[16:19], s80 offen offset:2048 lds
    buffer_load_dwordx4 v4, s[16:19], s80 offen offset:3072 lds
    s_bfe_u32 s81, s60, 262144
    s_mul_i32 s81, s81, 458752
    s_add_u32 s81, s81, s37
    s_add_u32 m0, s39, 0
    s_nop 0
    buffer_load_dwordx4 v5, s[20:23], s81 offen offset:0 lds
    buffer_load_dwordx4 v6, s[20:23], s81 offen offset:1024 lds
    s_add_u32 m0, s39, 2048
    s_nop 0
    buffer_load_dwordx4 v5, s[24:27], s81 offen offset:0 lds
    buffer_load_dwordx4 v6, s[24:27], s81 offen offset:1024 lds
    s_add_u32 m0, s38, 4096
    s_nop 0
    buffer_load_dwordx4 v24, s[16:19], s80 offen offset:0 lds
    buffer_load_dwordx4 v25, s[16:19], s80 offen offset:1024 lds
    buffer_load_dwordx4 v26, s[16:19], s80 offen offset:2048 lds
    buffer_load_dwordx4 v27, s[16:19], s80 offen offset:3072 lds
    s_add_u32 s81, s81, 229376
    s_add_u32 m0, s39, 16384
    s_nop 0
    buffer_load_dwordx4 v5, s[20:23], s81 offen offset:0 lds
    buffer_load_dwordx4 v6, s[20:23], s81 offen offset:1024 lds
    s_add_u32 m0, s39, 18432
    s_nop 0
    buffer_load_dwordx4 v5, s[24:27], s81 offen offset:0 lds
    buffer_load_dwordx4 v6, s[24:27], s81 offen offset:1024 lds
    s_mov_b32 s28, s12
    s_and_b32 s29, s13, 0xffff
    s_mov_b32 s30, 67108864
    s_mov_b32 s31, 0x00020000
    s_mov_b32 s52, s10
    s_and_b32 s53, s11, 0xffff
    s_mov_b32 s54, 7340032
    s_mov_b32 s55, 0x00020000
    s_mov_b32 s88, s86
    s_and_b32 s89, s87, 0xffff
    s_mov_b32 s90, 256
    s_mov_b32 s91, 0x00020000
    s_getpc_b64 s[86:87]
k_pc:
    s_sub_u32 s86, s86, k_pc-standalone__glu_gated_swiglu__prompt_kernel
    s_subb_u32 s87, s87, 0
    s_lshl_b32 s43, s3, 2
    s_add_u32 s43, s43, s32
    s_and_b32 s43, s43, 63
    s_lshl_b32 s43, s43, 10
    v_and_b32 v23, 7, v15
    v_lshlrev_b32 v23, 7, v23
    v_add_u32 v23, s43, v23
    v_min_u32 v23, k_done-standalone__glu_gated_swiglu__prompt_kernel, v23
    s_bfe_u32 s101, s2, 65538
    s_xor_b32 s101, s101, 1
    s_and_b32 s14, s2, 3
    s_lshl_b32 s14, s14, 2
    s_and_b32 s48, s3, 3
    s_add_u32 s14, s14, s48
    s_lshr_b32 s15, s3, 2
    s_lshl_b32 s43, s33, 2
    s_add_u32 s43, s43, s32
    s_lshl_b32 s43, s43, 8
    s_lshr_b32 s82, s34, 4
    s_lshl_b32 s82, s82, 7
    s_add_u32 s43, s43, s82
    s_and_b32 s82, s34, 15
    s_lshl_b32 s82, s82, 2
    s_add_u32 s82, s82, s43
    s_add_u32 s82, s82, 51380224
    s_lshl_b32 s43, s2, 2
    s_add_u32 s43, s43, s32
    s_lshl_b32 s97, s43, 13
    s_add_u32 s97, s97, 33554432
    s_xor_b32 s98, s97, 131072
    s_add_u32 s99, s97, 4096
    s_add_u32 s100, s98, 4096
    v_mov_b32 v31, 0
    s_mov_b64 exec, 1
    buffer_store_dword v31, v31, s[28:31], s82 offen sc1
    s_mov_b64 exec, -1
    s_lshl_b32 s83, s14, 1
    s_lshr_b32 s43, s32, 1
    s_add_u32 s83, s83, s43
    s_lshl_b32 s83, s83, 1
    s_add_u32 s83, s83, s101
    s_lshl_b32 s83, s83, 7
    s_add_u32 s83, s83, 51380224
    s_and_b32 s50, s3, 3
    s_add_u32 s42, s50, s15
    s_add_u32 s50, s50, s42
    s_add_u32 s48, s50, 0
    s_bfe_u32 s49, s48, 131073
    s_mul_i32 s49, s49, 7
    s_and_b32 s48, s48, 1
    s_mul_i32 s48, s48, 6
    s_add_u32 s48, s48, s49
    s_lshl_b32 s4, s48, 17
    s_add_u32 s48, s50, 1
    s_bfe_u32 s49, s48, 131073
    s_mul_i32 s49, s49, 7
    s_and_b32 s48, s48, 1
    s_mul_i32 s48, s48, 6
    s_add_u32 s48, s48, s49
    s_lshl_b32 s5, s48, 17
    s_add_u32 s48, s50, 2
    s_bfe_u32 s49, s48, 131073
    s_mul_i32 s49, s49, 7
    s_and_b32 s48, s48, 1
    s_mul_i32 s48, s48, 6
    s_add_u32 s48, s48, s49
    s_lshl_b32 s6, s48, 17
    s_add_u32 s48, s50, 3
    s_bfe_u32 s49, s48, 131073
    s_mul_i32 s49, s49, 7
    s_and_b32 s48, s48, 1
    s_mul_i32 s48, s48, 6
    s_add_u32 s48, s48, s49
    s_lshl_b32 s7, s48, 17
    s_add_u32 s48, s50, 4
    s_bfe_u32 s49, s48, 131073
    s_mul_i32 s49, s49, 7
    s_and_b32 s48, s48, 1
    s_mul_i32 s48, s48, 6
    s_add_u32 s48, s48, s49
    s_lshl_b32 s8, s48, 17
    s_add_u32 s48, s50, 5
    s_bfe_u32 s49, s48, 131073
    s_mul_i32 s49, s49, 7
    s_and_b32 s48, s48, 1
    s_mul_i32 s48, s48, 6
    s_add_u32 s48, s48, s49
    s_lshl_b32 s9, s48, 17
    s_add_u32 s48, s50, 6
    s_bfe_u32 s49, s48, 131073
    s_mul_i32 s49, s49, 7
    s_and_b32 s48, s48, 1
    s_mul_i32 s48, s48, 6
    s_add_u32 s48, s48, s49
    s_lshl_b32 s10, s48, 17
    s_add_u32 s48, s50, 7
    s_bfe_u32 s49, s48, 131073
    s_mul_i32 s49, s49, 7
    s_and_b32 s48, s48, 1
    s_mul_i32 s48, s48, 6
    s_add_u32 s48, s48, s49
    s_lshl_b32 s11, s48, 17
    s_bitcmp1_b32 s50, 0
    s_mov_b32 s62, 262144
    s_cselect_b32 s59, 4294705152, s62
    s_sub_u32 s62, 0, s59
    s_lshl_b32 s63, s32, 11
    v_lshrrev_b32 v16, 3, v15
    v_and_b32 v17, 7, v15
    v_lshrrev_b32 v18, 4, v15
    v_lshlrev_b32 v18, 1, v18
    v_xor_b32 v17, v17, v18
    v_lshlrev_b32 v17, 4, v17
    v_and_b32 v18, 4, v16
    v_add_u32 v16, v16, v18
    v_lshl_add_u32 v16, v16, 11, v17
    s_lshr_b32 s48, s32, 1
    s_lshl_b32 s48, s48, 16
    s_and_b32 s43, s32, 1
    s_lshl_b32 s43, s43, 13
    s_add_u32 s48, s48, s43
    s_lshl_b32 s43, s15, 8
    s_add_u32 s48, s48, s43
    s_mul_i32 s43, s101, 3670144
    s_add_u32 s48, s48, s43
    v_add_u32 v12, s48, v16
    v_add_u32 v13, 31744, v12
    v_xor_b32 v14, 128, v12
    v_xor_b32 v0, 128, v13
    v_and_b32 v16, 15, v15
    v_lshrrev_b32 v17, 4, v15
    v_bfe_u32 v18, v15, 1, 3
    v_xor_b32 v18, v18, v17
    v_lshlrev_b32 v18, 4, v18
    v_lshl_add_u32 v18, v16, 7, v18
    v_add_u32 v7, s38, v18
    v_xor_b32 v9, 64, v7
    v_add_u32 v8, 0x10000, v7
    v_add_u32 v10, 0x10000, v9
    v_lshlrev_b32 v11, 12, v17
    v_bfe_u32 v18, v15, 4, 1
    v_lshl_add_u32 v11, v18, 7, v11
    v_bfe_u32 v18, v15, 2, 2
    v_mul_u32_u24 v18, 224, v18
    v_add_u32 v11, v11, v18
    v_and_b32 v18, 3, v15
    v_lshl_add_u32 v11, v18, 3, v11
    v_cmp_gt_u32 vcc, 56, v15
    v_lshlrev_b32 v28, 7, v15
    v_mov_b32 v19, 0x40000000
    v_cndmask_b32 v28, v19, v28, vcc
    s_and_b32 s58, s2, 63
    s_lshr_b32 s43, s2, 7
    s_lshl_b32 s43, s43, 6
    s_add_u32 s58, s58, s43
    s_lshl_b32 s58, s58, 2
    s_add_u32 s58, s58, s32
    s_mul_i32 s58, s58, 14336
    v_lshlrev_b32 v30, 2, v15
    v_mov_b32 v20, 1
    s_and_b32 s36, s2, 63
    s_lshl_b32 s36, s36, 2
    s_bfe_u32 s56, s2, 196611
    s_add_u32 s43, s34, 1
    s_and_b32 s43, s43, 2
    s_lshl4_add_u32 s56, s43, s56
    s_mov_b32 s44, 0xbfb8aa3b
    s_mov_b32 s45, 0xbfb8aa3b
    s_mov_b32 s46, 1.0
    s_mov_b32 s47, 1.0
    s_bfe_u32 s80, s60, 262148
    s_lshl_b32 s80, s80, 7
    s_add_u32 s80, s80, s35
    s_add_u32 m0, s38, 32768
    s_nop 0
    buffer_load_dwordx4 v1, s[16:19], s80 offen offset:0 lds
    buffer_load_dwordx4 v2, s[16:19], s80 offen offset:1024 lds
    buffer_load_dwordx4 v3, s[16:19], s80 offen offset:2048 lds
    buffer_load_dwordx4 v4, s[16:19], s80 offen offset:3072 lds
    s_bfe_u32 s81, s60, 262148
    s_mul_i32 s81, s81, 458752
    s_add_u32 s81, s81, s37
    s_add_u32 m0, s39, 32768
    s_nop 0
    buffer_load_dwordx4 v5, s[20:23], s81 offen offset:0 lds
    buffer_load_dwordx4 v6, s[20:23], s81 offen offset:1024 lds
    s_add_u32 m0, s39, 34816
    s_nop 0
    buffer_load_dwordx4 v5, s[24:27], s81 offen offset:0 lds
    buffer_load_dwordx4 v6, s[24:27], s81 offen offset:1024 lds
    s_waitcnt vmcnt(13)
    s_barrier
    ds_read_b128 a[0:3], v7 offset:0
    ds_read_b128 a[4:7], v7 offset:2048
    ds_read_b128 a[8:11], v7 offset:4096
    ds_read_b128 a[12:15], v7 offset:6144
    ds_read_b64_tr_b16 a[16:17], v11 offset:0
    ds_read_b64_tr_b16 a[18:19], v11 offset:1024
    ds_read_b64_tr_b16 a[20:21], v11 offset:2048
    ds_read_b64_tr_b16 a[22:23], v11 offset:3072
    ds_read_b64_tr_b16 a[24:25], v11 offset:32
    ds_read_b64_tr_b16 a[26:27], v11 offset:1056
    ds_read_b64_tr_b16 a[28:29], v11 offset:2080
    ds_read_b64_tr_b16 a[30:31], v11 offset:3104
    ds_read_b64_tr_b16 a[32:33], v11 offset:64
    ds_read_b64_tr_b16 a[34:35], v11 offset:1088
    ds_read_b64_tr_b16 a[36:37], v11 offset:2112
    ds_read_b64_tr_b16 a[38:39], v11 offset:3136
    ds_read_b64_tr_b16 a[40:41], v11 offset:96
    ds_read_b64_tr_b16 a[42:43], v11 offset:1120
    ds_read_b64_tr_b16 a[44:45], v11 offset:2144
    ds_read_b64_tr_b16 a[46:47], v11 offset:3168
    ds_read_b64_tr_b16 a[48:49], v11 offset:128
    ds_read_b64_tr_b16 a[50:51], v11 offset:1152
    ds_read_b64_tr_b16 a[52:53], v11 offset:2176
    ds_read_b64_tr_b16 a[54:55], v11 offset:3200
    ds_read_b64_tr_b16 a[56:57], v11 offset:160
    ds_read_b64_tr_b16 a[58:59], v11 offset:1184
    ds_read_b64_tr_b16 a[60:61], v11 offset:2208
    ds_read_b64_tr_b16 a[62:63], v11 offset:3232
    ds_read_b64_tr_b16 a[64:65], v11 offset:192
    ds_read_b64_tr_b16 a[66:67], v11 offset:1216
    ds_read_b64_tr_b16 a[68:69], v11 offset:2240
    ds_read_b64_tr_b16 a[70:71], v11 offset:3264
.p2align 3
    s_waitcnt vmcnt(9) lgkmcnt(0)
    s_barrier
    v_mfma_f32_16x16x32_bf16 v[32:35], a[16:19], a[0:3], 0
    ds_read_b128 a[72:75], v9 offset:0
    s_add_u32 m0, s38, 36864
    v_mfma_f32_16x16x32_bf16 v[36:39], a[16:19], a[4:7], 0
    ds_read_b128 a[76:79], v9 offset:2048
    v_mfma_f32_16x16x32_bf16 v[40:43], a[16:19], a[8:11], 0
    ds_read_b128 a[80:83], v9 offset:4096
    v_mfma_f32_16x16x32_bf16 v[44:47], a[16:19], a[12:15], 0
    buffer_load_dwordx4 v24, s[16:19], s80 offen offset:0 lds
    v_mfma_f32_16x16x32_bf16 v[60:63], a[20:23], a[12:15], 0
    ds_read_b128 a[84:87], v9 offset:6144
    v_mfma_f32_16x16x32_bf16 v[56:59], a[20:23], a[8:11], 0
    ds_read_b64_tr_b16 a[88:89], v11 offset:16384
    v_mfma_f32_16x16x32_bf16 v[52:55], a[20:23], a[4:7], 0
    buffer_load_dwordx4 v25, s[16:19], s80 offen offset:1024 lds
    v_mfma_f32_16x16x32_bf16 v[48:51], a[20:23], a[0:3], 0
    ds_read_b64_tr_b16 a[90:91], v11 offset:17408
    v_mfma_f32_16x16x32_bf16 v[64:67], a[24:27], a[0:3], 0
    ds_read_b64_tr_b16 a[92:93], v11 offset:18432
    v_mfma_f32_16x16x32_bf16 v[68:71], a[24:27], a[4:7], 0
    ds_read_b64_tr_b16 a[94:95], v11 offset:19456
    v_mfma_f32_16x16x32_bf16 v[72:75], a[24:27], a[8:11], 0
    buffer_load_dwordx4 v26, s[16:19], s80 offen offset:2048 lds
    v_mfma_f32_16x16x32_bf16 v[76:79], a[24:27], a[12:15], 0
    ds_read_b64_tr_b16 a[96:97], v11 offset:16416
    v_mfma_f32_16x16x32_bf16 v[92:95], a[28:31], a[12:15], 0
    ds_read_b64_tr_b16 a[98:99], v11 offset:17440
    v_mfma_f32_16x16x32_bf16 v[88:91], a[28:31], a[8:11], 0
    buffer_load_dwordx4 v27, s[16:19], s80 offen offset:3072 lds
    v_mfma_f32_16x16x32_bf16 v[84:87], a[28:31], a[4:7], 0
    ds_read_b64_tr_b16 a[100:101], v11 offset:18464
    v_mfma_f32_16x16x32_bf16 v[80:83], a[28:31], a[0:3], 0
    ds_read_b64_tr_b16 a[102:103], v11 offset:19488
    v_mfma_f32_16x16x32_bf16 v[96:99], a[32:35], a[0:3], 0
    s_add_u32 s81, s81, 229376
    v_mfma_f32_16x16x32_bf16 v[100:103], a[32:35], a[4:7], 0
    ds_read_b64_tr_b16 a[104:105], v11 offset:16448
    v_mfma_f32_16x16x32_bf16 v[104:107], a[32:35], a[8:11], 0
    ds_read_b64_tr_b16 a[106:107], v11 offset:17472
    v_mfma_f32_16x16x32_bf16 v[108:111], a[32:35], a[12:15], 0
    ds_read_b64_tr_b16 a[108:109], v11 offset:18496
    v_mfma_f32_16x16x32_bf16 v[124:127], a[36:39], a[12:15], 0
    s_add_u32 m0, s39, 49152
    v_mfma_f32_16x16x32_bf16 v[120:123], a[36:39], a[8:11], 0
    ds_read_b64_tr_b16 a[110:111], v11 offset:19520
    v_mfma_f32_16x16x32_bf16 v[116:119], a[36:39], a[4:7], 0
    ds_read_b64_tr_b16 a[112:113], v11 offset:16480
    v_mfma_f32_16x16x32_bf16 v[112:115], a[36:39], a[0:3], 0
    buffer_load_dwordx4 v5, s[20:23], s81 offen offset:0 lds
    v_mfma_f32_16x16x32_bf16 v[128:131], a[40:43], a[0:3], 0
    ds_read_b64_tr_b16 a[114:115], v11 offset:17504
    v_mfma_f32_16x16x32_bf16 v[132:135], a[40:43], a[4:7], 0
    ds_read_b64_tr_b16 a[116:117], v11 offset:18528
    v_mfma_f32_16x16x32_bf16 v[136:139], a[40:43], a[8:11], 0
    ds_read_b64_tr_b16 a[118:119], v11 offset:19552
    v_mfma_f32_16x16x32_bf16 v[140:143], a[40:43], a[12:15], 0
    buffer_load_dwordx4 v6, s[20:23], s81 offen offset:1024 lds
    v_mfma_f32_16x16x32_bf16 v[156:159], a[44:47], a[12:15], 0
    ds_read_b64_tr_b16 a[120:121], v11 offset:16512
    v_mfma_f32_16x16x32_bf16 v[152:155], a[44:47], a[8:11], 0
    ds_read_b64_tr_b16 a[122:123], v11 offset:17536
    v_mfma_f32_16x16x32_bf16 v[148:151], a[44:47], a[4:7], 0
    s_add_u32 m0, s39, 51200
    v_mfma_f32_16x16x32_bf16 v[144:147], a[44:47], a[0:3], 0
    ds_read_b64_tr_b16 a[124:125], v11 offset:18560
    v_mfma_f32_16x16x32_bf16 v[160:163], a[48:51], a[0:3], 0
    ds_read_b64_tr_b16 a[126:127], v11 offset:19584
    v_mfma_f32_16x16x32_bf16 v[164:167], a[48:51], a[4:7], 0
    buffer_load_dwordx4 v5, s[24:27], s81 offen offset:0 lds
    v_mfma_f32_16x16x32_bf16 v[168:171], a[48:51], a[8:11], 0
    ds_read_b64_tr_b16 a[128:129], v11 offset:16544
    v_mfma_f32_16x16x32_bf16 v[172:175], a[48:51], a[12:15], 0
    ds_read_b64_tr_b16 a[130:131], v11 offset:17568
    v_mfma_f32_16x16x32_bf16 v[188:191], a[52:55], a[12:15], 0
    ds_read_b64_tr_b16 a[132:133], v11 offset:18592
    v_mfma_f32_16x16x32_bf16 v[184:187], a[52:55], a[8:11], 0
    buffer_load_dwordx4 v6, s[24:27], s81 offen offset:1024 lds
    v_mfma_f32_16x16x32_bf16 v[180:183], a[52:55], a[4:7], 0
    ds_read_b64_tr_b16 a[134:135], v11 offset:19616
    v_mfma_f32_16x16x32_bf16 v[176:179], a[52:55], a[0:3], 0
    ds_read_b64_tr_b16 a[136:137], v11 offset:16576
    v_mfma_f32_16x16x32_bf16 v[192:195], a[56:59], a[0:3], 0
    s_bfe_u32 s80, s60, 262152
    v_mfma_f32_16x16x32_bf16 v[196:199], a[56:59], a[4:7], 0
    ds_read_b64_tr_b16 a[138:139], v11 offset:17600
    v_mfma_f32_16x16x32_bf16 v[200:203], a[56:59], a[8:11], 0
    ds_read_b64_tr_b16 a[140:141], v11 offset:18624
    v_mfma_f32_16x16x32_bf16 v[204:207], a[56:59], a[12:15], 0
    s_lshl_b32 s80, s80, 7
    v_mfma_f32_16x16x32_bf16 v[220:223], a[60:63], a[12:15], 0
    ds_read_b64_tr_b16 a[142:143], v11 offset:19648
    v_mfma_f32_16x16x32_bf16 v[216:219], a[60:63], a[8:11], 0
    s_add_u32 s80, s80, s35
    v_mfma_f32_16x16x32_bf16 v[212:215], a[60:63], a[4:7], 0
    s_add_u32 m0, s38, 65536
    v_mfma_f32_16x16x32_bf16 v[208:211], a[60:63], a[0:3], 0
    buffer_load_dwordx4 v1, s[16:19], s80 offen offset:0 lds
    v_mfma_f32_16x16x32_bf16 v[224:227], a[64:67], a[0:3], 0
    buffer_load_dwordx4 v2, s[16:19], s80 offen offset:1024 lds
    v_mfma_f32_16x16x32_bf16 v[228:231], a[64:67], a[4:7], 0
    buffer_load_dwordx4 v3, s[16:19], s80 offen offset:2048 lds
    v_mfma_f32_16x16x32_bf16 v[232:235], a[64:67], a[8:11], 0
    buffer_load_dwordx4 v4, s[16:19], s80 offen offset:3072 lds
    v_mfma_f32_16x16x32_bf16 v[236:239], a[64:67], a[12:15], 0
    v_mfma_f32_16x16x32_bf16 v[252:255], a[68:71], a[12:15], 0
    v_mfma_f32_16x16x32_bf16 v[248:251], a[68:71], a[8:11], 0
    v_mfma_f32_16x16x32_bf16 v[244:247], a[68:71], a[4:7], 0
    v_mfma_f32_16x16x32_bf16 v[240:243], a[68:71], a[0:3], 0
    s_waitcnt vmcnt(8) lgkmcnt(0)
    s_barrier
    v_mfma_f32_16x16x32_bf16 v[32:35], a[88:91], a[72:75], v[32:35]
    ds_read_b128 a[0:3], v7 offset:32768
    s_bfe_u32 s81, s60, 262152
    v_mfma_f32_16x16x32_bf16 v[36:39], a[88:91], a[76:79], v[36:39]
    ds_read_b128 a[4:7], v7 offset:34816
    v_mfma_f32_16x16x32_bf16 v[40:43], a[88:91], a[80:83], v[40:43]
    ds_read_b128 a[8:11], v7 offset:36864
    v_mfma_f32_16x16x32_bf16 v[44:47], a[88:91], a[84:87], v[44:47]
    s_mul_i32 s81, s81, 458752
    v_mfma_f32_16x16x32_bf16 v[60:63], a[92:95], a[84:87], v[60:63]
    ds_read_b128 a[12:15], v7 offset:38912
    v_mfma_f32_16x16x32_bf16 v[56:59], a[92:95], a[80:83], v[56:59]
    ds_read_b64_tr_b16 a[16:17], v11 offset:32768
    v_mfma_f32_16x16x32_bf16 v[52:55], a[92:95], a[76:79], v[52:55]
    s_add_u32 s81, s81, s37
    v_mfma_f32_16x16x32_bf16 v[48:51], a[92:95], a[72:75], v[48:51]
    ds_read_b64_tr_b16 a[18:19], v11 offset:33792
    v_mfma_f32_16x16x32_bf16 v[64:67], a[96:99], a[72:75], v[64:67]
    ds_read_b64_tr_b16 a[20:21], v11 offset:34816
    v_mfma_f32_16x16x32_bf16 v[68:71], a[96:99], a[76:79], v[68:71]
    ds_read_b64_tr_b16 a[22:23], v11 offset:35840
    v_mfma_f32_16x16x32_bf16 v[72:75], a[96:99], a[80:83], v[72:75]
    s_add_u32 m0, s39, 0
    v_mfma_f32_16x16x32_bf16 v[76:79], a[96:99], a[84:87], v[76:79]
    ds_read_b64_tr_b16 a[24:25], v11 offset:32800
    v_mfma_f32_16x16x32_bf16 v[92:95], a[100:103], a[84:87], v[92:95]
    ds_read_b64_tr_b16 a[26:27], v11 offset:33824
    v_mfma_f32_16x16x32_bf16 v[88:91], a[100:103], a[80:83], v[88:91]
    buffer_load_dwordx4 v5, s[20:23], s81 offen offset:0 lds
    v_mfma_f32_16x16x32_bf16 v[84:87], a[100:103], a[76:79], v[84:87]
    ds_read_b64_tr_b16 a[28:29], v11 offset:34848
    v_mfma_f32_16x16x32_bf16 v[80:83], a[100:103], a[72:75], v[80:83]
    ds_read_b64_tr_b16 a[30:31], v11 offset:35872
    v_mfma_f32_16x16x32_bf16 v[96:99], a[104:107], a[72:75], v[96:99]
    buffer_load_dwordx4 v6, s[20:23], s81 offen offset:1024 lds
    v_mfma_f32_16x16x32_bf16 v[100:103], a[104:107], a[76:79], v[100:103]
    ds_read_b64_tr_b16 a[32:33], v11 offset:32832
    v_mfma_f32_16x16x32_bf16 v[104:107], a[104:107], a[80:83], v[104:107]
    ds_read_b64_tr_b16 a[34:35], v11 offset:33856
    v_mfma_f32_16x16x32_bf16 v[108:111], a[104:107], a[84:87], v[108:111]
    ds_read_b64_tr_b16 a[36:37], v11 offset:34880
    v_mfma_f32_16x16x32_bf16 v[124:127], a[108:111], a[84:87], v[124:127]
    s_add_u32 m0, s39, 2048
    v_mfma_f32_16x16x32_bf16 v[120:123], a[108:111], a[80:83], v[120:123]
    ds_read_b64_tr_b16 a[38:39], v11 offset:35904
    v_mfma_f32_16x16x32_bf16 v[116:119], a[108:111], a[76:79], v[116:119]
    ds_read_b64_tr_b16 a[40:41], v11 offset:32864
    v_mfma_f32_16x16x32_bf16 v[112:115], a[108:111], a[72:75], v[112:115]
    buffer_load_dwordx4 v5, s[24:27], s81 offen offset:0 lds
    v_mfma_f32_16x16x32_bf16 v[128:131], a[112:115], a[72:75], v[128:131]
    ds_read_b64_tr_b16 a[42:43], v11 offset:33888
    v_mfma_f32_16x16x32_bf16 v[132:135], a[112:115], a[76:79], v[132:135]
    ds_read_b64_tr_b16 a[44:45], v11 offset:34912
    v_mfma_f32_16x16x32_bf16 v[136:139], a[112:115], a[80:83], v[136:139]
    ds_read_b64_tr_b16 a[46:47], v11 offset:35936
    v_mfma_f32_16x16x32_bf16 v[140:143], a[112:115], a[84:87], v[140:143]
    buffer_load_dwordx4 v6, s[24:27], s81 offen offset:1024 lds
    v_mfma_f32_16x16x32_bf16 v[156:159], a[116:119], a[84:87], v[156:159]
    ds_read_b64_tr_b16 a[48:49], v11 offset:32896
    v_mfma_f32_16x16x32_bf16 v[152:155], a[116:119], a[80:83], v[152:155]
    ds_read_b64_tr_b16 a[50:51], v11 offset:33920
    v_mfma_f32_16x16x32_bf16 v[148:151], a[116:119], a[76:79], v[148:151]
    s_add_u32 m0, s38, 69632
    v_mfma_f32_16x16x32_bf16 v[144:147], a[116:119], a[72:75], v[144:147]
    ds_read_b64_tr_b16 a[52:53], v11 offset:34944
    v_mfma_f32_16x16x32_bf16 v[160:163], a[120:123], a[72:75], v[160:163]
    ds_read_b64_tr_b16 a[54:55], v11 offset:35968
    v_mfma_f32_16x16x32_bf16 v[164:167], a[120:123], a[76:79], v[164:167]
    buffer_load_dwordx4 v24, s[16:19], s80 offen offset:0 lds
    v_mfma_f32_16x16x32_bf16 v[168:171], a[120:123], a[80:83], v[168:171]
    ds_read_b64_tr_b16 a[56:57], v11 offset:32928
    v_mfma_f32_16x16x32_bf16 v[172:175], a[120:123], a[84:87], v[172:175]
    ds_read_b64_tr_b16 a[58:59], v11 offset:33952
    v_mfma_f32_16x16x32_bf16 v[188:191], a[124:127], a[84:87], v[188:191]
    ds_read_b64_tr_b16 a[60:61], v11 offset:34976
    v_mfma_f32_16x16x32_bf16 v[184:187], a[124:127], a[80:83], v[184:187]
    buffer_load_dwordx4 v25, s[16:19], s80 offen offset:1024 lds
    v_mfma_f32_16x16x32_bf16 v[180:183], a[124:127], a[76:79], v[180:183]
    ds_read_b64_tr_b16 a[62:63], v11 offset:36000
    v_mfma_f32_16x16x32_bf16 v[176:179], a[124:127], a[72:75], v[176:179]
    ds_read_b64_tr_b16 a[64:65], v11 offset:32960
    v_mfma_f32_16x16x32_bf16 v[192:195], a[128:131], a[72:75], v[192:195]
    buffer_load_dwordx4 v26, s[16:19], s80 offen offset:2048 lds
    v_mfma_f32_16x16x32_bf16 v[196:199], a[128:131], a[76:79], v[196:199]
    ds_read_b64_tr_b16 a[66:67], v11 offset:33984
    v_mfma_f32_16x16x32_bf16 v[200:203], a[128:131], a[80:83], v[200:203]
    ds_read_b64_tr_b16 a[68:69], v11 offset:35008
    v_mfma_f32_16x16x32_bf16 v[204:207], a[128:131], a[84:87], v[204:207]
    buffer_load_dwordx4 v27, s[16:19], s80 offen offset:3072 lds
    v_mfma_f32_16x16x32_bf16 v[220:223], a[132:135], a[84:87], v[220:223]
    ds_read_b64_tr_b16 a[70:71], v11 offset:36032
    s_add_u32 s81, s81, 229376
    v_mfma_f32_16x16x32_bf16 v[216:219], a[132:135], a[80:83], v[216:219]
    s_add_u32 m0, s39, 16384
    v_mfma_f32_16x16x32_bf16 v[212:215], a[132:135], a[76:79], v[212:215]
    buffer_load_dwordx4 v5, s[20:23], s81 offen offset:0 lds
    v_mfma_f32_16x16x32_bf16 v[208:211], a[132:135], a[72:75], v[208:211]
    buffer_load_dwordx4 v6, s[20:23], s81 offen offset:1024 lds
    v_mfma_f32_16x16x32_bf16 v[224:227], a[136:139], a[72:75], v[224:227]
    s_add_u32 m0, s39, 18432
    v_mfma_f32_16x16x32_bf16 v[228:231], a[136:139], a[76:79], v[228:231]
    buffer_load_dwordx4 v5, s[24:27], s81 offen offset:0 lds
    v_mfma_f32_16x16x32_bf16 v[232:235], a[136:139], a[80:83], v[232:235]
    buffer_load_dwordx4 v6, s[24:27], s81 offen offset:1024 lds
    v_mfma_f32_16x16x32_bf16 v[236:239], a[136:139], a[84:87], v[236:239]
    v_mfma_f32_16x16x32_bf16 v[252:255], a[140:143], a[84:87], v[252:255]
    v_mfma_f32_16x16x32_bf16 v[248:251], a[140:143], a[80:83], v[248:251]
    v_mfma_f32_16x16x32_bf16 v[244:247], a[140:143], a[76:79], v[244:247]
    v_mfma_f32_16x16x32_bf16 v[240:243], a[140:143], a[72:75], v[240:243]
    s_waitcnt vmcnt(16) lgkmcnt(0)
    s_barrier
    v_mfma_f32_16x16x32_bf16 v[32:35], a[16:19], a[0:3], v[32:35]
    ds_read_b128 a[72:75], v9 offset:32768
    s_bfe_u32 s80, s60, 262156
    v_mfma_f32_16x16x32_bf16 v[36:39], a[16:19], a[4:7], v[36:39]
    ds_read_b128 a[76:79], v9 offset:34816
    v_mfma_f32_16x16x32_bf16 v[40:43], a[16:19], a[8:11], v[40:43]
    ds_read_b128 a[80:83], v9 offset:36864
    v_mfma_f32_16x16x32_bf16 v[44:47], a[16:19], a[12:15], v[44:47]
    s_lshl_b32 s80, s80, 7
    v_mfma_f32_16x16x32_bf16 v[60:63], a[20:23], a[12:15], v[60:63]
    ds_read_b128 a[84:87], v9 offset:38912
    v_mfma_f32_16x16x32_bf16 v[56:59], a[20:23], a[8:11], v[56:59]
    ds_read_b64_tr_b16 a[88:89], v11 offset:49152
    v_mfma_f32_16x16x32_bf16 v[52:55], a[20:23], a[4:7], v[52:55]
    s_add_u32 s80, s80, s35
    v_mfma_f32_16x16x32_bf16 v[48:51], a[20:23], a[0:3], v[48:51]
    ds_read_b64_tr_b16 a[90:91], v11 offset:50176
    v_mfma_f32_16x16x32_bf16 v[64:67], a[24:27], a[0:3], v[64:67]
    ds_read_b64_tr_b16 a[92:93], v11 offset:51200
    v_mfma_f32_16x16x32_bf16 v[68:71], a[24:27], a[4:7], v[68:71]
    ds_read_b64_tr_b16 a[94:95], v11 offset:52224
    v_mfma_f32_16x16x32_bf16 v[72:75], a[24:27], a[8:11], v[72:75]
    s_add_u32 m0, s38, 0
    v_mfma_f32_16x16x32_bf16 v[76:79], a[24:27], a[12:15], v[76:79]
    ds_read_b64_tr_b16 a[96:97], v11 offset:49184
    v_mfma_f32_16x16x32_bf16 v[92:95], a[28:31], a[12:15], v[92:95]
    ds_read_b64_tr_b16 a[98:99], v11 offset:50208
    v_mfma_f32_16x16x32_bf16 v[88:91], a[28:31], a[8:11], v[88:91]
    buffer_load_dwordx4 v1, s[16:19], s80 offen offset:0 lds
    v_mfma_f32_16x16x32_bf16 v[84:87], a[28:31], a[4:7], v[84:87]
    ds_read_b64_tr_b16 a[100:101], v11 offset:51232
    v_mfma_f32_16x16x32_bf16 v[80:83], a[28:31], a[0:3], v[80:83]
    ds_read_b64_tr_b16 a[102:103], v11 offset:52256
    v_mfma_f32_16x16x32_bf16 v[96:99], a[32:35], a[0:3], v[96:99]
    buffer_load_dwordx4 v2, s[16:19], s80 offen offset:1024 lds
    v_mfma_f32_16x16x32_bf16 v[100:103], a[32:35], a[4:7], v[100:103]
    ds_read_b64_tr_b16 a[104:105], v11 offset:49216
    v_mfma_f32_16x16x32_bf16 v[104:107], a[32:35], a[8:11], v[104:107]
    ds_read_b64_tr_b16 a[106:107], v11 offset:50240
    v_mfma_f32_16x16x32_bf16 v[108:111], a[32:35], a[12:15], v[108:111]
    ds_read_b64_tr_b16 a[108:109], v11 offset:51264
    v_mfma_f32_16x16x32_bf16 v[124:127], a[36:39], a[12:15], v[124:127]
    buffer_load_dwordx4 v3, s[16:19], s80 offen offset:2048 lds
    v_mfma_f32_16x16x32_bf16 v[120:123], a[36:39], a[8:11], v[120:123]
    ds_read_b64_tr_b16 a[110:111], v11 offset:52288
    buffer_load_dwordx4 v4, s[16:19], s80 offen offset:3072 lds
    v_mfma_f32_16x16x32_bf16 v[116:119], a[36:39], a[4:7], v[116:119]
    ds_read_b64_tr_b16 a[112:113], v11 offset:49248
    v_mfma_f32_16x16x32_bf16 v[112:115], a[36:39], a[0:3], v[112:115]
    s_bfe_u32 s81, s60, 262156
    v_mfma_f32_16x16x32_bf16 v[128:131], a[40:43], a[0:3], v[128:131]
    ds_read_b64_tr_b16 a[114:115], v11 offset:50272
    v_mfma_f32_16x16x32_bf16 v[132:135], a[40:43], a[4:7], v[132:135]
    ds_read_b64_tr_b16 a[116:117], v11 offset:51296
    v_mfma_f32_16x16x32_bf16 v[136:139], a[40:43], a[8:11], v[136:139]
    ds_read_b64_tr_b16 a[118:119], v11 offset:52320
    v_mfma_f32_16x16x32_bf16 v[140:143], a[40:43], a[12:15], v[140:143]
    s_mul_i32 s81, s81, 458752
    v_mfma_f32_16x16x32_bf16 v[156:159], a[44:47], a[12:15], v[156:159]
    ds_read_b64_tr_b16 a[120:121], v11 offset:49280
    v_mfma_f32_16x16x32_bf16 v[152:155], a[44:47], a[8:11], v[152:155]
    ds_read_b64_tr_b16 a[122:123], v11 offset:50304
    v_mfma_f32_16x16x32_bf16 v[148:151], a[44:47], a[4:7], v[148:151]
    s_add_u32 s81, s81, s37
    v_mfma_f32_16x16x32_bf16 v[144:147], a[44:47], a[0:3], v[144:147]
    ds_read_b64_tr_b16 a[124:125], v11 offset:51328
    v_mfma_f32_16x16x32_bf16 v[160:163], a[48:51], a[0:3], v[160:163]
    ds_read_b64_tr_b16 a[126:127], v11 offset:52352
    v_mfma_f32_16x16x32_bf16 v[164:167], a[48:51], a[4:7], v[164:167]
    s_add_u32 m0, s39, 32768
    v_mfma_f32_16x16x32_bf16 v[168:171], a[48:51], a[8:11], v[168:171]
    ds_read_b64_tr_b16 a[128:129], v11 offset:49312
    v_mfma_f32_16x16x32_bf16 v[172:175], a[48:51], a[12:15], v[172:175]
    ds_read_b64_tr_b16 a[130:131], v11 offset:50336
    v_mfma_f32_16x16x32_bf16 v[188:191], a[52:55], a[12:15], v[188:191]
    ds_read_b64_tr_b16 a[132:133], v11 offset:51360
    v_mfma_f32_16x16x32_bf16 v[184:187], a[52:55], a[8:11], v[184:187]
    buffer_load_dwordx4 v5, s[20:23], s81 offen offset:0 lds
    v_mfma_f32_16x16x32_bf16 v[180:183], a[52:55], a[4:7], v[180:183]
    ds_read_b64_tr_b16 a[134:135], v11 offset:52384
    v_mfma_f32_16x16x32_bf16 v[176:179], a[52:55], a[0:3], v[176:179]
    ds_read_b64_tr_b16 a[136:137], v11 offset:49344
    v_mfma_f32_16x16x32_bf16 v[192:195], a[56:59], a[0:3], v[192:195]
    buffer_load_dwordx4 v6, s[20:23], s81 offen offset:1024 lds
    v_mfma_f32_16x16x32_bf16 v[196:199], a[56:59], a[4:7], v[196:199]
    ds_read_b64_tr_b16 a[138:139], v11 offset:50368
    v_mfma_f32_16x16x32_bf16 v[200:203], a[56:59], a[8:11], v[200:203]
    ds_read_b64_tr_b16 a[140:141], v11 offset:51392
    v_mfma_f32_16x16x32_bf16 v[204:207], a[56:59], a[12:15], v[204:207]
    s_add_u32 m0, s39, 34816
    v_mfma_f32_16x16x32_bf16 v[220:223], a[60:63], a[12:15], v[220:223]
    ds_read_b64_tr_b16 a[142:143], v11 offset:52416
    buffer_load_dwordx4 v5, s[24:27], s81 offen offset:0 lds
    v_mfma_f32_16x16x32_bf16 v[216:219], a[60:63], a[8:11], v[216:219]
    buffer_load_dwordx4 v6, s[24:27], s81 offen offset:1024 lds
    v_mfma_f32_16x16x32_bf16 v[212:215], a[60:63], a[4:7], v[212:215]
    s_add_u32 m0, s38, 4096
    v_mfma_f32_16x16x32_bf16 v[208:211], a[60:63], a[0:3], v[208:211]
    buffer_load_dwordx4 v24, s[16:19], s80 offen offset:0 lds
    v_mfma_f32_16x16x32_bf16 v[224:227], a[64:67], a[0:3], v[224:227]
    buffer_load_dwordx4 v25, s[16:19], s80 offen offset:1024 lds
    v_mfma_f32_16x16x32_bf16 v[228:231], a[64:67], a[4:7], v[228:231]
    buffer_load_dwordx4 v26, s[16:19], s80 offen offset:2048 lds
    v_mfma_f32_16x16x32_bf16 v[232:235], a[64:67], a[8:11], v[232:235]
    buffer_load_dwordx4 v27, s[16:19], s80 offen offset:3072 lds
    v_mfma_f32_16x16x32_bf16 v[236:239], a[64:67], a[12:15], v[236:239]
    v_mfma_f32_16x16x32_bf16 v[252:255], a[68:71], a[12:15], v[252:255]
    v_mfma_f32_16x16x32_bf16 v[248:251], a[68:71], a[8:11], v[248:251]
    v_mfma_f32_16x16x32_bf16 v[244:247], a[68:71], a[4:7], v[244:247]
    v_mfma_f32_16x16x32_bf16 v[240:243], a[68:71], a[0:3], v[240:243]
    s_waitcnt vmcnt(16) lgkmcnt(0)
    s_barrier
    v_mfma_f32_16x16x32_bf16 v[32:35], a[88:91], a[72:75], v[32:35]
    ds_read_b128 a[0:3], v8 offset:0
    v_mfma_f32_16x16x32_bf16 v[36:39], a[88:91], a[76:79], v[36:39]
    ds_read_b128 a[4:7], v8 offset:2048
    v_mfma_f32_16x16x32_bf16 v[40:43], a[88:91], a[80:83], v[40:43]
    ds_read_b128 a[8:11], v8 offset:4096
    v_mfma_f32_16x16x32_bf16 v[44:47], a[88:91], a[84:87], v[44:47]
    s_add_u32 s81, s81, 229376
    v_mfma_f32_16x16x32_bf16 v[60:63], a[92:95], a[84:87], v[60:63]
    ds_read_b128 a[12:15], v8 offset:6144
    v_mfma_f32_16x16x32_bf16 v[56:59], a[92:95], a[80:83], v[56:59]
    ds_read_b64_tr_b16 a[16:17], v11 offset:0
    v_mfma_f32_16x16x32_bf16 v[52:55], a[92:95], a[76:79], v[52:55]
    s_add_u32 m0, s39, 49152
    v_mfma_f32_16x16x32_bf16 v[48:51], a[92:95], a[72:75], v[48:51]
    ds_read_b64_tr_b16 a[18:19], v11 offset:1024
    v_mfma_f32_16x16x32_bf16 v[64:67], a[96:99], a[72:75], v[64:67]
    ds_read_b64_tr_b16 a[20:21], v11 offset:2048
    v_mfma_f32_16x16x32_bf16 v[68:71], a[96:99], a[76:79], v[68:71]
    ds_read_b64_tr_b16 a[22:23], v11 offset:3072
    v_mfma_f32_16x16x32_bf16 v[72:75], a[96:99], a[80:83], v[72:75]
    buffer_load_dwordx4 v5, s[20:23], s81 offen offset:0 lds
    v_mfma_f32_16x16x32_bf16 v[76:79], a[96:99], a[84:87], v[76:79]
    ds_read_b64_tr_b16 a[24:25], v11 offset:32
    v_mfma_f32_16x16x32_bf16 v[92:95], a[100:103], a[84:87], v[92:95]
    ds_read_b64_tr_b16 a[26:27], v11 offset:1056
    v_mfma_f32_16x16x32_bf16 v[88:91], a[100:103], a[80:83], v[88:91]
    buffer_load_dwordx4 v6, s[20:23], s81 offen offset:1024 lds
    v_mfma_f32_16x16x32_bf16 v[84:87], a[100:103], a[76:79], v[84:87]
    ds_read_b64_tr_b16 a[28:29], v11 offset:2080
    v_mfma_f32_16x16x32_bf16 v[80:83], a[100:103], a[72:75], v[80:83]
    ds_read_b64_tr_b16 a[30:31], v11 offset:3104
    v_mfma_f32_16x16x32_bf16 v[96:99], a[104:107], a[72:75], v[96:99]
    v_mfma_f32_16x16x32_bf16 v[100:103], a[104:107], a[76:79], v[100:103]
    ds_read_b64_tr_b16 a[32:33], v11 offset:64
    v_mfma_f32_16x16x32_bf16 v[104:107], a[104:107], a[80:83], v[104:107]
    ds_read_b64_tr_b16 a[34:35], v11 offset:1088
    v_mfma_f32_16x16x32_bf16 v[108:111], a[104:107], a[84:87], v[108:111]
    ds_read_b64_tr_b16 a[36:37], v11 offset:2112
    v_mfma_f32_16x16x32_bf16 v[124:127], a[108:111], a[84:87], v[124:127]
    s_add_u32 m0, s39, 51200
    v_mfma_f32_16x16x32_bf16 v[120:123], a[108:111], a[80:83], v[120:123]
    ds_read_b64_tr_b16 a[38:39], v11 offset:3136
    v_mfma_f32_16x16x32_bf16 v[116:119], a[108:111], a[76:79], v[116:119]
    ds_read_b64_tr_b16 a[40:41], v11 offset:96
    v_mfma_f32_16x16x32_bf16 v[112:115], a[108:111], a[72:75], v[112:115]
    buffer_load_dwordx4 v5, s[24:27], s81 offen offset:0 lds
    v_mfma_f32_16x16x32_bf16 v[128:131], a[112:115], a[72:75], v[128:131]
    ds_read_b64_tr_b16 a[42:43], v11 offset:1120
    v_mfma_f32_16x16x32_bf16 v[132:135], a[112:115], a[76:79], v[132:135]
    ds_read_b64_tr_b16 a[44:45], v11 offset:2144
    v_mfma_f32_16x16x32_bf16 v[136:139], a[112:115], a[80:83], v[136:139]
    ds_read_b64_tr_b16 a[46:47], v11 offset:3168
    v_mfma_f32_16x16x32_bf16 v[140:143], a[112:115], a[84:87], v[140:143]
    buffer_load_dwordx4 v6, s[24:27], s81 offen offset:1024 lds
    v_mfma_f32_16x16x32_bf16 v[156:159], a[116:119], a[84:87], v[156:159]
    ds_read_b64_tr_b16 a[48:49], v11 offset:128
    v_mfma_f32_16x16x32_bf16 v[152:155], a[116:119], a[80:83], v[152:155]
    ds_read_b64_tr_b16 a[50:51], v11 offset:1152
    v_mfma_f32_16x16x32_bf16 v[148:151], a[116:119], a[76:79], v[148:151]
    v_mfma_f32_16x16x32_bf16 v[144:147], a[116:119], a[72:75], v[144:147]
    ds_read_b64_tr_b16 a[52:53], v11 offset:2176
    v_mfma_f32_16x16x32_bf16 v[160:163], a[120:123], a[72:75], v[160:163]
    ds_read_b64_tr_b16 a[54:55], v11 offset:3200
    v_mfma_f32_16x16x32_bf16 v[164:167], a[120:123], a[76:79], v[164:167]
    s_bfe_u32 s80, s60, 262160
    v_mfma_f32_16x16x32_bf16 v[168:171], a[120:123], a[80:83], v[168:171]
    ds_read_b64_tr_b16 a[56:57], v11 offset:160
    v_mfma_f32_16x16x32_bf16 v[172:175], a[120:123], a[84:87], v[172:175]
    ds_read_b64_tr_b16 a[58:59], v11 offset:1184
    v_mfma_f32_16x16x32_bf16 v[188:191], a[124:127], a[84:87], v[188:191]
    ds_read_b64_tr_b16 a[60:61], v11 offset:2208
    v_mfma_f32_16x16x32_bf16 v[184:187], a[124:127], a[80:83], v[184:187]
    s_lshl_b32 s80, s80, 7
    v_mfma_f32_16x16x32_bf16 v[180:183], a[124:127], a[76:79], v[180:183]
    ds_read_b64_tr_b16 a[62:63], v11 offset:3232
    v_mfma_f32_16x16x32_bf16 v[176:179], a[124:127], a[72:75], v[176:179]
    ds_read_b64_tr_b16 a[64:65], v11 offset:192
    v_mfma_f32_16x16x32_bf16 v[192:195], a[128:131], a[72:75], v[192:195]
    s_add_u32 s80, s80, s35
    v_mfma_f32_16x16x32_bf16 v[196:199], a[128:131], a[76:79], v[196:199]
    ds_read_b64_tr_b16 a[66:67], v11 offset:1216
    v_mfma_f32_16x16x32_bf16 v[200:203], a[128:131], a[80:83], v[200:203]
    ds_read_b64_tr_b16 a[68:69], v11 offset:2240
    v_mfma_f32_16x16x32_bf16 v[204:207], a[128:131], a[84:87], v[204:207]
    s_add_u32 m0, s38, 32768
    v_mfma_f32_16x16x32_bf16 v[220:223], a[132:135], a[84:87], v[220:223]
    ds_read_b64_tr_b16 a[70:71], v11 offset:3264
    v_mfma_f32_16x16x32_bf16 v[216:219], a[132:135], a[80:83], v[216:219]
    v_mfma_f32_16x16x32_bf16 v[212:215], a[132:135], a[76:79], v[212:215]
    buffer_load_dwordx4 v1, s[16:19], s80 offen offset:0 lds
    v_mfma_f32_16x16x32_bf16 v[208:211], a[132:135], a[72:75], v[208:211]
    buffer_load_dwordx4 v2, s[16:19], s80 offen offset:1024 lds
    v_mfma_f32_16x16x32_bf16 v[224:227], a[136:139], a[72:75], v[224:227]
    buffer_load_dwordx4 v3, s[16:19], s80 offen offset:2048 lds
    v_mfma_f32_16x16x32_bf16 v[228:231], a[136:139], a[76:79], v[228:231]
    v_mfma_f32_16x16x32_bf16 v[232:235], a[136:139], a[80:83], v[232:235]
    buffer_load_dwordx4 v4, s[16:19], s80 offen offset:3072 lds
    v_mfma_f32_16x16x32_bf16 v[236:239], a[136:139], a[84:87], v[236:239]
    v_mfma_f32_16x16x32_bf16 v[252:255], a[140:143], a[84:87], v[252:255]
    global_load_dword a255, v23, s[86:87]
    v_mfma_f32_16x16x32_bf16 v[248:251], a[140:143], a[80:83], v[248:251]
    v_mfma_f32_16x16x32_bf16 v[244:247], a[140:143], a[76:79], v[244:247]
    v_mfma_f32_16x16x32_bf16 v[240:243], a[140:143], a[72:75], v[240:243]
    s_waitcnt vmcnt(21) lgkmcnt(0)
    s_barrier
    s_cmp_lg_u32 s32, 0
    s_cbranch_scc1 k_noarr
    s_mov_b64 exec, 1
    buffer_atomic_add v20, v31, s[88:91], s36 offen sc1
    s_mov_b64 exec, -1
k_noarr:
    v_mfma_f32_16x16x32_bf16 v[32:35], a[16:19], a[0:3], v[32:35]
    ds_read_b128 a[72:75], v10 offset:0
    v_mfma_f32_16x16x32_bf16 v[36:39], a[16:19], a[4:7], v[36:39]
    ds_read_b128 a[76:79], v10 offset:2048
    v_mfma_f32_16x16x32_bf16 v[40:43], a[16:19], a[8:11], v[40:43]
    ds_read_b128 a[80:83], v10 offset:4096
    v_mfma_f32_16x16x32_bf16 v[44:47], a[16:19], a[12:15], v[44:47]
    s_bfe_u32 s81, s60, 262160
    v_mfma_f32_16x16x32_bf16 v[60:63], a[20:23], a[12:15], v[60:63]
    ds_read_b128 a[84:87], v10 offset:6144
    v_mfma_f32_16x16x32_bf16 v[56:59], a[20:23], a[8:11], v[56:59]
    ds_read_b64_tr_b16 a[88:89], v11 offset:16384
    v_mfma_f32_16x16x32_bf16 v[52:55], a[20:23], a[4:7], v[52:55]
    s_mul_i32 s81, s81, 458752
    v_mfma_f32_16x16x32_bf16 v[48:51], a[20:23], a[0:3], v[48:51]
    ds_read_b64_tr_b16 a[90:91], v11 offset:17408
    v_mfma_f32_16x16x32_bf16 v[64:67], a[24:27], a[0:3], v[64:67]
    ds_read_b64_tr_b16 a[92:93], v11 offset:18432
    v_mfma_f32_16x16x32_bf16 v[68:71], a[24:27], a[4:7], v[68:71]
    ds_read_b64_tr_b16 a[94:95], v11 offset:19456
    v_mfma_f32_16x16x32_bf16 v[72:75], a[24:27], a[8:11], v[72:75]
    s_add_u32 s81, s81, s37
    v_mfma_f32_16x16x32_bf16 v[76:79], a[24:27], a[12:15], v[76:79]
    ds_read_b64_tr_b16 a[96:97], v11 offset:16416
    v_mfma_f32_16x16x32_bf16 v[92:95], a[28:31], a[12:15], v[92:95]
    ds_read_b64_tr_b16 a[98:99], v11 offset:17440
    v_mfma_f32_16x16x32_bf16 v[88:91], a[28:31], a[8:11], v[88:91]
    v_mfma_f32_16x16x32_bf16 v[84:87], a[28:31], a[4:7], v[84:87]
    ds_read_b64_tr_b16 a[100:101], v11 offset:18464
    v_mfma_f32_16x16x32_bf16 v[80:83], a[28:31], a[0:3], v[80:83]
    ds_read_b64_tr_b16 a[102:103], v11 offset:19488
    v_mfma_f32_16x16x32_bf16 v[96:99], a[32:35], a[0:3], v[96:99]
    s_add_u32 m0, s39, 0
    v_mfma_f32_16x16x32_bf16 v[100:103], a[32:35], a[4:7], v[100:103]
    ds_read_b64_tr_b16 a[104:105], v11 offset:16448
    v_mfma_f32_16x16x32_bf16 v[104:107], a[32:35], a[8:11], v[104:107]
    ds_read_b64_tr_b16 a[106:107], v11 offset:17472
    v_mfma_f32_16x16x32_bf16 v[108:111], a[32:35], a[12:15], v[108:111]
    ds_read_b64_tr_b16 a[108:109], v11 offset:18496
    v_mfma_f32_16x16x32_bf16 v[124:127], a[36:39], a[12:15], v[124:127]
    buffer_load_dwordx4 v5, s[20:23], s81 offen offset:0 lds
    v_mfma_f32_16x16x32_bf16 v[120:123], a[36:39], a[8:11], v[120:123]
    ds_read_b64_tr_b16 a[110:111], v11 offset:19520
    v_mfma_f32_16x16x32_bf16 v[116:119], a[36:39], a[4:7], v[116:119]
    ds_read_b64_tr_b16 a[112:113], v11 offset:16480
    v_mfma_f32_16x16x32_bf16 v[112:115], a[36:39], a[0:3], v[112:115]
    buffer_load_dwordx4 v6, s[20:23], s81 offen offset:1024 lds
    v_mfma_f32_16x16x32_bf16 v[128:131], a[40:43], a[0:3], v[128:131]
    ds_read_b64_tr_b16 a[114:115], v11 offset:17504
    v_mfma_f32_16x16x32_bf16 v[132:135], a[40:43], a[4:7], v[132:135]
    ds_read_b64_tr_b16 a[116:117], v11 offset:18528
    v_mfma_f32_16x16x32_bf16 v[136:139], a[40:43], a[8:11], v[136:139]
    ds_read_b64_tr_b16 a[118:119], v11 offset:19552
    v_mfma_f32_16x16x32_bf16 v[140:143], a[40:43], a[12:15], v[140:143]
    v_mfma_f32_16x16x32_bf16 v[156:159], a[44:47], a[12:15], v[156:159]
    ds_read_b64_tr_b16 a[120:121], v11 offset:16512
    v_mfma_f32_16x16x32_bf16 v[152:155], a[44:47], a[8:11], v[152:155]
    ds_read_b64_tr_b16 a[122:123], v11 offset:17536
    v_mfma_f32_16x16x32_bf16 v[148:151], a[44:47], a[4:7], v[148:151]
    s_add_u32 m0, s39, 2048
    v_mfma_f32_16x16x32_bf16 v[144:147], a[44:47], a[0:3], v[144:147]
    ds_read_b64_tr_b16 a[124:125], v11 offset:18560
    v_mfma_f32_16x16x32_bf16 v[160:163], a[48:51], a[0:3], v[160:163]
    ds_read_b64_tr_b16 a[126:127], v11 offset:19584
    v_mfma_f32_16x16x32_bf16 v[164:167], a[48:51], a[4:7], v[164:167]
    buffer_load_dwordx4 v5, s[24:27], s81 offen offset:0 lds
    v_mfma_f32_16x16x32_bf16 v[168:171], a[48:51], a[8:11], v[168:171]
    ds_read_b64_tr_b16 a[128:129], v11 offset:16544
    v_mfma_f32_16x16x32_bf16 v[172:175], a[48:51], a[12:15], v[172:175]
    ds_read_b64_tr_b16 a[130:131], v11 offset:17568
    v_mfma_f32_16x16x32_bf16 v[188:191], a[52:55], a[12:15], v[188:191]
    ds_read_b64_tr_b16 a[132:133], v11 offset:18592
    v_mfma_f32_16x16x32_bf16 v[184:187], a[52:55], a[8:11], v[184:187]
    v_mfma_f32_16x16x32_bf16 v[180:183], a[52:55], a[4:7], v[180:183]
    ds_read_b64_tr_b16 a[134:135], v11 offset:19616
    v_mfma_f32_16x16x32_bf16 v[176:179], a[52:55], a[0:3], v[176:179]
    ds_read_b64_tr_b16 a[136:137], v11 offset:16576
    v_mfma_f32_16x16x32_bf16 v[192:195], a[56:59], a[0:3], v[192:195]
    buffer_load_dwordx4 v6, s[24:27], s81 offen offset:1024 lds
    v_mfma_f32_16x16x32_bf16 v[196:199], a[56:59], a[4:7], v[196:199]
    ds_read_b64_tr_b16 a[138:139], v11 offset:17600
    v_mfma_f32_16x16x32_bf16 v[200:203], a[56:59], a[8:11], v[200:203]
    ds_read_b64_tr_b16 a[140:141], v11 offset:18624
    v_mfma_f32_16x16x32_bf16 v[204:207], a[56:59], a[12:15], v[204:207]
    s_add_u32 m0, s38, 36864
    v_mfma_f32_16x16x32_bf16 v[220:223], a[60:63], a[12:15], v[220:223]
    ds_read_b64_tr_b16 a[142:143], v11 offset:19648
    v_mfma_f32_16x16x32_bf16 v[216:219], a[60:63], a[8:11], v[216:219]
    buffer_load_dwordx4 v24, s[16:19], s80 offen offset:0 lds
    v_mfma_f32_16x16x32_bf16 v[212:215], a[60:63], a[4:7], v[212:215]
    v_mfma_f32_16x16x32_bf16 v[208:211], a[60:63], a[0:3], v[208:211]
    buffer_load_dwordx4 v25, s[16:19], s80 offen offset:1024 lds
    v_mfma_f32_16x16x32_bf16 v[224:227], a[64:67], a[0:3], v[224:227]
    buffer_load_dwordx4 v26, s[16:19], s80 offen offset:2048 lds
    v_mfma_f32_16x16x32_bf16 v[228:231], a[64:67], a[4:7], v[228:231]
    v_mfma_f32_16x16x32_bf16 v[232:235], a[64:67], a[8:11], v[232:235]
    buffer_load_dwordx4 v27, s[16:19], s80 offen offset:3072 lds
    v_mfma_f32_16x16x32_bf16 v[236:239], a[64:67], a[12:15], v[236:239]
    v_mfma_f32_16x16x32_bf16 v[252:255], a[68:71], a[12:15], v[252:255]
    v_mfma_f32_16x16x32_bf16 v[248:251], a[68:71], a[8:11], v[248:251]
    v_mfma_f32_16x16x32_bf16 v[244:247], a[68:71], a[4:7], v[244:247]
    v_mfma_f32_16x16x32_bf16 v[240:243], a[68:71], a[0:3], v[240:243]
    s_waitcnt vmcnt(17) lgkmcnt(0)
    s_barrier
    v_mfma_f32_16x16x32_bf16 v[32:35], a[88:91], a[72:75], v[32:35]
    ds_read_b128 a[0:3], v7 offset:0
    v_mfma_f32_16x16x32_bf16 v[36:39], a[88:91], a[76:79], v[36:39]
    ds_read_b128 a[4:7], v7 offset:2048
    v_mfma_f32_16x16x32_bf16 v[40:43], a[88:91], a[80:83], v[40:43]
    ds_read_b128 a[8:11], v7 offset:4096
    v_mfma_f32_16x16x32_bf16 v[44:47], a[88:91], a[84:87], v[44:47]
    s_add_u32 s81, s81, 229376
    v_mfma_f32_16x16x32_bf16 v[60:63], a[92:95], a[84:87], v[60:63]
    ds_read_b128 a[12:15], v7 offset:6144
    v_mfma_f32_16x16x32_bf16 v[56:59], a[92:95], a[80:83], v[56:59]
    ds_read_b64_tr_b16 a[16:17], v11 offset:32768
    v_mfma_f32_16x16x32_bf16 v[52:55], a[92:95], a[76:79], v[52:55]
    s_add_u32 m0, s39, 16384
    v_mfma_f32_16x16x32_bf16 v[48:51], a[92:95], a[72:75], v[48:51]
    ds_read_b64_tr_b16 a[18:19], v11 offset:33792
    v_mfma_f32_16x16x32_bf16 v[64:67], a[96:99], a[72:75], v[64:67]
    ds_read_b64_tr_b16 a[20:21], v11 offset:34816
    v_mfma_f32_16x16x32_bf16 v[68:71], a[96:99], a[76:79], v[68:71]
    ds_read_b64_tr_b16 a[22:23], v11 offset:35840
    v_mfma_f32_16x16x32_bf16 v[72:75], a[96:99], a[80:83], v[72:75]
    buffer_load_dwordx4 v5, s[20:23], s81 offen offset:0 lds
    v_mfma_f32_16x16x32_bf16 v[76:79], a[96:99], a[84:87], v[76:79]
    ds_read_b64_tr_b16 a[24:25], v11 offset:32800
    v_mfma_f32_16x16x32_bf16 v[92:95], a[100:103], a[84:87], v[92:95]
    ds_read_b64_tr_b16 a[26:27], v11 offset:33824
    v_mfma_f32_16x16x32_bf16 v[88:91], a[100:103], a[80:83], v[88:91]
    buffer_load_dwordx4 v6, s[20:23], s81 offen offset:1024 lds
    v_mfma_f32_16x16x32_bf16 v[84:87], a[100:103], a[76:79], v[84:87]
    ds_read_b64_tr_b16 a[28:29], v11 offset:34848
    v_mfma_f32_16x16x32_bf16 v[80:83], a[100:103], a[72:75], v[80:83]
    ds_read_b64_tr_b16 a[30:31], v11 offset:35872
    v_mfma_f32_16x16x32_bf16 v[96:99], a[104:107], a[72:75], v[96:99]
    v_mfma_f32_16x16x32_bf16 v[100:103], a[104:107], a[76:79], v[100:103]
    ds_read_b64_tr_b16 a[32:33], v11 offset:32832
    v_mfma_f32_16x16x32_bf16 v[104:107], a[104:107], a[80:83], v[104:107]
    ds_read_b64_tr_b16 a[34:35], v11 offset:33856
    v_mfma_f32_16x16x32_bf16 v[108:111], a[104:107], a[84:87], v[108:111]
    ds_read_b64_tr_b16 a[36:37], v11 offset:34880
    v_mfma_f32_16x16x32_bf16 v[124:127], a[108:111], a[84:87], v[124:127]
    s_add_u32 m0, s39, 18432
    v_mfma_f32_16x16x32_bf16 v[120:123], a[108:111], a[80:83], v[120:123]
    ds_read_b64_tr_b16 a[38:39], v11 offset:35904
    v_mfma_f32_16x16x32_bf16 v[116:119], a[108:111], a[76:79], v[116:119]
    ds_read_b64_tr_b16 a[40:41], v11 offset:32864
    v_mfma_f32_16x16x32_bf16 v[112:115], a[108:111], a[72:75], v[112:115]
    buffer_load_dwordx4 v5, s[24:27], s81 offen offset:0 lds
    v_mfma_f32_16x16x32_bf16 v[128:131], a[112:115], a[72:75], v[128:131]
    ds_read_b64_tr_b16 a[42:43], v11 offset:33888
    v_mfma_f32_16x16x32_bf16 v[132:135], a[112:115], a[76:79], v[132:135]
    ds_read_b64_tr_b16 a[44:45], v11 offset:34912
    v_mfma_f32_16x16x32_bf16 v[136:139], a[112:115], a[80:83], v[136:139]
    ds_read_b64_tr_b16 a[46:47], v11 offset:35936
    v_mfma_f32_16x16x32_bf16 v[140:143], a[112:115], a[84:87], v[140:143]
    buffer_load_dwordx4 v6, s[24:27], s81 offen offset:1024 lds
    v_mfma_f32_16x16x32_bf16 v[156:159], a[116:119], a[84:87], v[156:159]
    ds_read_b64_tr_b16 a[48:49], v11 offset:32896
    v_mfma_f32_16x16x32_bf16 v[152:155], a[116:119], a[80:83], v[152:155]
    ds_read_b64_tr_b16 a[50:51], v11 offset:33920
    v_mfma_f32_16x16x32_bf16 v[148:151], a[116:119], a[76:79], v[148:151]
    v_mfma_f32_16x16x32_bf16 v[144:147], a[116:119], a[72:75], v[144:147]
    ds_read_b64_tr_b16 a[52:53], v11 offset:34944
    v_mfma_f32_16x16x32_bf16 v[160:163], a[120:123], a[72:75], v[160:163]
    ds_read_b64_tr_b16 a[54:55], v11 offset:35968
    v_mfma_f32_16x16x32_bf16 v[164:167], a[120:123], a[76:79], v[164:167]
    s_bfe_u32 s80, s60, 262164
    v_mfma_f32_16x16x32_bf16 v[168:171], a[120:123], a[80:83], v[168:171]
    ds_read_b64_tr_b16 a[56:57], v11 offset:32928
    v_mfma_f32_16x16x32_bf16 v[172:175], a[120:123], a[84:87], v[172:175]
    ds_read_b64_tr_b16 a[58:59], v11 offset:33952
    v_mfma_f32_16x16x32_bf16 v[188:191], a[124:127], a[84:87], v[188:191]
    ds_read_b64_tr_b16 a[60:61], v11 offset:34976
    v_mfma_f32_16x16x32_bf16 v[184:187], a[124:127], a[80:83], v[184:187]
    s_lshl_b32 s80, s80, 7
    v_mfma_f32_16x16x32_bf16 v[180:183], a[124:127], a[76:79], v[180:183]
    ds_read_b64_tr_b16 a[62:63], v11 offset:36000
    v_mfma_f32_16x16x32_bf16 v[176:179], a[124:127], a[72:75], v[176:179]
    ds_read_b64_tr_b16 a[64:65], v11 offset:32960
    v_mfma_f32_16x16x32_bf16 v[192:195], a[128:131], a[72:75], v[192:195]
    s_add_u32 s80, s80, s35
    v_mfma_f32_16x16x32_bf16 v[196:199], a[128:131], a[76:79], v[196:199]
    ds_read_b64_tr_b16 a[66:67], v11 offset:33984
    v_mfma_f32_16x16x32_bf16 v[200:203], a[128:131], a[80:83], v[200:203]
    ds_read_b64_tr_b16 a[68:69], v11 offset:35008
    v_mfma_f32_16x16x32_bf16 v[204:207], a[128:131], a[84:87], v[204:207]
    s_add_u32 m0, s38, 65536
    v_mfma_f32_16x16x32_bf16 v[220:223], a[132:135], a[84:87], v[220:223]
    ds_read_b64_tr_b16 a[70:71], v11 offset:36032
    v_mfma_f32_16x16x32_bf16 v[216:219], a[132:135], a[80:83], v[216:219]
    v_mfma_f32_16x16x32_bf16 v[212:215], a[132:135], a[76:79], v[212:215]
    buffer_load_dwordx4 v1, s[16:19], s80 offen offset:0 lds
    v_mfma_f32_16x16x32_bf16 v[208:211], a[132:135], a[72:75], v[208:211]
    buffer_load_dwordx4 v2, s[16:19], s80 offen offset:1024 lds
    v_mfma_f32_16x16x32_bf16 v[224:227], a[136:139], a[72:75], v[224:227]
    buffer_load_dwordx4 v3, s[16:19], s80 offen offset:2048 lds
    v_mfma_f32_16x16x32_bf16 v[228:231], a[136:139], a[76:79], v[228:231]
    v_mfma_f32_16x16x32_bf16 v[232:235], a[136:139], a[80:83], v[232:235]
    buffer_load_dwordx4 v4, s[16:19], s80 offen offset:3072 lds
    v_mfma_f32_16x16x32_bf16 v[236:239], a[136:139], a[84:87], v[236:239]
    v_mfma_f32_16x16x32_bf16 v[252:255], a[140:143], a[84:87], v[252:255]
    v_mfma_f32_16x16x32_bf16 v[248:251], a[140:143], a[80:83], v[248:251]
    v_mfma_f32_16x16x32_bf16 v[244:247], a[140:143], a[76:79], v[244:247]
    v_mfma_f32_16x16x32_bf16 v[240:243], a[140:143], a[72:75], v[240:243]
    s_waitcnt vmcnt(21) lgkmcnt(0)
    s_barrier
    v_mfma_f32_16x16x32_bf16 v[32:35], a[16:19], a[0:3], v[32:35]
    ds_read_b128 a[72:75], v9 offset:0
    v_mfma_f32_16x16x32_bf16 v[36:39], a[16:19], a[4:7], v[36:39]
    ds_read_b128 a[76:79], v9 offset:2048
    v_mfma_f32_16x16x32_bf16 v[40:43], a[16:19], a[8:11], v[40:43]
    ds_read_b128 a[80:83], v9 offset:4096
    v_mfma_f32_16x16x32_bf16 v[44:47], a[16:19], a[12:15], v[44:47]
    s_bfe_u32 s81, s60, 262164
    v_mfma_f32_16x16x32_bf16 v[60:63], a[20:23], a[12:15], v[60:63]
    ds_read_b128 a[84:87], v9 offset:6144
    v_mfma_f32_16x16x32_bf16 v[56:59], a[20:23], a[8:11], v[56:59]
    ds_read_b64_tr_b16 a[88:89], v11 offset:49152
    v_mfma_f32_16x16x32_bf16 v[52:55], a[20:23], a[4:7], v[52:55]
    s_mul_i32 s81, s81, 458752
    v_mfma_f32_16x16x32_bf16 v[48:51], a[20:23], a[0:3], v[48:51]
    ds_read_b64_tr_b16 a[90:91], v11 offset:50176
    v_mfma_f32_16x16x32_bf16 v[64:67], a[24:27], a[0:3], v[64:67]
    ds_read_b64_tr_b16 a[92:93], v11 offset:51200
    v_mfma_f32_16x16x32_bf16 v[68:71], a[24:27], a[4:7], v[68:71]
    ds_read_b64_tr_b16 a[94:95], v11 offset:52224
    v_mfma_f32_16x16x32_bf16 v[72:75], a[24:27], a[8:11], v[72:75]
    s_add_u32 s81, s81, s37
    v_mfma_f32_16x16x32_bf16 v[76:79], a[24:27], a[12:15], v[76:79]
    ds_read_b64_tr_b16 a[96:97], v11 offset:49184
    v_mfma_f32_16x16x32_bf16 v[92:95], a[28:31], a[12:15], v[92:95]
    ds_read_b64_tr_b16 a[98:99], v11 offset:50208
    v_mfma_f32_16x16x32_bf16 v[88:91], a[28:31], a[8:11], v[88:91]
    v_mfma_f32_16x16x32_bf16 v[84:87], a[28:31], a[4:7], v[84:87]
    ds_read_b64_tr_b16 a[100:101], v11 offset:51232
    v_mfma_f32_16x16x32_bf16 v[80:83], a[28:31], a[0:3], v[80:83]
    ds_read_b64_tr_b16 a[102:103], v11 offset:52256
    v_mfma_f32_16x16x32_bf16 v[96:99], a[32:35], a[0:3], v[96:99]
    s_add_u32 m0, s39, 32768
    v_mfma_f32_16x16x32_bf16 v[100:103], a[32:35], a[4:7], v[100:103]
    ds_read_b64_tr_b16 a[104:105], v11 offset:49216
    v_mfma_f32_16x16x32_bf16 v[104:107], a[32:35], a[8:11], v[104:107]
    ds_read_b64_tr_b16 a[106:107], v11 offset:50240
    v_mfma_f32_16x16x32_bf16 v[108:111], a[32:35], a[12:15], v[108:111]
    ds_read_b64_tr_b16 a[108:109], v11 offset:51264
    v_mfma_f32_16x16x32_bf16 v[124:127], a[36:39], a[12:15], v[124:127]
    buffer_load_dwordx4 v5, s[20:23], s81 offen offset:0 lds
    v_mfma_f32_16x16x32_bf16 v[120:123], a[36:39], a[8:11], v[120:123]
    ds_read_b64_tr_b16 a[110:111], v11 offset:52288
    v_mfma_f32_16x16x32_bf16 v[116:119], a[36:39], a[4:7], v[116:119]
    ds_read_b64_tr_b16 a[112:113], v11 offset:49248
    v_mfma_f32_16x16x32_bf16 v[112:115], a[36:39], a[0:3], v[112:115]
    buffer_load_dwordx4 v6, s[20:23], s81 offen offset:1024 lds
    v_mfma_f32_16x16x32_bf16 v[128:131], a[40:43], a[0:3], v[128:131]
    ds_read_b64_tr_b16 a[114:115], v11 offset:50272
    v_mfma_f32_16x16x32_bf16 v[132:135], a[40:43], a[4:7], v[132:135]
    ds_read_b64_tr_b16 a[116:117], v11 offset:51296
    v_mfma_f32_16x16x32_bf16 v[136:139], a[40:43], a[8:11], v[136:139]
    ds_read_b64_tr_b16 a[118:119], v11 offset:52320
    v_mfma_f32_16x16x32_bf16 v[140:143], a[40:43], a[12:15], v[140:143]
    v_mfma_f32_16x16x32_bf16 v[156:159], a[44:47], a[12:15], v[156:159]
    ds_read_b64_tr_b16 a[120:121], v11 offset:49280
    v_mfma_f32_16x16x32_bf16 v[152:155], a[44:47], a[8:11], v[152:155]
    ds_read_b64_tr_b16 a[122:123], v11 offset:50304
    v_mfma_f32_16x16x32_bf16 v[148:151], a[44:47], a[4:7], v[148:151]
    s_add_u32 m0, s39, 34816
    v_mfma_f32_16x16x32_bf16 v[144:147], a[44:47], a[0:3], v[144:147]
    ds_read_b64_tr_b16 a[124:125], v11 offset:51328
    v_mfma_f32_16x16x32_bf16 v[160:163], a[48:51], a[0:3], v[160:163]
    ds_read_b64_tr_b16 a[126:127], v11 offset:52352
    v_mfma_f32_16x16x32_bf16 v[164:167], a[48:51], a[4:7], v[164:167]
    buffer_load_dwordx4 v5, s[24:27], s81 offen offset:0 lds
    v_mfma_f32_16x16x32_bf16 v[168:171], a[48:51], a[8:11], v[168:171]
    ds_read_b64_tr_b16 a[128:129], v11 offset:49312
    v_mfma_f32_16x16x32_bf16 v[172:175], a[48:51], a[12:15], v[172:175]
    ds_read_b64_tr_b16 a[130:131], v11 offset:50336
    v_mfma_f32_16x16x32_bf16 v[188:191], a[52:55], a[12:15], v[188:191]
    ds_read_b64_tr_b16 a[132:133], v11 offset:51360
    v_mfma_f32_16x16x32_bf16 v[184:187], a[52:55], a[8:11], v[184:187]
    v_mfma_f32_16x16x32_bf16 v[180:183], a[52:55], a[4:7], v[180:183]
    ds_read_b64_tr_b16 a[134:135], v11 offset:52384
    v_mfma_f32_16x16x32_bf16 v[176:179], a[52:55], a[0:3], v[176:179]
    ds_read_b64_tr_b16 a[136:137], v11 offset:49344
    v_mfma_f32_16x16x32_bf16 v[192:195], a[56:59], a[0:3], v[192:195]
    buffer_load_dwordx4 v6, s[24:27], s81 offen offset:1024 lds
    v_mfma_f32_16x16x32_bf16 v[196:199], a[56:59], a[4:7], v[196:199]
    ds_read_b64_tr_b16 a[138:139], v11 offset:50368
    v_mfma_f32_16x16x32_bf16 v[200:203], a[56:59], a[8:11], v[200:203]
    ds_read_b64_tr_b16 a[140:141], v11 offset:51392
    v_mfma_f32_16x16x32_bf16 v[204:207], a[56:59], a[12:15], v[204:207]
    s_add_u32 m0, s38, 69632
    v_mfma_f32_16x16x32_bf16 v[220:223], a[60:63], a[12:15], v[220:223]
    ds_read_b64_tr_b16 a[142:143], v11 offset:52416
    v_mfma_f32_16x16x32_bf16 v[216:219], a[60:63], a[8:11], v[216:219]
    buffer_load_dwordx4 v24, s[16:19], s80 offen offset:0 lds
    v_mfma_f32_16x16x32_bf16 v[212:215], a[60:63], a[4:7], v[212:215]
    v_mfma_f32_16x16x32_bf16 v[208:211], a[60:63], a[0:3], v[208:211]
    buffer_load_dwordx4 v25, s[16:19], s80 offen offset:1024 lds
    v_mfma_f32_16x16x32_bf16 v[224:227], a[64:67], a[0:3], v[224:227]
    buffer_load_dwordx4 v26, s[16:19], s80 offen offset:2048 lds
    v_mfma_f32_16x16x32_bf16 v[228:231], a[64:67], a[4:7], v[228:231]
    v_mfma_f32_16x16x32_bf16 v[232:235], a[64:67], a[8:11], v[232:235]
    buffer_load_dwordx4 v27, s[16:19], s80 offen offset:3072 lds
    v_mfma_f32_16x16x32_bf16 v[236:239], a[64:67], a[12:15], v[236:239]
    v_mfma_f32_16x16x32_bf16 v[252:255], a[68:71], a[12:15], v[252:255]
    v_mfma_f32_16x16x32_bf16 v[248:251], a[68:71], a[8:11], v[248:251]
    v_mfma_f32_16x16x32_bf16 v[244:247], a[68:71], a[4:7], v[244:247]
    v_mfma_f32_16x16x32_bf16 v[240:243], a[68:71], a[0:3], v[240:243]
    s_waitcnt vmcnt(16) lgkmcnt(0)
    s_barrier
    v_mfma_f32_16x16x32_bf16 v[32:35], a[88:91], a[72:75], v[32:35]
    ds_read_b128 a[0:3], v7 offset:32768
    v_mfma_f32_16x16x32_bf16 v[36:39], a[88:91], a[76:79], v[36:39]
    ds_read_b128 a[4:7], v7 offset:34816
    v_mfma_f32_16x16x32_bf16 v[40:43], a[88:91], a[80:83], v[40:43]
    ds_read_b128 a[8:11], v7 offset:36864
    v_mfma_f32_16x16x32_bf16 v[44:47], a[88:91], a[84:87], v[44:47]
    s_add_u32 s81, s81, 229376
    v_mfma_f32_16x16x32_bf16 v[60:63], a[92:95], a[84:87], v[60:63]
    ds_read_b128 a[12:15], v7 offset:38912
    v_mfma_f32_16x16x32_bf16 v[56:59], a[92:95], a[80:83], v[56:59]
    ds_read_b64_tr_b16 a[16:17], v11 offset:0
    v_mfma_f32_16x16x32_bf16 v[52:55], a[92:95], a[76:79], v[52:55]
    s_add_u32 m0, s39, 49152
    v_mfma_f32_16x16x32_bf16 v[48:51], a[92:95], a[72:75], v[48:51]
    ds_read_b64_tr_b16 a[18:19], v11 offset:1024
    v_mfma_f32_16x16x32_bf16 v[64:67], a[96:99], a[72:75], v[64:67]
    ds_read_b64_tr_b16 a[20:21], v11 offset:2048
    v_mfma_f32_16x16x32_bf16 v[68:71], a[96:99], a[76:79], v[68:71]
    ds_read_b64_tr_b16 a[22:23], v11 offset:3072
    v_mfma_f32_16x16x32_bf16 v[72:75], a[96:99], a[80:83], v[72:75]
    buffer_load_dwordx4 v5, s[20:23], s81 offen offset:0 lds
    v_mfma_f32_16x16x32_bf16 v[76:79], a[96:99], a[84:87], v[76:79]
    ds_read_b64_tr_b16 a[24:25], v11 offset:32
    v_mfma_f32_16x16x32_bf16 v[92:95], a[100:103], a[84:87], v[92:95]
    ds_read_b64_tr_b16 a[26:27], v11 offset:1056
    v_mfma_f32_16x16x32_bf16 v[88:91], a[100:103], a[80:83], v[88:91]
    buffer_load_dwordx4 v6, s[20:23], s81 offen offset:1024 lds
    v_mfma_f32_16x16x32_bf16 v[84:87], a[100:103], a[76:79], v[84:87]
    ds_read_b64_tr_b16 a[28:29], v11 offset:2080
    v_mfma_f32_16x16x32_bf16 v[80:83], a[100:103], a[72:75], v[80:83]
    ds_read_b64_tr_b16 a[30:31], v11 offset:3104
    v_mfma_f32_16x16x32_bf16 v[96:99], a[104:107], a[72:75], v[96:99]
    v_mfma_f32_16x16x32_bf16 v[100:103], a[104:107], a[76:79], v[100:103]
    ds_read_b64_tr_b16 a[32:33], v11 offset:64
    v_mfma_f32_16x16x32_bf16 v[104:107], a[104:107], a[80:83], v[104:107]
    ds_read_b64_tr_b16 a[34:35], v11 offset:1088
    v_mfma_f32_16x16x32_bf16 v[108:111], a[104:107], a[84:87], v[108:111]
    ds_read_b64_tr_b16 a[36:37], v11 offset:2112
    v_mfma_f32_16x16x32_bf16 v[124:127], a[108:111], a[84:87], v[124:127]
    s_add_u32 m0, s39, 51200
    v_mfma_f32_16x16x32_bf16 v[120:123], a[108:111], a[80:83], v[120:123]
    ds_read_b64_tr_b16 a[38:39], v11 offset:3136
    v_mfma_f32_16x16x32_bf16 v[116:119], a[108:111], a[76:79], v[116:119]
    ds_read_b64_tr_b16 a[40:41], v11 offset:96
    v_mfma_f32_16x16x32_bf16 v[112:115], a[108:111], a[72:75], v[112:115]
    buffer_load_dwordx4 v5, s[24:27], s81 offen offset:0 lds
    v_mfma_f32_16x16x32_bf16 v[128:131], a[112:115], a[72:75], v[128:131]
    ds_read_b64_tr_b16 a[42:43], v11 offset:1120
    v_mfma_f32_16x16x32_bf16 v[132:135], a[112:115], a[76:79], v[132:135]
    ds_read_b64_tr_b16 a[44:45], v11 offset:2144
    v_mfma_f32_16x16x32_bf16 v[136:139], a[112:115], a[80:83], v[136:139]
    ds_read_b64_tr_b16 a[46:47], v11 offset:3168
    v_mfma_f32_16x16x32_bf16 v[140:143], a[112:115], a[84:87], v[140:143]
    buffer_load_dwordx4 v6, s[24:27], s81 offen offset:1024 lds
    v_mfma_f32_16x16x32_bf16 v[156:159], a[116:119], a[84:87], v[156:159]
    ds_read_b64_tr_b16 a[48:49], v11 offset:128
    v_mfma_f32_16x16x32_bf16 v[152:155], a[116:119], a[80:83], v[152:155]
    ds_read_b64_tr_b16 a[50:51], v11 offset:1152
    v_mfma_f32_16x16x32_bf16 v[148:151], a[116:119], a[76:79], v[148:151]
    v_mfma_f32_16x16x32_bf16 v[144:147], a[116:119], a[72:75], v[144:147]
    ds_read_b64_tr_b16 a[52:53], v11 offset:2176
    v_mfma_f32_16x16x32_bf16 v[160:163], a[120:123], a[72:75], v[160:163]
    ds_read_b64_tr_b16 a[54:55], v11 offset:3200
    v_mfma_f32_16x16x32_bf16 v[164:167], a[120:123], a[76:79], v[164:167]
    s_bfe_u32 s80, s60, 262168
    v_mfma_f32_16x16x32_bf16 v[168:171], a[120:123], a[80:83], v[168:171]
    ds_read_b64_tr_b16 a[56:57], v11 offset:160
    v_mfma_f32_16x16x32_bf16 v[172:175], a[120:123], a[84:87], v[172:175]
    ds_read_b64_tr_b16 a[58:59], v11 offset:1184
    v_mfma_f32_16x16x32_bf16 v[188:191], a[124:127], a[84:87], v[188:191]
    ds_read_b64_tr_b16 a[60:61], v11 offset:2208
    v_mfma_f32_16x16x32_bf16 v[184:187], a[124:127], a[80:83], v[184:187]
    s_lshl_b32 s80, s80, 7
    v_mfma_f32_16x16x32_bf16 v[180:183], a[124:127], a[76:79], v[180:183]
    ds_read_b64_tr_b16 a[62:63], v11 offset:3232
    v_mfma_f32_16x16x32_bf16 v[176:179], a[124:127], a[72:75], v[176:179]
    ds_read_b64_tr_b16 a[64:65], v11 offset:192
    v_mfma_f32_16x16x32_bf16 v[192:195], a[128:131], a[72:75], v[192:195]
    s_add_u32 s80, s80, s35
    v_mfma_f32_16x16x32_bf16 v[196:199], a[128:131], a[76:79], v[196:199]
    ds_read_b64_tr_b16 a[66:67], v11 offset:1216
    v_mfma_f32_16x16x32_bf16 v[200:203], a[128:131], a[80:83], v[200:203]
    ds_read_b64_tr_b16 a[68:69], v11 offset:2240
    v_mfma_f32_16x16x32_bf16 v[204:207], a[128:131], a[84:87], v[204:207]
    s_add_u32 m0, s38, 0
    v_mfma_f32_16x16x32_bf16 v[220:223], a[132:135], a[84:87], v[220:223]
    ds_read_b64_tr_b16 a[70:71], v11 offset:3264
    v_mfma_f32_16x16x32_bf16 v[216:219], a[132:135], a[80:83], v[216:219]
    v_mfma_f32_16x16x32_bf16 v[212:215], a[132:135], a[76:79], v[212:215]
    buffer_load_dwordx4 v1, s[16:19], s80 offen offset:0 lds
    v_mfma_f32_16x16x32_bf16 v[208:211], a[132:135], a[72:75], v[208:211]
    buffer_load_dwordx4 v2, s[16:19], s80 offen offset:1024 lds
    v_mfma_f32_16x16x32_bf16 v[224:227], a[136:139], a[72:75], v[224:227]
    buffer_load_dwordx4 v3, s[16:19], s80 offen offset:2048 lds
    v_mfma_f32_16x16x32_bf16 v[228:231], a[136:139], a[76:79], v[228:231]
    v_mfma_f32_16x16x32_bf16 v[232:235], a[136:139], a[80:83], v[232:235]
    buffer_load_dwordx4 v4, s[16:19], s80 offen offset:3072 lds
    v_mfma_f32_16x16x32_bf16 v[236:239], a[136:139], a[84:87], v[236:239]
    v_mfma_f32_16x16x32_bf16 v[252:255], a[140:143], a[84:87], v[252:255]
    v_mfma_f32_16x16x32_bf16 v[248:251], a[140:143], a[80:83], v[248:251]
    v_mfma_f32_16x16x32_bf16 v[244:247], a[140:143], a[76:79], v[244:247]
    v_mfma_f32_16x16x32_bf16 v[240:243], a[140:143], a[72:75], v[240:243]
    s_waitcnt vmcnt(20) lgkmcnt(0)
    s_barrier
    v_mfma_f32_16x16x32_bf16 v[32:35], a[16:19], a[0:3], v[32:35]
    ds_read_b128 a[72:75], v9 offset:32768
    v_mfma_f32_16x16x32_bf16 v[36:39], a[16:19], a[4:7], v[36:39]
    ds_read_b128 a[76:79], v9 offset:34816
    v_mfma_f32_16x16x32_bf16 v[40:43], a[16:19], a[8:11], v[40:43]
    ds_read_b128 a[80:83], v9 offset:36864
    v_mfma_f32_16x16x32_bf16 v[44:47], a[16:19], a[12:15], v[44:47]
    s_bfe_u32 s81, s60, 262168
    v_mfma_f32_16x16x32_bf16 v[60:63], a[20:23], a[12:15], v[60:63]
    ds_read_b128 a[84:87], v9 offset:38912
    v_mfma_f32_16x16x32_bf16 v[56:59], a[20:23], a[8:11], v[56:59]
    ds_read_b64_tr_b16 a[88:89], v11 offset:16384
    v_mfma_f32_16x16x32_bf16 v[52:55], a[20:23], a[4:7], v[52:55]
    s_mul_i32 s81, s81, 458752
    v_mfma_f32_16x16x32_bf16 v[48:51], a[20:23], a[0:3], v[48:51]
    ds_read_b64_tr_b16 a[90:91], v11 offset:17408
    v_mfma_f32_16x16x32_bf16 v[64:67], a[24:27], a[0:3], v[64:67]
    ds_read_b64_tr_b16 a[92:93], v11 offset:18432
    v_mfma_f32_16x16x32_bf16 v[68:71], a[24:27], a[4:7], v[68:71]
    ds_read_b64_tr_b16 a[94:95], v11 offset:19456
    v_mfma_f32_16x16x32_bf16 v[72:75], a[24:27], a[8:11], v[72:75]
    s_add_u32 s81, s81, s37
    v_mfma_f32_16x16x32_bf16 v[76:79], a[24:27], a[12:15], v[76:79]
    ds_read_b64_tr_b16 a[96:97], v11 offset:16416
    v_mfma_f32_16x16x32_bf16 v[92:95], a[28:31], a[12:15], v[92:95]
    ds_read_b64_tr_b16 a[98:99], v11 offset:17440
    v_mfma_f32_16x16x32_bf16 v[88:91], a[28:31], a[8:11], v[88:91]
    v_mfma_f32_16x16x32_bf16 v[84:87], a[28:31], a[4:7], v[84:87]
    ds_read_b64_tr_b16 a[100:101], v11 offset:18464
    v_mfma_f32_16x16x32_bf16 v[80:83], a[28:31], a[0:3], v[80:83]
    ds_read_b64_tr_b16 a[102:103], v11 offset:19488
    v_mfma_f32_16x16x32_bf16 v[96:99], a[32:35], a[0:3], v[96:99]
    s_add_u32 m0, s39, 0
    v_mfma_f32_16x16x32_bf16 v[100:103], a[32:35], a[4:7], v[100:103]
    ds_read_b64_tr_b16 a[104:105], v11 offset:16448
    v_mfma_f32_16x16x32_bf16 v[104:107], a[32:35], a[8:11], v[104:107]
    ds_read_b64_tr_b16 a[106:107], v11 offset:17472
    v_mfma_f32_16x16x32_bf16 v[108:111], a[32:35], a[12:15], v[108:111]
    ds_read_b64_tr_b16 a[108:109], v11 offset:18496
    v_mfma_f32_16x16x32_bf16 v[124:127], a[36:39], a[12:15], v[124:127]
    buffer_load_dwordx4 v5, s[20:23], s81 offen offset:0 lds
    v_mfma_f32_16x16x32_bf16 v[120:123], a[36:39], a[8:11], v[120:123]
    ds_read_b64_tr_b16 a[110:111], v11 offset:19520
    v_mfma_f32_16x16x32_bf16 v[116:119], a[36:39], a[4:7], v[116:119]
    ds_read_b64_tr_b16 a[112:113], v11 offset:16480
    v_mfma_f32_16x16x32_bf16 v[112:115], a[36:39], a[0:3], v[112:115]
    buffer_load_dwordx4 v6, s[20:23], s81 offen offset:1024 lds
    v_mfma_f32_16x16x32_bf16 v[128:131], a[40:43], a[0:3], v[128:131]
    ds_read_b64_tr_b16 a[114:115], v11 offset:17504
    v_mfma_f32_16x16x32_bf16 v[132:135], a[40:43], a[4:7], v[132:135]
    ds_read_b64_tr_b16 a[116:117], v11 offset:18528
    v_mfma_f32_16x16x32_bf16 v[136:139], a[40:43], a[8:11], v[136:139]
    ds_read_b64_tr_b16 a[118:119], v11 offset:19552
    v_mfma_f32_16x16x32_bf16 v[140:143], a[40:43], a[12:15], v[140:143]
    v_mfma_f32_16x16x32_bf16 v[156:159], a[44:47], a[12:15], v[156:159]
    ds_read_b64_tr_b16 a[120:121], v11 offset:16512
    v_mfma_f32_16x16x32_bf16 v[152:155], a[44:47], a[8:11], v[152:155]
    ds_read_b64_tr_b16 a[122:123], v11 offset:17536
    v_mfma_f32_16x16x32_bf16 v[148:151], a[44:47], a[4:7], v[148:151]
    s_add_u32 m0, s39, 2048
    v_mfma_f32_16x16x32_bf16 v[144:147], a[44:47], a[0:3], v[144:147]
    ds_read_b64_tr_b16 a[124:125], v11 offset:18560
    v_mfma_f32_16x16x32_bf16 v[160:163], a[48:51], a[0:3], v[160:163]
    ds_read_b64_tr_b16 a[126:127], v11 offset:19584
    v_mfma_f32_16x16x32_bf16 v[164:167], a[48:51], a[4:7], v[164:167]
    buffer_load_dwordx4 v5, s[24:27], s81 offen offset:0 lds
    v_mfma_f32_16x16x32_bf16 v[168:171], a[48:51], a[8:11], v[168:171]
    ds_read_b64_tr_b16 a[128:129], v11 offset:16544
    v_mfma_f32_16x16x32_bf16 v[172:175], a[48:51], a[12:15], v[172:175]
    ds_read_b64_tr_b16 a[130:131], v11 offset:17568
    v_mfma_f32_16x16x32_bf16 v[188:191], a[52:55], a[12:15], v[188:191]
    ds_read_b64_tr_b16 a[132:133], v11 offset:18592
    v_mfma_f32_16x16x32_bf16 v[184:187], a[52:55], a[8:11], v[184:187]
    v_mfma_f32_16x16x32_bf16 v[180:183], a[52:55], a[4:7], v[180:183]
    ds_read_b64_tr_b16 a[134:135], v11 offset:19616
    v_mfma_f32_16x16x32_bf16 v[176:179], a[52:55], a[0:3], v[176:179]
    ds_read_b64_tr_b16 a[136:137], v11 offset:16576
    v_mfma_f32_16x16x32_bf16 v[192:195], a[56:59], a[0:3], v[192:195]
    buffer_load_dwordx4 v6, s[24:27], s81 offen offset:1024 lds
    v_mfma_f32_16x16x32_bf16 v[196:199], a[56:59], a[4:7], v[196:199]
    ds_read_b64_tr_b16 a[138:139], v11 offset:17600
    v_mfma_f32_16x16x32_bf16 v[200:203], a[56:59], a[8:11], v[200:203]
    ds_read_b64_tr_b16 a[140:141], v11 offset:18624
    v_mfma_f32_16x16x32_bf16 v[204:207], a[56:59], a[12:15], v[204:207]
    s_add_u32 m0, s38, 4096
    v_mfma_f32_16x16x32_bf16 v[220:223], a[60:63], a[12:15], v[220:223]
    ds_read_b64_tr_b16 a[142:143], v11 offset:19648
    v_mfma_f32_16x16x32_bf16 v[216:219], a[60:63], a[8:11], v[216:219]
    buffer_load_dwordx4 v24, s[16:19], s80 offen offset:0 lds
    v_mfma_f32_16x16x32_bf16 v[212:215], a[60:63], a[4:7], v[212:215]
    v_mfma_f32_16x16x32_bf16 v[208:211], a[60:63], a[0:3], v[208:211]
    buffer_load_dwordx4 v25, s[16:19], s80 offen offset:1024 lds
    v_mfma_f32_16x16x32_bf16 v[224:227], a[64:67], a[0:3], v[224:227]
    buffer_load_dwordx4 v26, s[16:19], s80 offen offset:2048 lds
    v_mfma_f32_16x16x32_bf16 v[228:231], a[64:67], a[4:7], v[228:231]
    v_mfma_f32_16x16x32_bf16 v[232:235], a[64:67], a[8:11], v[232:235]
    buffer_load_dwordx4 v27, s[16:19], s80 offen offset:3072 lds
    v_mfma_f32_16x16x32_bf16 v[236:239], a[64:67], a[12:15], v[236:239]
    v_mfma_f32_16x16x32_bf16 v[252:255], a[68:71], a[12:15], v[252:255]
    v_mfma_f32_16x16x32_bf16 v[248:251], a[68:71], a[8:11], v[248:251]
    v_mfma_f32_16x16x32_bf16 v[244:247], a[68:71], a[4:7], v[244:247]
    v_mfma_f32_16x16x32_bf16 v[240:243], a[68:71], a[0:3], v[240:243]
    s_waitcnt vmcnt(16) lgkmcnt(0)
    s_barrier
    v_mfma_f32_16x16x32_bf16 v[32:35], a[88:91], a[72:75], v[32:35]
    ds_read_b128 a[0:3], v8 offset:0
    v_mfma_f32_16x16x32_bf16 v[36:39], a[88:91], a[76:79], v[36:39]
    ds_read_b128 a[4:7], v8 offset:2048
    v_mfma_f32_16x16x32_bf16 v[40:43], a[88:91], a[80:83], v[40:43]
    ds_read_b128 a[8:11], v8 offset:4096
    v_mfma_f32_16x16x32_bf16 v[44:47], a[88:91], a[84:87], v[44:47]
    s_add_u32 s81, s81, 229376
    v_mfma_f32_16x16x32_bf16 v[60:63], a[92:95], a[84:87], v[60:63]
    ds_read_b128 a[12:15], v8 offset:6144
    v_mfma_f32_16x16x32_bf16 v[56:59], a[92:95], a[80:83], v[56:59]
    ds_read_b64_tr_b16 a[16:17], v11 offset:32768
    v_mfma_f32_16x16x32_bf16 v[52:55], a[92:95], a[76:79], v[52:55]
    s_add_u32 m0, s39, 16384
    v_mfma_f32_16x16x32_bf16 v[48:51], a[92:95], a[72:75], v[48:51]
    ds_read_b64_tr_b16 a[18:19], v11 offset:33792
    v_mfma_f32_16x16x32_bf16 v[64:67], a[96:99], a[72:75], v[64:67]
    ds_read_b64_tr_b16 a[20:21], v11 offset:34816
    v_mfma_f32_16x16x32_bf16 v[68:71], a[96:99], a[76:79], v[68:71]
    ds_read_b64_tr_b16 a[22:23], v11 offset:35840
    v_mfma_f32_16x16x32_bf16 v[72:75], a[96:99], a[80:83], v[72:75]
    buffer_load_dwordx4 v5, s[20:23], s81 offen offset:0 lds
    v_mfma_f32_16x16x32_bf16 v[76:79], a[96:99], a[84:87], v[76:79]
    ds_read_b64_tr_b16 a[24:25], v11 offset:32800
    v_mfma_f32_16x16x32_bf16 v[92:95], a[100:103], a[84:87], v[92:95]
    ds_read_b64_tr_b16 a[26:27], v11 offset:33824
    v_mfma_f32_16x16x32_bf16 v[88:91], a[100:103], a[80:83], v[88:91]
    buffer_load_dwordx4 v6, s[20:23], s81 offen offset:1024 lds
    v_mfma_f32_16x16x32_bf16 v[84:87], a[100:103], a[76:79], v[84:87]
    ds_read_b64_tr_b16 a[28:29], v11 offset:34848
    v_mfma_f32_16x16x32_bf16 v[80:83], a[100:103], a[72:75], v[80:83]
    ds_read_b64_tr_b16 a[30:31], v11 offset:35872
    v_mfma_f32_16x16x32_bf16 v[96:99], a[104:107], a[72:75], v[96:99]
    v_mfma_f32_16x16x32_bf16 v[100:103], a[104:107], a[76:79], v[100:103]
    ds_read_b64_tr_b16 a[32:33], v11 offset:32832
    v_mfma_f32_16x16x32_bf16 v[104:107], a[104:107], a[80:83], v[104:107]
    ds_read_b64_tr_b16 a[34:35], v11 offset:33856
    v_mfma_f32_16x16x32_bf16 v[108:111], a[104:107], a[84:87], v[108:111]
    ds_read_b64_tr_b16 a[36:37], v11 offset:34880
    v_mfma_f32_16x16x32_bf16 v[124:127], a[108:111], a[84:87], v[124:127]
    s_add_u32 m0, s39, 18432
    v_mfma_f32_16x16x32_bf16 v[120:123], a[108:111], a[80:83], v[120:123]
    ds_read_b64_tr_b16 a[38:39], v11 offset:35904
    v_mfma_f32_16x16x32_bf16 v[116:119], a[108:111], a[76:79], v[116:119]
    ds_read_b64_tr_b16 a[40:41], v11 offset:32864
    v_mfma_f32_16x16x32_bf16 v[112:115], a[108:111], a[72:75], v[112:115]
    buffer_load_dwordx4 v5, s[24:27], s81 offen offset:0 lds
    v_mfma_f32_16x16x32_bf16 v[128:131], a[112:115], a[72:75], v[128:131]
    ds_read_b64_tr_b16 a[42:43], v11 offset:33888
    v_mfma_f32_16x16x32_bf16 v[132:135], a[112:115], a[76:79], v[132:135]
    ds_read_b64_tr_b16 a[44:45], v11 offset:34912
    v_mfma_f32_16x16x32_bf16 v[136:139], a[112:115], a[80:83], v[136:139]
    ds_read_b64_tr_b16 a[46:47], v11 offset:35936
    v_mfma_f32_16x16x32_bf16 v[140:143], a[112:115], a[84:87], v[140:143]
    buffer_load_dwordx4 v6, s[24:27], s81 offen offset:1024 lds
    v_mfma_f32_16x16x32_bf16 v[156:159], a[116:119], a[84:87], v[156:159]
    ds_read_b64_tr_b16 a[48:49], v11 offset:32896
    v_mfma_f32_16x16x32_bf16 v[152:155], a[116:119], a[80:83], v[152:155]
    ds_read_b64_tr_b16 a[50:51], v11 offset:33920
    v_mfma_f32_16x16x32_bf16 v[148:151], a[116:119], a[76:79], v[148:151]
    v_mfma_f32_16x16x32_bf16 v[144:147], a[116:119], a[72:75], v[144:147]
    ds_read_b64_tr_b16 a[52:53], v11 offset:34944
    v_mfma_f32_16x16x32_bf16 v[160:163], a[120:123], a[72:75], v[160:163]
    ds_read_b64_tr_b16 a[54:55], v11 offset:35968
    v_mfma_f32_16x16x32_bf16 v[164:167], a[120:123], a[76:79], v[164:167]
    s_bfe_u32 s80, s60, 262172
    v_mfma_f32_16x16x32_bf16 v[168:171], a[120:123], a[80:83], v[168:171]
    ds_read_b64_tr_b16 a[56:57], v11 offset:32928
    v_mfma_f32_16x16x32_bf16 v[172:175], a[120:123], a[84:87], v[172:175]
    ds_read_b64_tr_b16 a[58:59], v11 offset:33952
    v_mfma_f32_16x16x32_bf16 v[188:191], a[124:127], a[84:87], v[188:191]
    ds_read_b64_tr_b16 a[60:61], v11 offset:34976
    v_mfma_f32_16x16x32_bf16 v[184:187], a[124:127], a[80:83], v[184:187]
    s_lshl_b32 s80, s80, 7
    v_mfma_f32_16x16x32_bf16 v[180:183], a[124:127], a[76:79], v[180:183]
    ds_read_b64_tr_b16 a[62:63], v11 offset:36000
    v_mfma_f32_16x16x32_bf16 v[176:179], a[124:127], a[72:75], v[176:179]
    ds_read_b64_tr_b16 a[64:65], v11 offset:32960
    v_mfma_f32_16x16x32_bf16 v[192:195], a[128:131], a[72:75], v[192:195]
    s_add_u32 s80, s80, s35
    v_mfma_f32_16x16x32_bf16 v[196:199], a[128:131], a[76:79], v[196:199]
    ds_read_b64_tr_b16 a[66:67], v11 offset:33984
    v_mfma_f32_16x16x32_bf16 v[200:203], a[128:131], a[80:83], v[200:203]
    ds_read_b64_tr_b16 a[68:69], v11 offset:35008
    v_mfma_f32_16x16x32_bf16 v[204:207], a[128:131], a[84:87], v[204:207]
    s_add_u32 m0, s38, 32768
    v_mfma_f32_16x16x32_bf16 v[220:223], a[132:135], a[84:87], v[220:223]
    ds_read_b64_tr_b16 a[70:71], v11 offset:36032
    v_mfma_f32_16x16x32_bf16 v[216:219], a[132:135], a[80:83], v[216:219]
    v_mfma_f32_16x16x32_bf16 v[212:215], a[132:135], a[76:79], v[212:215]
    buffer_load_dwordx4 v1, s[16:19], s80 offen offset:0 lds
    v_mfma_f32_16x16x32_bf16 v[208:211], a[132:135], a[72:75], v[208:211]
    buffer_load_dwordx4 v2, s[16:19], s80 offen offset:1024 lds
    v_mfma_f32_16x16x32_bf16 v[224:227], a[136:139], a[72:75], v[224:227]
    buffer_load_dwordx4 v3, s[16:19], s80 offen offset:2048 lds
    v_mfma_f32_16x16x32_bf16 v[228:231], a[136:139], a[76:79], v[228:231]
    v_mfma_f32_16x16x32_bf16 v[232:235], a[136:139], a[80:83], v[232:235]
    buffer_load_dwordx4 v4, s[16:19], s80 offen offset:3072 lds
    v_mfma_f32_16x16x32_bf16 v[236:239], a[136:139], a[84:87], v[236:239]
    v_mfma_f32_16x16x32_bf16 v[252:255], a[140:143], a[84:87], v[252:255]
    v_mfma_f32_16x16x32_bf16 v[248:251], a[140:143], a[80:83], v[248:251]
    v_mfma_f32_16x16x32_bf16 v[244:247], a[140:143], a[76:79], v[244:247]
    v_mfma_f32_16x16x32_bf16 v[240:243], a[140:143], a[72:75], v[240:243]
    s_waitcnt vmcnt(20) lgkmcnt(0)
    s_barrier
    v_mfma_f32_16x16x32_bf16 v[32:35], a[16:19], a[0:3], v[32:35]
    ds_read_b128 a[72:75], v10 offset:0
    v_mfma_f32_16x16x32_bf16 v[36:39], a[16:19], a[4:7], v[36:39]
    ds_read_b128 a[76:79], v10 offset:2048
    v_mfma_f32_16x16x32_bf16 v[40:43], a[16:19], a[8:11], v[40:43]
    ds_read_b128 a[80:83], v10 offset:4096
    v_mfma_f32_16x16x32_bf16 v[44:47], a[16:19], a[12:15], v[44:47]
    s_bfe_u32 s81, s60, 262172
    v_mfma_f32_16x16x32_bf16 v[60:63], a[20:23], a[12:15], v[60:63]
    ds_read_b128 a[84:87], v10 offset:6144
    v_mfma_f32_16x16x32_bf16 v[56:59], a[20:23], a[8:11], v[56:59]
    ds_read_b64_tr_b16 a[88:89], v11 offset:49152
    v_mfma_f32_16x16x32_bf16 v[52:55], a[20:23], a[4:7], v[52:55]
    s_mul_i32 s81, s81, 458752
    v_mfma_f32_16x16x32_bf16 v[48:51], a[20:23], a[0:3], v[48:51]
    ds_read_b64_tr_b16 a[90:91], v11 offset:50176
    v_mfma_f32_16x16x32_bf16 v[64:67], a[24:27], a[0:3], v[64:67]
    ds_read_b64_tr_b16 a[92:93], v11 offset:51200
    v_mfma_f32_16x16x32_bf16 v[68:71], a[24:27], a[4:7], v[68:71]
    ds_read_b64_tr_b16 a[94:95], v11 offset:52224
    v_mfma_f32_16x16x32_bf16 v[72:75], a[24:27], a[8:11], v[72:75]
    s_add_u32 s81, s81, s37
    v_mfma_f32_16x16x32_bf16 v[76:79], a[24:27], a[12:15], v[76:79]
    ds_read_b64_tr_b16 a[96:97], v11 offset:49184
    v_mfma_f32_16x16x32_bf16 v[92:95], a[28:31], a[12:15], v[92:95]
    ds_read_b64_tr_b16 a[98:99], v11 offset:50208
    v_mfma_f32_16x16x32_bf16 v[88:91], a[28:31], a[8:11], v[88:91]
    v_mfma_f32_16x16x32_bf16 v[84:87], a[28:31], a[4:7], v[84:87]
    ds_read_b64_tr_b16 a[100:101], v11 offset:51232
    v_mfma_f32_16x16x32_bf16 v[80:83], a[28:31], a[0:3], v[80:83]
    ds_read_b64_tr_b16 a[102:103], v11 offset:52256
    v_mfma_f32_16x16x32_bf16 v[96:99], a[32:35], a[0:3], v[96:99]
    s_add_u32 m0, s39, 32768
    v_mfma_f32_16x16x32_bf16 v[100:103], a[32:35], a[4:7], v[100:103]
    ds_read_b64_tr_b16 a[104:105], v11 offset:49216
    v_mfma_f32_16x16x32_bf16 v[104:107], a[32:35], a[8:11], v[104:107]
    ds_read_b64_tr_b16 a[106:107], v11 offset:50240
    v_mfma_f32_16x16x32_bf16 v[108:111], a[32:35], a[12:15], v[108:111]
    ds_read_b64_tr_b16 a[108:109], v11 offset:51264
    v_mfma_f32_16x16x32_bf16 v[124:127], a[36:39], a[12:15], v[124:127]
    buffer_load_dwordx4 v5, s[20:23], s81 offen offset:0 lds
    v_mfma_f32_16x16x32_bf16 v[120:123], a[36:39], a[8:11], v[120:123]
    ds_read_b64_tr_b16 a[110:111], v11 offset:52288
    v_mfma_f32_16x16x32_bf16 v[116:119], a[36:39], a[4:7], v[116:119]
    ds_read_b64_tr_b16 a[112:113], v11 offset:49248
    v_mfma_f32_16x16x32_bf16 v[112:115], a[36:39], a[0:3], v[112:115]
    buffer_load_dwordx4 v6, s[20:23], s81 offen offset:1024 lds
    v_mfma_f32_16x16x32_bf16 v[128:131], a[40:43], a[0:3], v[128:131]
    ds_read_b64_tr_b16 a[114:115], v11 offset:50272
    v_mfma_f32_16x16x32_bf16 v[132:135], a[40:43], a[4:7], v[132:135]
    ds_read_b64_tr_b16 a[116:117], v11 offset:51296
    v_mfma_f32_16x16x32_bf16 v[136:139], a[40:43], a[8:11], v[136:139]
    ds_read_b64_tr_b16 a[118:119], v11 offset:52320
    v_mfma_f32_16x16x32_bf16 v[140:143], a[40:43], a[12:15], v[140:143]
    v_mfma_f32_16x16x32_bf16 v[156:159], a[44:47], a[12:15], v[156:159]
    ds_read_b64_tr_b16 a[120:121], v11 offset:49280
    v_mfma_f32_16x16x32_bf16 v[152:155], a[44:47], a[8:11], v[152:155]
    ds_read_b64_tr_b16 a[122:123], v11 offset:50304
    v_mfma_f32_16x16x32_bf16 v[148:151], a[44:47], a[4:7], v[148:151]
    s_add_u32 m0, s39, 34816
    v_mfma_f32_16x16x32_bf16 v[144:147], a[44:47], a[0:3], v[144:147]
    ds_read_b64_tr_b16 a[124:125], v11 offset:51328
    v_mfma_f32_16x16x32_bf16 v[160:163], a[48:51], a[0:3], v[160:163]
    ds_read_b64_tr_b16 a[126:127], v11 offset:52352
    v_mfma_f32_16x16x32_bf16 v[164:167], a[48:51], a[4:7], v[164:167]
    buffer_load_dwordx4 v5, s[24:27], s81 offen offset:0 lds
    v_mfma_f32_16x16x32_bf16 v[168:171], a[48:51], a[8:11], v[168:171]
    ds_read_b64_tr_b16 a[128:129], v11 offset:49312
    v_mfma_f32_16x16x32_bf16 v[172:175], a[48:51], a[12:15], v[172:175]
    ds_read_b64_tr_b16 a[130:131], v11 offset:50336
    v_mfma_f32_16x16x32_bf16 v[188:191], a[52:55], a[12:15], v[188:191]
    ds_read_b64_tr_b16 a[132:133], v11 offset:51360
    v_mfma_f32_16x16x32_bf16 v[184:187], a[52:55], a[8:11], v[184:187]
    v_mfma_f32_16x16x32_bf16 v[180:183], a[52:55], a[4:7], v[180:183]
    ds_read_b64_tr_b16 a[134:135], v11 offset:52384
    v_mfma_f32_16x16x32_bf16 v[176:179], a[52:55], a[0:3], v[176:179]
    ds_read_b64_tr_b16 a[136:137], v11 offset:49344
    v_mfma_f32_16x16x32_bf16 v[192:195], a[56:59], a[0:3], v[192:195]
    buffer_load_dwordx4 v6, s[24:27], s81 offen offset:1024 lds
    v_mfma_f32_16x16x32_bf16 v[196:199], a[56:59], a[4:7], v[196:199]
    ds_read_b64_tr_b16 a[138:139], v11 offset:50368
    v_mfma_f32_16x16x32_bf16 v[200:203], a[56:59], a[8:11], v[200:203]
    ds_read_b64_tr_b16 a[140:141], v11 offset:51392
    v_mfma_f32_16x16x32_bf16 v[204:207], a[56:59], a[12:15], v[204:207]
    s_add_u32 m0, s38, 36864
    v_mfma_f32_16x16x32_bf16 v[220:223], a[60:63], a[12:15], v[220:223]
    ds_read_b64_tr_b16 a[142:143], v11 offset:52416
    v_mfma_f32_16x16x32_bf16 v[216:219], a[60:63], a[8:11], v[216:219]
    buffer_load_dwordx4 v24, s[16:19], s80 offen offset:0 lds
    v_mfma_f32_16x16x32_bf16 v[212:215], a[60:63], a[4:7], v[212:215]
    v_mfma_f32_16x16x32_bf16 v[208:211], a[60:63], a[0:3], v[208:211]
    buffer_load_dwordx4 v25, s[16:19], s80 offen offset:1024 lds
    v_mfma_f32_16x16x32_bf16 v[224:227], a[64:67], a[0:3], v[224:227]
    buffer_load_dwordx4 v26, s[16:19], s80 offen offset:2048 lds
    v_mfma_f32_16x16x32_bf16 v[228:231], a[64:67], a[4:7], v[228:231]
    v_mfma_f32_16x16x32_bf16 v[232:235], a[64:67], a[8:11], v[232:235]
    buffer_load_dwordx4 v27, s[16:19], s80 offen offset:3072 lds
    v_mfma_f32_16x16x32_bf16 v[236:239], a[64:67], a[12:15], v[236:239]
    v_mfma_f32_16x16x32_bf16 v[252:255], a[68:71], a[12:15], v[252:255]
    v_mfma_f32_16x16x32_bf16 v[248:251], a[68:71], a[8:11], v[248:251]
    v_mfma_f32_16x16x32_bf16 v[244:247], a[68:71], a[4:7], v[244:247]
    v_mfma_f32_16x16x32_bf16 v[240:243], a[68:71], a[0:3], v[240:243]
    s_waitcnt vmcnt(16) lgkmcnt(0)
    s_barrier
    v_mfma_f32_16x16x32_bf16 v[32:35], a[88:91], a[72:75], v[32:35]
    ds_read_b128 a[0:3], v7 offset:0
    v_mfma_f32_16x16x32_bf16 v[36:39], a[88:91], a[76:79], v[36:39]
    ds_read_b128 a[4:7], v7 offset:2048
    v_mfma_f32_16x16x32_bf16 v[40:43], a[88:91], a[80:83], v[40:43]
    ds_read_b128 a[8:11], v7 offset:4096
    v_mfma_f32_16x16x32_bf16 v[44:47], a[88:91], a[84:87], v[44:47]
    s_add_u32 s81, s81, 229376
    v_mfma_f32_16x16x32_bf16 v[60:63], a[92:95], a[84:87], v[60:63]
    ds_read_b128 a[12:15], v7 offset:6144
    v_mfma_f32_16x16x32_bf16 v[56:59], a[92:95], a[80:83], v[56:59]
    ds_read_b64_tr_b16 a[16:17], v11 offset:0
    v_mfma_f32_16x16x32_bf16 v[52:55], a[92:95], a[76:79], v[52:55]
    s_add_u32 m0, s39, 49152
    v_mfma_f32_16x16x32_bf16 v[48:51], a[92:95], a[72:75], v[48:51]
    ds_read_b64_tr_b16 a[18:19], v11 offset:1024
    v_mfma_f32_16x16x32_bf16 v[64:67], a[96:99], a[72:75], v[64:67]
    ds_read_b64_tr_b16 a[20:21], v11 offset:2048
    v_mfma_f32_16x16x32_bf16 v[68:71], a[96:99], a[76:79], v[68:71]
    ds_read_b64_tr_b16 a[22:23], v11 offset:3072
    v_mfma_f32_16x16x32_bf16 v[72:75], a[96:99], a[80:83], v[72:75]
    buffer_load_dwordx4 v5, s[20:23], s81 offen offset:0 lds
    v_mfma_f32_16x16x32_bf16 v[76:79], a[96:99], a[84:87], v[76:79]
    ds_read_b64_tr_b16 a[24:25], v11 offset:32
    v_mfma_f32_16x16x32_bf16 v[92:95], a[100:103], a[84:87], v[92:95]
    ds_read_b64_tr_b16 a[26:27], v11 offset:1056
    v_mfma_f32_16x16x32_bf16 v[88:91], a[100:103], a[80:83], v[88:91]
    buffer_load_dwordx4 v6, s[20:23], s81 offen offset:1024 lds
    v_mfma_f32_16x16x32_bf16 v[84:87], a[100:103], a[76:79], v[84:87]
    ds_read_b64_tr_b16 a[28:29], v11 offset:2080
    v_mfma_f32_16x16x32_bf16 v[80:83], a[100:103], a[72:75], v[80:83]
    ds_read_b64_tr_b16 a[30:31], v11 offset:3104
    v_mfma_f32_16x16x32_bf16 v[96:99], a[104:107], a[72:75], v[96:99]
    v_mfma_f32_16x16x32_bf16 v[100:103], a[104:107], a[76:79], v[100:103]
    ds_read_b64_tr_b16 a[32:33], v11 offset:64
    v_mfma_f32_16x16x32_bf16 v[104:107], a[104:107], a[80:83], v[104:107]
    ds_read_b64_tr_b16 a[34:35], v11 offset:1088
    v_mfma_f32_16x16x32_bf16 v[108:111], a[104:107], a[84:87], v[108:111]
    ds_read_b64_tr_b16 a[36:37], v11 offset:2112
    v_mfma_f32_16x16x32_bf16 v[124:127], a[108:111], a[84:87], v[124:127]
    s_add_u32 m0, s39, 51200
    v_mfma_f32_16x16x32_bf16 v[120:123], a[108:111], a[80:83], v[120:123]
    ds_read_b64_tr_b16 a[38:39], v11 offset:3136
    v_mfma_f32_16x16x32_bf16 v[116:119], a[108:111], a[76:79], v[116:119]
    ds_read_b64_tr_b16 a[40:41], v11 offset:96
    v_mfma_f32_16x16x32_bf16 v[112:115], a[108:111], a[72:75], v[112:115]
    buffer_load_dwordx4 v5, s[24:27], s81 offen offset:0 lds
    v_mfma_f32_16x16x32_bf16 v[128:131], a[112:115], a[72:75], v[128:131]
    ds_read_b64_tr_b16 a[42:43], v11 offset:1120
    v_mfma_f32_16x16x32_bf16 v[132:135], a[112:115], a[76:79], v[132:135]
    ds_read_b64_tr_b16 a[44:45], v11 offset:2144
    v_mfma_f32_16x16x32_bf16 v[136:139], a[112:115], a[80:83], v[136:139]
    ds_read_b64_tr_b16 a[46:47], v11 offset:3168
    v_mfma_f32_16x16x32_bf16 v[140:143], a[112:115], a[84:87], v[140:143]
    buffer_load_dwordx4 v6, s[24:27], s81 offen offset:1024 lds
    v_mfma_f32_16x16x32_bf16 v[156:159], a[116:119], a[84:87], v[156:159]
    ds_read_b64_tr_b16 a[48:49], v11 offset:128
    v_mfma_f32_16x16x32_bf16 v[152:155], a[116:119], a[80:83], v[152:155]
    ds_read_b64_tr_b16 a[50:51], v11 offset:1152
    v_mfma_f32_16x16x32_bf16 v[148:151], a[116:119], a[76:79], v[148:151]
    v_mfma_f32_16x16x32_bf16 v[144:147], a[116:119], a[72:75], v[144:147]
    ds_read_b64_tr_b16 a[52:53], v11 offset:2176
    v_mfma_f32_16x16x32_bf16 v[160:163], a[120:123], a[72:75], v[160:163]
    ds_read_b64_tr_b16 a[54:55], v11 offset:3200
    v_mfma_f32_16x16x32_bf16 v[164:167], a[120:123], a[76:79], v[164:167]
    s_bfe_u32 s80, s61, 262144
    v_mfma_f32_16x16x32_bf16 v[168:171], a[120:123], a[80:83], v[168:171]
    ds_read_b64_tr_b16 a[56:57], v11 offset:160
    v_mfma_f32_16x16x32_bf16 v[172:175], a[120:123], a[84:87], v[172:175]
    ds_read_b64_tr_b16 a[58:59], v11 offset:1184
    v_mfma_f32_16x16x32_bf16 v[188:191], a[124:127], a[84:87], v[188:191]
    ds_read_b64_tr_b16 a[60:61], v11 offset:2208
    v_mfma_f32_16x16x32_bf16 v[184:187], a[124:127], a[80:83], v[184:187]
    s_lshl_b32 s80, s80, 7
    v_mfma_f32_16x16x32_bf16 v[180:183], a[124:127], a[76:79], v[180:183]
    ds_read_b64_tr_b16 a[62:63], v11 offset:3232
    v_mfma_f32_16x16x32_bf16 v[176:179], a[124:127], a[72:75], v[176:179]
    ds_read_b64_tr_b16 a[64:65], v11 offset:192
    v_mfma_f32_16x16x32_bf16 v[192:195], a[128:131], a[72:75], v[192:195]
    s_add_u32 s80, s80, s35
    v_mfma_f32_16x16x32_bf16 v[196:199], a[128:131], a[76:79], v[196:199]
    ds_read_b64_tr_b16 a[66:67], v11 offset:1216
    v_mfma_f32_16x16x32_bf16 v[200:203], a[128:131], a[80:83], v[200:203]
    ds_read_b64_tr_b16 a[68:69], v11 offset:2240
    v_mfma_f32_16x16x32_bf16 v[204:207], a[128:131], a[84:87], v[204:207]
    s_add_u32 m0, s38, 65536
    v_mfma_f32_16x16x32_bf16 v[220:223], a[132:135], a[84:87], v[220:223]
    ds_read_b64_tr_b16 a[70:71], v11 offset:3264
    v_mfma_f32_16x16x32_bf16 v[216:219], a[132:135], a[80:83], v[216:219]
    v_mfma_f32_16x16x32_bf16 v[212:215], a[132:135], a[76:79], v[212:215]
    buffer_load_dwordx4 v1, s[16:19], s80 offen offset:0 lds
    v_mfma_f32_16x16x32_bf16 v[208:211], a[132:135], a[72:75], v[208:211]
    buffer_load_dwordx4 v2, s[16:19], s80 offen offset:1024 lds
    v_mfma_f32_16x16x32_bf16 v[224:227], a[136:139], a[72:75], v[224:227]
    buffer_load_dwordx4 v3, s[16:19], s80 offen offset:2048 lds
    v_mfma_f32_16x16x32_bf16 v[228:231], a[136:139], a[76:79], v[228:231]
    v_mfma_f32_16x16x32_bf16 v[232:235], a[136:139], a[80:83], v[232:235]
    buffer_load_dwordx4 v4, s[16:19], s80 offen offset:3072 lds
    v_mfma_f32_16x16x32_bf16 v[236:239], a[136:139], a[84:87], v[236:239]
    v_mfma_f32_16x16x32_bf16 v[252:255], a[140:143], a[84:87], v[252:255]
    v_mfma_f32_16x16x32_bf16 v[248:251], a[140:143], a[80:83], v[248:251]
    v_mfma_f32_16x16x32_bf16 v[244:247], a[140:143], a[76:79], v[244:247]
    v_mfma_f32_16x16x32_bf16 v[240:243], a[140:143], a[72:75], v[240:243]
    s_waitcnt vmcnt(20) lgkmcnt(0)
    s_barrier
    v_mfma_f32_16x16x32_bf16 v[32:35], a[16:19], a[0:3], v[32:35]
    ds_read_b128 a[72:75], v9 offset:0
    v_mfma_f32_16x16x32_bf16 v[36:39], a[16:19], a[4:7], v[36:39]
    ds_read_b128 a[76:79], v9 offset:2048
    v_mfma_f32_16x16x32_bf16 v[40:43], a[16:19], a[8:11], v[40:43]
    ds_read_b128 a[80:83], v9 offset:4096
    v_mfma_f32_16x16x32_bf16 v[44:47], a[16:19], a[12:15], v[44:47]
    s_bfe_u32 s81, s61, 262144
    v_mfma_f32_16x16x32_bf16 v[60:63], a[20:23], a[12:15], v[60:63]
    ds_read_b128 a[84:87], v9 offset:6144
    v_mfma_f32_16x16x32_bf16 v[56:59], a[20:23], a[8:11], v[56:59]
    ds_read_b64_tr_b16 a[88:89], v11 offset:16384
    v_mfma_f32_16x16x32_bf16 v[52:55], a[20:23], a[4:7], v[52:55]
    s_mul_i32 s81, s81, 458752
    v_mfma_f32_16x16x32_bf16 v[48:51], a[20:23], a[0:3], v[48:51]
    ds_read_b64_tr_b16 a[90:91], v11 offset:17408
    v_mfma_f32_16x16x32_bf16 v[64:67], a[24:27], a[0:3], v[64:67]
    ds_read_b64_tr_b16 a[92:93], v11 offset:18432
    v_mfma_f32_16x16x32_bf16 v[68:71], a[24:27], a[4:7], v[68:71]
    ds_read_b64_tr_b16 a[94:95], v11 offset:19456
    v_mfma_f32_16x16x32_bf16 v[72:75], a[24:27], a[8:11], v[72:75]
    s_add_u32 s81, s81, s37
    v_mfma_f32_16x16x32_bf16 v[76:79], a[24:27], a[12:15], v[76:79]
    ds_read_b64_tr_b16 a[96:97], v11 offset:16416
    v_mfma_f32_16x16x32_bf16 v[92:95], a[28:31], a[12:15], v[92:95]
    ds_read_b64_tr_b16 a[98:99], v11 offset:17440
    v_mfma_f32_16x16x32_bf16 v[88:91], a[28:31], a[8:11], v[88:91]
    v_mfma_f32_16x16x32_bf16 v[84:87], a[28:31], a[4:7], v[84:87]
    ds_read_b64_tr_b16 a[100:101], v11 offset:18464
    v_mfma_f32_16x16x32_bf16 v[80:83], a[28:31], a[0:3], v[80:83]
    ds_read_b64_tr_b16 a[102:103], v11 offset:19488
    v_mfma_f32_16x16x32_bf16 v[96:99], a[32:35], a[0:3], v[96:99]
    s_add_u32 m0, s39, 0
    v_mfma_f32_16x16x32_bf16 v[100:103], a[32:35], a[4:7], v[100:103]
    ds_read_b64_tr_b16 a[104:105], v11 offset:16448
    v_mfma_f32_16x16x32_bf16 v[104:107], a[32:35], a[8:11], v[104:107]
    ds_read_b64_tr_b16 a[106:107], v11 offset:17472
    v_mfma_f32_16x16x32_bf16 v[108:111], a[32:35], a[12:15], v[108:111]
    ds_read_b64_tr_b16 a[108:109], v11 offset:18496
    v_mfma_f32_16x16x32_bf16 v[124:127], a[36:39], a[12:15], v[124:127]
    buffer_load_dwordx4 v5, s[20:23], s81 offen offset:0 lds
    v_mfma_f32_16x16x32_bf16 v[120:123], a[36:39], a[8:11], v[120:123]
    ds_read_b64_tr_b16 a[110:111], v11 offset:19520
    v_mfma_f32_16x16x32_bf16 v[116:119], a[36:39], a[4:7], v[116:119]
    ds_read_b64_tr_b16 a[112:113], v11 offset:16480
    v_mfma_f32_16x16x32_bf16 v[112:115], a[36:39], a[0:3], v[112:115]
    buffer_load_dwordx4 v6, s[20:23], s81 offen offset:1024 lds
    v_mfma_f32_16x16x32_bf16 v[128:131], a[40:43], a[0:3], v[128:131]
    ds_read_b64_tr_b16 a[114:115], v11 offset:17504
    v_mfma_f32_16x16x32_bf16 v[132:135], a[40:43], a[4:7], v[132:135]
    ds_read_b64_tr_b16 a[116:117], v11 offset:18528
    v_mfma_f32_16x16x32_bf16 v[136:139], a[40:43], a[8:11], v[136:139]
    ds_read_b64_tr_b16 a[118:119], v11 offset:19552
    v_mfma_f32_16x16x32_bf16 v[140:143], a[40:43], a[12:15], v[140:143]
    v_mfma_f32_16x16x32_bf16 v[156:159], a[44:47], a[12:15], v[156:159]
    ds_read_b64_tr_b16 a[120:121], v11 offset:16512
    v_mfma_f32_16x16x32_bf16 v[152:155], a[44:47], a[8:11], v[152:155]
    ds_read_b64_tr_b16 a[122:123], v11 offset:17536
    v_mfma_f32_16x16x32_bf16 v[148:151], a[44:47], a[4:7], v[148:151]
    s_add_u32 m0, s39, 2048
    v_mfma_f32_16x16x32_bf16 v[144:147], a[44:47], a[0:3], v[144:147]
    ds_read_b64_tr_b16 a[124:125], v11 offset:18560
    v_mfma_f32_16x16x32_bf16 v[160:163], a[48:51], a[0:3], v[160:163]
    ds_read_b64_tr_b16 a[126:127], v11 offset:19584
    v_mfma_f32_16x16x32_bf16 v[164:167], a[48:51], a[4:7], v[164:167]
    buffer_load_dwordx4 v5, s[24:27], s81 offen offset:0 lds
    v_mfma_f32_16x16x32_bf16 v[168:171], a[48:51], a[8:11], v[168:171]
    ds_read_b64_tr_b16 a[128:129], v11 offset:16544
    v_mfma_f32_16x16x32_bf16 v[172:175], a[48:51], a[12:15], v[172:175]
    ds_read_b64_tr_b16 a[130:131], v11 offset:17568
    v_mfma_f32_16x16x32_bf16 v[188:191], a[52:55], a[12:15], v[188:191]
    ds_read_b64_tr_b16 a[132:133], v11 offset:18592
    v_mfma_f32_16x16x32_bf16 v[184:187], a[52:55], a[8:11], v[184:187]
    v_mfma_f32_16x16x32_bf16 v[180:183], a[52:55], a[4:7], v[180:183]
    ds_read_b64_tr_b16 a[134:135], v11 offset:19616
    v_mfma_f32_16x16x32_bf16 v[176:179], a[52:55], a[0:3], v[176:179]
    ds_read_b64_tr_b16 a[136:137], v11 offset:16576
    v_mfma_f32_16x16x32_bf16 v[192:195], a[56:59], a[0:3], v[192:195]
    buffer_load_dwordx4 v6, s[24:27], s81 offen offset:1024 lds
    v_mfma_f32_16x16x32_bf16 v[196:199], a[56:59], a[4:7], v[196:199]
    ds_read_b64_tr_b16 a[138:139], v11 offset:17600
    v_mfma_f32_16x16x32_bf16 v[200:203], a[56:59], a[8:11], v[200:203]
    ds_read_b64_tr_b16 a[140:141], v11 offset:18624
    v_mfma_f32_16x16x32_bf16 v[204:207], a[56:59], a[12:15], v[204:207]
    s_add_u32 m0, s38, 69632
    v_mfma_f32_16x16x32_bf16 v[220:223], a[60:63], a[12:15], v[220:223]
    ds_read_b64_tr_b16 a[142:143], v11 offset:19648
    v_mfma_f32_16x16x32_bf16 v[216:219], a[60:63], a[8:11], v[216:219]
    buffer_load_dwordx4 v24, s[16:19], s80 offen offset:0 lds
    v_mfma_f32_16x16x32_bf16 v[212:215], a[60:63], a[4:7], v[212:215]
    v_mfma_f32_16x16x32_bf16 v[208:211], a[60:63], a[0:3], v[208:211]
    buffer_load_dwordx4 v25, s[16:19], s80 offen offset:1024 lds
    v_mfma_f32_16x16x32_bf16 v[224:227], a[64:67], a[0:3], v[224:227]
    buffer_load_dwordx4 v26, s[16:19], s80 offen offset:2048 lds
    v_mfma_f32_16x16x32_bf16 v[228:231], a[64:67], a[4:7], v[228:231]
    v_mfma_f32_16x16x32_bf16 v[232:235], a[64:67], a[8:11], v[232:235]
    buffer_load_dwordx4 v27, s[16:19], s80 offen offset:3072 lds
    v_mfma_f32_16x16x32_bf16 v[236:239], a[64:67], a[12:15], v[236:239]
    v_mfma_f32_16x16x32_bf16 v[252:255], a[68:71], a[12:15], v[252:255]
    v_mfma_f32_16x16x32_bf16 v[248:251], a[68:71], a[8:11], v[248:251]
    v_mfma_f32_16x16x32_bf16 v[244:247], a[68:71], a[4:7], v[244:247]
    v_mfma_f32_16x16x32_bf16 v[240:243], a[68:71], a[0:3], v[240:243]
    s_waitcnt vmcnt(16) lgkmcnt(0)
    s_barrier
    v_mfma_f32_16x16x32_bf16 v[32:35], a[88:91], a[72:75], v[32:35]
    ds_read_b128 a[0:3], v7 offset:32768
    v_mfma_f32_16x16x32_bf16 v[36:39], a[88:91], a[76:79], v[36:39]
    ds_read_b128 a[4:7], v7 offset:34816
    v_mfma_f32_16x16x32_bf16 v[40:43], a[88:91], a[80:83], v[40:43]
    ds_read_b128 a[8:11], v7 offset:36864
    v_mfma_f32_16x16x32_bf16 v[44:47], a[88:91], a[84:87], v[44:47]
    s_add_u32 s81, s81, 229376
    v_mfma_f32_16x16x32_bf16 v[60:63], a[92:95], a[84:87], v[60:63]
    ds_read_b128 a[12:15], v7 offset:38912
    v_mfma_f32_16x16x32_bf16 v[56:59], a[92:95], a[80:83], v[56:59]
    ds_read_b64_tr_b16 a[16:17], v11 offset:32768
    v_mfma_f32_16x16x32_bf16 v[52:55], a[92:95], a[76:79], v[52:55]
    s_add_u32 m0, s39, 16384
    v_mfma_f32_16x16x32_bf16 v[48:51], a[92:95], a[72:75], v[48:51]
    ds_read_b64_tr_b16 a[18:19], v11 offset:33792
    v_mfma_f32_16x16x32_bf16 v[64:67], a[96:99], a[72:75], v[64:67]
    ds_read_b64_tr_b16 a[20:21], v11 offset:34816
    v_mfma_f32_16x16x32_bf16 v[68:71], a[96:99], a[76:79], v[68:71]
    ds_read_b64_tr_b16 a[22:23], v11 offset:35840
    v_mfma_f32_16x16x32_bf16 v[72:75], a[96:99], a[80:83], v[72:75]
    buffer_load_dwordx4 v5, s[20:23], s81 offen offset:0 lds
    v_mfma_f32_16x16x32_bf16 v[76:79], a[96:99], a[84:87], v[76:79]
    ds_read_b64_tr_b16 a[24:25], v11 offset:32800
    v_mfma_f32_16x16x32_bf16 v[92:95], a[100:103], a[84:87], v[92:95]
    ds_read_b64_tr_b16 a[26:27], v11 offset:33824
    v_mfma_f32_16x16x32_bf16 v[88:91], a[100:103], a[80:83], v[88:91]
    buffer_load_dwordx4 v6, s[20:23], s81 offen offset:1024 lds
    v_mfma_f32_16x16x32_bf16 v[84:87], a[100:103], a[76:79], v[84:87]
    ds_read_b64_tr_b16 a[28:29], v11 offset:34848
    v_mfma_f32_16x16x32_bf16 v[80:83], a[100:103], a[72:75], v[80:83]
    ds_read_b64_tr_b16 a[30:31], v11 offset:35872
    v_mfma_f32_16x16x32_bf16 v[96:99], a[104:107], a[72:75], v[96:99]
    v_mfma_f32_16x16x32_bf16 v[100:103], a[104:107], a[76:79], v[100:103]
    ds_read_b64_tr_b16 a[32:33], v11 offset:32832
    v_mfma_f32_16x16x32_bf16 v[104:107], a[104:107], a[80:83], v[104:107]
    ds_read_b64_tr_b16 a[34:35], v11 offset:33856
    v_mfma_f32_16x16x32_bf16 v[108:111], a[104:107], a[84:87], v[108:111]
    ds_read_b64_tr_b16 a[36:37], v11 offset:34880
    v_mfma_f32_16x16x32_bf16 v[124:127], a[108:111], a[84:87], v[124:127]
    s_add_u32 m0, s39, 18432
    v_mfma_f32_16x16x32_bf16 v[120:123], a[108:111], a[80:83], v[120:123]
    ds_read_b64_tr_b16 a[38:39], v11 offset:35904
    v_mfma_f32_16x16x32_bf16 v[116:119], a[108:111], a[76:79], v[116:119]
    ds_read_b64_tr_b16 a[40:41], v11 offset:32864
    v_mfma_f32_16x16x32_bf16 v[112:115], a[108:111], a[72:75], v[112:115]
    buffer_load_dwordx4 v5, s[24:27], s81 offen offset:0 lds
    v_mfma_f32_16x16x32_bf16 v[128:131], a[112:115], a[72:75], v[128:131]
    ds_read_b64_tr_b16 a[42:43], v11 offset:33888
    v_mfma_f32_16x16x32_bf16 v[132:135], a[112:115], a[76:79], v[132:135]
    ds_read_b64_tr_b16 a[44:45], v11 offset:34912
    v_mfma_f32_16x16x32_bf16 v[136:139], a[112:115], a[80:83], v[136:139]
    ds_read_b64_tr_b16 a[46:47], v11 offset:35936
    v_mfma_f32_16x16x32_bf16 v[140:143], a[112:115], a[84:87], v[140:143]
    buffer_load_dwordx4 v6, s[24:27], s81 offen offset:1024 lds
    v_mfma_f32_16x16x32_bf16 v[156:159], a[116:119], a[84:87], v[156:159]
    ds_read_b64_tr_b16 a[48:49], v11 offset:32896
    v_mfma_f32_16x16x32_bf16 v[152:155], a[116:119], a[80:83], v[152:155]
    ds_read_b64_tr_b16 a[50:51], v11 offset:33920
    v_mfma_f32_16x16x32_bf16 v[148:151], a[116:119], a[76:79], v[148:151]
    v_mfma_f32_16x16x32_bf16 v[144:147], a[116:119], a[72:75], v[144:147]
    ds_read_b64_tr_b16 a[52:53], v11 offset:34944
    v_mfma_f32_16x16x32_bf16 v[160:163], a[120:123], a[72:75], v[160:163]
    ds_read_b64_tr_b16 a[54:55], v11 offset:35968
    v_mfma_f32_16x16x32_bf16 v[164:167], a[120:123], a[76:79], v[164:167]
    s_bfe_u32 s80, s61, 262148
    v_mfma_f32_16x16x32_bf16 v[168:171], a[120:123], a[80:83], v[168:171]
    ds_read_b64_tr_b16 a[56:57], v11 offset:32928
    v_mfma_f32_16x16x32_bf16 v[172:175], a[120:123], a[84:87], v[172:175]
    ds_read_b64_tr_b16 a[58:59], v11 offset:33952
    v_mfma_f32_16x16x32_bf16 v[188:191], a[124:127], a[84:87], v[188:191]
    ds_read_b64_tr_b16 a[60:61], v11 offset:34976
    v_mfma_f32_16x16x32_bf16 v[184:187], a[124:127], a[80:83], v[184:187]
    s_lshl_b32 s80, s80, 7
    v_mfma_f32_16x16x32_bf16 v[180:183], a[124:127], a[76:79], v[180:183]
    ds_read_b64_tr_b16 a[62:63], v11 offset:36000
    v_mfma_f32_16x16x32_bf16 v[176:179], a[124:127], a[72:75], v[176:179]
    ds_read_b64_tr_b16 a[64:65], v11 offset:32960
    v_mfma_f32_16x16x32_bf16 v[192:195], a[128:131], a[72:75], v[192:195]
    s_add_u32 s80, s80, s35
    v_mfma_f32_16x16x32_bf16 v[196:199], a[128:131], a[76:79], v[196:199]
    ds_read_b64_tr_b16 a[66:67], v11 offset:33984
    v_mfma_f32_16x16x32_bf16 v[200:203], a[128:131], a[80:83], v[200:203]
    ds_read_b64_tr_b16 a[68:69], v11 offset:35008
    v_mfma_f32_16x16x32_bf16 v[204:207], a[128:131], a[84:87], v[204:207]
    s_add_u32 m0, s38, 0
    v_mfma_f32_16x16x32_bf16 v[220:223], a[132:135], a[84:87], v[220:223]
    ds_read_b64_tr_b16 a[70:71], v11 offset:36032
    v_mfma_f32_16x16x32_bf16 v[216:219], a[132:135], a[80:83], v[216:219]
    v_mfma_f32_16x16x32_bf16 v[212:215], a[132:135], a[76:79], v[212:215]
    buffer_load_dwordx4 v1, s[16:19], s80 offen offset:0 lds
    v_mfma_f32_16x16x32_bf16 v[208:211], a[132:135], a[72:75], v[208:211]
    buffer_load_dwordx4 v2, s[16:19], s80 offen offset:1024 lds
    v_mfma_f32_16x16x32_bf16 v[224:227], a[136:139], a[72:75], v[224:227]
    buffer_load_dwordx4 v3, s[16:19], s80 offen offset:2048 lds
    v_mfma_f32_16x16x32_bf16 v[228:231], a[136:139], a[76:79], v[228:231]
    v_mfma_f32_16x16x32_bf16 v[232:235], a[136:139], a[80:83], v[232:235]
    buffer_load_dwordx4 v4, s[16:19], s80 offen offset:3072 lds
    v_mfma_f32_16x16x32_bf16 v[236:239], a[136:139], a[84:87], v[236:239]
    v_mfma_f32_16x16x32_bf16 v[252:255], a[140:143], a[84:87], v[252:255]
    s_cmp_lg_u32 s56, 0
    s_cbranch_scc1 k_pf0
    buffer_load_dword a255, v28, s[52:55], s58 offen
    s_add_u32 s58, s58, 7168
    buffer_load_dword a255, v28, s[52:55], s58 offen
k_pf0:
    v_mfma_f32_16x16x32_bf16 v[248:251], a[140:143], a[80:83], v[248:251]
    v_mfma_f32_16x16x32_bf16 v[244:247], a[140:143], a[76:79], v[244:247]
    v_mfma_f32_16x16x32_bf16 v[240:243], a[140:143], a[72:75], v[240:243]
    s_waitcnt vmcnt(20) lgkmcnt(0)
    s_barrier
    v_mfma_f32_16x16x32_bf16 v[32:35], a[16:19], a[0:3], v[32:35]
    ds_read_b128 a[72:75], v9 offset:32768
    v_mfma_f32_16x16x32_bf16 v[36:39], a[16:19], a[4:7], v[36:39]
    ds_read_b128 a[76:79], v9 offset:34816
    v_mfma_f32_16x16x32_bf16 v[40:43], a[16:19], a[8:11], v[40:43]
    ds_read_b128 a[80:83], v9 offset:36864
    v_mfma_f32_16x16x32_bf16 v[44:47], a[16:19], a[12:15], v[44:47]
    s_bfe_u32 s81, s61, 262148
    v_mfma_f32_16x16x32_bf16 v[60:63], a[20:23], a[12:15], v[60:63]
    ds_read_b128 a[84:87], v9 offset:38912
    v_mfma_f32_16x16x32_bf16 v[56:59], a[20:23], a[8:11], v[56:59]
    ds_read_b64_tr_b16 a[88:89], v11 offset:49152
    v_mfma_f32_16x16x32_bf16 v[52:55], a[20:23], a[4:7], v[52:55]
    s_mul_i32 s81, s81, 458752
    v_mfma_f32_16x16x32_bf16 v[48:51], a[20:23], a[0:3], v[48:51]
    ds_read_b64_tr_b16 a[90:91], v11 offset:50176
    v_mfma_f32_16x16x32_bf16 v[64:67], a[24:27], a[0:3], v[64:67]
    ds_read_b64_tr_b16 a[92:93], v11 offset:51200
    v_mfma_f32_16x16x32_bf16 v[68:71], a[24:27], a[4:7], v[68:71]
    ds_read_b64_tr_b16 a[94:95], v11 offset:52224
    v_mfma_f32_16x16x32_bf16 v[72:75], a[24:27], a[8:11], v[72:75]
    s_add_u32 s81, s81, s37
    v_mfma_f32_16x16x32_bf16 v[76:79], a[24:27], a[12:15], v[76:79]
    ds_read_b64_tr_b16 a[96:97], v11 offset:49184
    v_mfma_f32_16x16x32_bf16 v[92:95], a[28:31], a[12:15], v[92:95]
    ds_read_b64_tr_b16 a[98:99], v11 offset:50208
    v_mfma_f32_16x16x32_bf16 v[88:91], a[28:31], a[8:11], v[88:91]
    v_mfma_f32_16x16x32_bf16 v[84:87], a[28:31], a[4:7], v[84:87]
    ds_read_b64_tr_b16 a[100:101], v11 offset:51232
    v_mfma_f32_16x16x32_bf16 v[80:83], a[28:31], a[0:3], v[80:83]
    ds_read_b64_tr_b16 a[102:103], v11 offset:52256
    v_mfma_f32_16x16x32_bf16 v[96:99], a[32:35], a[0:3], v[96:99]
    s_add_u32 m0, s39, 32768
    v_mfma_f32_16x16x32_bf16 v[100:103], a[32:35], a[4:7], v[100:103]
    ds_read_b64_tr_b16 a[104:105], v11 offset:49216
    v_mfma_f32_16x16x32_bf16 v[104:107], a[32:35], a[8:11], v[104:107]
    ds_read_b64_tr_b16 a[106:107], v11 offset:50240
    v_mfma_f32_16x16x32_bf16 v[108:111], a[32:35], a[12:15], v[108:111]
    ds_read_b64_tr_b16 a[108:109], v11 offset:51264
    v_mfma_f32_16x16x32_bf16 v[124:127], a[36:39], a[12:15], v[124:127]
    buffer_load_dwordx4 v5, s[20:23], s81 offen offset:0 lds
    v_mfma_f32_16x16x32_bf16 v[120:123], a[36:39], a[8:11], v[120:123]
    ds_read_b64_tr_b16 a[110:111], v11 offset:52288
    v_mfma_f32_16x16x32_bf16 v[116:119], a[36:39], a[4:7], v[116:119]
    ds_read_b64_tr_b16 a[112:113], v11 offset:49248
    v_mfma_f32_16x16x32_bf16 v[112:115], a[36:39], a[0:3], v[112:115]
    buffer_load_dwordx4 v6, s[20:23], s81 offen offset:1024 lds
    v_mfma_f32_16x16x32_bf16 v[128:131], a[40:43], a[0:3], v[128:131]
    ds_read_b64_tr_b16 a[114:115], v11 offset:50272
    v_mfma_f32_16x16x32_bf16 v[132:135], a[40:43], a[4:7], v[132:135]
    ds_read_b64_tr_b16 a[116:117], v11 offset:51296
    v_mfma_f32_16x16x32_bf16 v[136:139], a[40:43], a[8:11], v[136:139]
    ds_read_b64_tr_b16 a[118:119], v11 offset:52320
    v_mfma_f32_16x16x32_bf16 v[140:143], a[40:43], a[12:15], v[140:143]
    v_mfma_f32_16x16x32_bf16 v[156:159], a[44:47], a[12:15], v[156:159]
    ds_read_b64_tr_b16 a[120:121], v11 offset:49280
    v_mfma_f32_16x16x32_bf16 v[152:155], a[44:47], a[8:11], v[152:155]
    ds_read_b64_tr_b16 a[122:123], v11 offset:50304
    v_mfma_f32_16x16x32_bf16 v[148:151], a[44:47], a[4:7], v[148:151]
    s_add_u32 m0, s39, 34816
    v_mfma_f32_16x16x32_bf16 v[144:147], a[44:47], a[0:3], v[144:147]
    ds_read_b64_tr_b16 a[124:125], v11 offset:51328
    v_mfma_f32_16x16x32_bf16 v[160:163], a[48:51], a[0:3], v[160:163]
    ds_read_b64_tr_b16 a[126:127], v11 offset:52352
    v_mfma_f32_16x16x32_bf16 v[164:167], a[48:51], a[4:7], v[164:167]
    buffer_load_dwordx4 v5, s[24:27], s81 offen offset:0 lds
    v_mfma_f32_16x16x32_bf16 v[168:171], a[48:51], a[8:11], v[168:171]
    ds_read_b64_tr_b16 a[128:129], v11 offset:49312
    v_mfma_f32_16x16x32_bf16 v[172:175], a[48:51], a[12:15], v[172:175]
    ds_read_b64_tr_b16 a[130:131], v11 offset:50336
    v_mfma_f32_16x16x32_bf16 v[188:191], a[52:55], a[12:15], v[188:191]
    ds_read_b64_tr_b16 a[132:133], v11 offset:51360
    v_mfma_f32_16x16x32_bf16 v[184:187], a[52:55], a[8:11], v[184:187]
    v_mfma_f32_16x16x32_bf16 v[180:183], a[52:55], a[4:7], v[180:183]
    ds_read_b64_tr_b16 a[134:135], v11 offset:52384
    v_mfma_f32_16x16x32_bf16 v[176:179], a[52:55], a[0:3], v[176:179]
    ds_read_b64_tr_b16 a[136:137], v11 offset:49344
    v_mfma_f32_16x16x32_bf16 v[192:195], a[56:59], a[0:3], v[192:195]
    buffer_load_dwordx4 v6, s[24:27], s81 offen offset:1024 lds
    v_mfma_f32_16x16x32_bf16 v[196:199], a[56:59], a[4:7], v[196:199]
    ds_read_b64_tr_b16 a[138:139], v11 offset:50368
    v_mfma_f32_16x16x32_bf16 v[200:203], a[56:59], a[8:11], v[200:203]
    ds_read_b64_tr_b16 a[140:141], v11 offset:51392
    v_mfma_f32_16x16x32_bf16 v[204:207], a[56:59], a[12:15], v[204:207]
    s_add_u32 m0, s38, 4096
    v_mfma_f32_16x16x32_bf16 v[220:223], a[60:63], a[12:15], v[220:223]
    ds_read_b64_tr_b16 a[142:143], v11 offset:52416
    v_mfma_f32_16x16x32_bf16 v[216:219], a[60:63], a[8:11], v[216:219]
    buffer_load_dwordx4 v24, s[16:19], s80 offen offset:0 lds
    v_mfma_f32_16x16x32_bf16 v[212:215], a[60:63], a[4:7], v[212:215]
    v_mfma_f32_16x16x32_bf16 v[208:211], a[60:63], a[0:3], v[208:211]
    buffer_load_dwordx4 v25, s[16:19], s80 offen offset:1024 lds
    v_mfma_f32_16x16x32_bf16 v[224:227], a[64:67], a[0:3], v[224:227]
    buffer_load_dwordx4 v26, s[16:19], s80 offen offset:2048 lds
    v_mfma_f32_16x16x32_bf16 v[228:231], a[64:67], a[4:7], v[228:231]
    v_mfma_f32_16x16x32_bf16 v[232:235], a[64:67], a[8:11], v[232:235]
    buffer_load_dwordx4 v27, s[16:19], s80 offen offset:3072 lds
    v_mfma_f32_16x16x32_bf16 v[236:239], a[64:67], a[12:15], v[236:239]
    v_mfma_f32_16x16x32_bf16 v[252:255], a[68:71], a[12:15], v[252:255]
    s_cmp_lg_u32 s56, 1
    s_cbranch_scc1 k_pf1
    buffer_load_dword a255, v28, s[52:55], s58 offen
    s_add_u32 s58, s58, 7168
    buffer_load_dword a255, v28, s[52:55], s58 offen
k_pf1:
    v_mfma_f32_16x16x32_bf16 v[248:251], a[68:71], a[8:11], v[248:251]
    v_mfma_f32_16x16x32_bf16 v[244:247], a[68:71], a[4:7], v[244:247]
    v_mfma_f32_16x16x32_bf16 v[240:243], a[68:71], a[0:3], v[240:243]
    s_waitcnt vmcnt(16) lgkmcnt(0)
    s_barrier
    v_mfma_f32_16x16x32_bf16 v[32:35], a[88:91], a[72:75], v[32:35]
    ds_read_b128 a[0:3], v8 offset:0
    v_mfma_f32_16x16x32_bf16 v[36:39], a[88:91], a[76:79], v[36:39]
    ds_read_b128 a[4:7], v8 offset:2048
    v_mfma_f32_16x16x32_bf16 v[40:43], a[88:91], a[80:83], v[40:43]
    ds_read_b128 a[8:11], v8 offset:4096
    v_mfma_f32_16x16x32_bf16 v[44:47], a[88:91], a[84:87], v[44:47]
    s_add_u32 s81, s81, 229376
    v_mfma_f32_16x16x32_bf16 v[60:63], a[92:95], a[84:87], v[60:63]
    ds_read_b128 a[12:15], v8 offset:6144
    v_mfma_f32_16x16x32_bf16 v[56:59], a[92:95], a[80:83], v[56:59]
    ds_read_b64_tr_b16 a[16:17], v11 offset:0
    v_mfma_f32_16x16x32_bf16 v[52:55], a[92:95], a[76:79], v[52:55]
    s_add_u32 m0, s39, 49152
    v_mfma_f32_16x16x32_bf16 v[48:51], a[92:95], a[72:75], v[48:51]
    ds_read_b64_tr_b16 a[18:19], v11 offset:1024
    v_mfma_f32_16x16x32_bf16 v[64:67], a[96:99], a[72:75], v[64:67]
    ds_read_b64_tr_b16 a[20:21], v11 offset:2048
    v_mfma_f32_16x16x32_bf16 v[68:71], a[96:99], a[76:79], v[68:71]
    ds_read_b64_tr_b16 a[22:23], v11 offset:3072
    v_mfma_f32_16x16x32_bf16 v[72:75], a[96:99], a[80:83], v[72:75]
    buffer_load_dwordx4 v5, s[20:23], s81 offen offset:0 lds
    v_mfma_f32_16x16x32_bf16 v[76:79], a[96:99], a[84:87], v[76:79]
    ds_read_b64_tr_b16 a[24:25], v11 offset:32
    v_mfma_f32_16x16x32_bf16 v[92:95], a[100:103], a[84:87], v[92:95]
    ds_read_b64_tr_b16 a[26:27], v11 offset:1056
    v_mfma_f32_16x16x32_bf16 v[88:91], a[100:103], a[80:83], v[88:91]
    buffer_load_dwordx4 v6, s[20:23], s81 offen offset:1024 lds
    v_mfma_f32_16x16x32_bf16 v[84:87], a[100:103], a[76:79], v[84:87]
    ds_read_b64_tr_b16 a[28:29], v11 offset:2080
    v_mfma_f32_16x16x32_bf16 v[80:83], a[100:103], a[72:75], v[80:83]
    ds_read_b64_tr_b16 a[30:31], v11 offset:3104
    v_mfma_f32_16x16x32_bf16 v[96:99], a[104:107], a[72:75], v[96:99]
    v_mfma_f32_16x16x32_bf16 v[100:103], a[104:107], a[76:79], v[100:103]
    ds_read_b64_tr_b16 a[32:33], v11 offset:64
    v_mfma_f32_16x16x32_bf16 v[104:107], a[104:107], a[80:83], v[104:107]
    ds_read_b64_tr_b16 a[34:35], v11 offset:1088
    v_mfma_f32_16x16x32_bf16 v[108:111], a[104:107], a[84:87], v[108:111]
    ds_read_b64_tr_b16 a[36:37], v11 offset:2112
    v_mfma_f32_16x16x32_bf16 v[124:127], a[108:111], a[84:87], v[124:127]
    s_add_u32 m0, s39, 51200
    v_mfma_f32_16x16x32_bf16 v[120:123], a[108:111], a[80:83], v[120:123]
    ds_read_b64_tr_b16 a[38:39], v11 offset:3136
    v_mfma_f32_16x16x32_bf16 v[116:119], a[108:111], a[76:79], v[116:119]
    ds_read_b64_tr_b16 a[40:41], v11 offset:96
    v_mfma_f32_16x16x32_bf16 v[112:115], a[108:111], a[72:75], v[112:115]
    buffer_load_dwordx4 v5, s[24:27], s81 offen offset:0 lds
    v_mfma_f32_16x16x32_bf16 v[128:131], a[112:115], a[72:75], v[128:131]
    ds_read_b64_tr_b16 a[42:43], v11 offset:1120
    v_mfma_f32_16x16x32_bf16 v[132:135], a[112:115], a[76:79], v[132:135]
    ds_read_b64_tr_b16 a[44:45], v11 offset:2144
    v_mfma_f32_16x16x32_bf16 v[136:139], a[112:115], a[80:83], v[136:139]
    ds_read_b64_tr_b16 a[46:47], v11 offset:3168
    v_mfma_f32_16x16x32_bf16 v[140:143], a[112:115], a[84:87], v[140:143]
    buffer_load_dwordx4 v6, s[24:27], s81 offen offset:1024 lds
    v_mfma_f32_16x16x32_bf16 v[156:159], a[116:119], a[84:87], v[156:159]
    ds_read_b64_tr_b16 a[48:49], v11 offset:128
    v_mfma_f32_16x16x32_bf16 v[152:155], a[116:119], a[80:83], v[152:155]
    ds_read_b64_tr_b16 a[50:51], v11 offset:1152
    v_mfma_f32_16x16x32_bf16 v[148:151], a[116:119], a[76:79], v[148:151]
    v_mfma_f32_16x16x32_bf16 v[144:147], a[116:119], a[72:75], v[144:147]
    ds_read_b64_tr_b16 a[52:53], v11 offset:2176
    v_mfma_f32_16x16x32_bf16 v[160:163], a[120:123], a[72:75], v[160:163]
    ds_read_b64_tr_b16 a[54:55], v11 offset:3200
    v_mfma_f32_16x16x32_bf16 v[164:167], a[120:123], a[76:79], v[164:167]
    s_bfe_u32 s80, s61, 262152
    v_mfma_f32_16x16x32_bf16 v[168:171], a[120:123], a[80:83], v[168:171]
    ds_read_b64_tr_b16 a[56:57], v11 offset:160
    v_mfma_f32_16x16x32_bf16 v[172:175], a[120:123], a[84:87], v[172:175]
    ds_read_b64_tr_b16 a[58:59], v11 offset:1184
    v_mfma_f32_16x16x32_bf16 v[188:191], a[124:127], a[84:87], v[188:191]
    ds_read_b64_tr_b16 a[60:61], v11 offset:2208
    v_mfma_f32_16x16x32_bf16 v[184:187], a[124:127], a[80:83], v[184:187]
    s_lshl_b32 s80, s80, 7
    v_mfma_f32_16x16x32_bf16 v[180:183], a[124:127], a[76:79], v[180:183]
    ds_read_b64_tr_b16 a[62:63], v11 offset:3232
    v_mfma_f32_16x16x32_bf16 v[176:179], a[124:127], a[72:75], v[176:179]
    ds_read_b64_tr_b16 a[64:65], v11 offset:192
    v_mfma_f32_16x16x32_bf16 v[192:195], a[128:131], a[72:75], v[192:195]
    s_add_u32 s80, s80, s35
    v_mfma_f32_16x16x32_bf16 v[196:199], a[128:131], a[76:79], v[196:199]
    ds_read_b64_tr_b16 a[66:67], v11 offset:1216
    v_mfma_f32_16x16x32_bf16 v[200:203], a[128:131], a[80:83], v[200:203]
    ds_read_b64_tr_b16 a[68:69], v11 offset:2240
    v_mfma_f32_16x16x32_bf16 v[204:207], a[128:131], a[84:87], v[204:207]
    s_add_u32 m0, s38, 32768
    v_mfma_f32_16x16x32_bf16 v[220:223], a[132:135], a[84:87], v[220:223]
    ds_read_b64_tr_b16 a[70:71], v11 offset:3264
    v_mfma_f32_16x16x32_bf16 v[216:219], a[132:135], a[80:83], v[216:219]
    v_mfma_f32_16x16x32_bf16 v[212:215], a[132:135], a[76:79], v[212:215]
    buffer_load_dwordx4 v1, s[16:19], s80 offen offset:0 lds
    v_mfma_f32_16x16x32_bf16 v[208:211], a[132:135], a[72:75], v[208:211]
    buffer_load_dwordx4 v2, s[16:19], s80 offen offset:1024 lds
    v_mfma_f32_16x16x32_bf16 v[224:227], a[136:139], a[72:75], v[224:227]
    buffer_load_dwordx4 v3, s[16:19], s80 offen offset:2048 lds
    v_mfma_f32_16x16x32_bf16 v[228:231], a[136:139], a[76:79], v[228:231]
    v_mfma_f32_16x16x32_bf16 v[232:235], a[136:139], a[80:83], v[232:235]
    buffer_load_dwordx4 v4, s[16:19], s80 offen offset:3072 lds
    v_mfma_f32_16x16x32_bf16 v[236:239], a[136:139], a[84:87], v[236:239]
    v_mfma_f32_16x16x32_bf16 v[252:255], a[140:143], a[84:87], v[252:255]
    s_cmp_lg_u32 s56, 2
    s_cbranch_scc1 k_pf2
    buffer_load_dword a255, v28, s[52:55], s58 offen
    s_add_u32 s58, s58, 7168
    buffer_load_dword a255, v28, s[52:55], s58 offen
k_pf2:
    v_mfma_f32_16x16x32_bf16 v[248:251], a[140:143], a[80:83], v[248:251]
    v_mfma_f32_16x16x32_bf16 v[244:247], a[140:143], a[76:79], v[244:247]
    v_mfma_f32_16x16x32_bf16 v[240:243], a[140:143], a[72:75], v[240:243]
    s_waitcnt vmcnt(20) lgkmcnt(0)
    s_barrier
    v_mfma_f32_16x16x32_bf16 v[32:35], a[16:19], a[0:3], v[32:35]
    ds_read_b128 a[72:75], v10 offset:0
    v_mfma_f32_16x16x32_bf16 v[36:39], a[16:19], a[4:7], v[36:39]
    ds_read_b128 a[76:79], v10 offset:2048
    v_mfma_f32_16x16x32_bf16 v[40:43], a[16:19], a[8:11], v[40:43]
    ds_read_b128 a[80:83], v10 offset:4096
    v_mfma_f32_16x16x32_bf16 v[44:47], a[16:19], a[12:15], v[44:47]
    s_bfe_u32 s81, s61, 262152
    v_mfma_f32_16x16x32_bf16 v[60:63], a[20:23], a[12:15], v[60:63]
    ds_read_b128 a[84:87], v10 offset:6144
    v_mfma_f32_16x16x32_bf16 v[56:59], a[20:23], a[8:11], v[56:59]
    ds_read_b64_tr_b16 a[88:89], v11 offset:16384
    v_mfma_f32_16x16x32_bf16 v[52:55], a[20:23], a[4:7], v[52:55]
    s_mul_i32 s81, s81, 458752
    v_mfma_f32_16x16x32_bf16 v[48:51], a[20:23], a[0:3], v[48:51]
    ds_read_b64_tr_b16 a[90:91], v11 offset:17408
    v_mfma_f32_16x16x32_bf16 v[64:67], a[24:27], a[0:3], v[64:67]
    ds_read_b64_tr_b16 a[92:93], v11 offset:18432
    v_mfma_f32_16x16x32_bf16 v[68:71], a[24:27], a[4:7], v[68:71]
    ds_read_b64_tr_b16 a[94:95], v11 offset:19456
    v_mfma_f32_16x16x32_bf16 v[72:75], a[24:27], a[8:11], v[72:75]
    s_add_u32 s81, s81, s37
    v_mfma_f32_16x16x32_bf16 v[76:79], a[24:27], a[12:15], v[76:79]
    ds_read_b64_tr_b16 a[96:97], v11 offset:16416
    v_mfma_f32_16x16x32_bf16 v[92:95], a[28:31], a[12:15], v[92:95]
    ds_read_b64_tr_b16 a[98:99], v11 offset:17440
    v_mfma_f32_16x16x32_bf16 v[88:91], a[28:31], a[8:11], v[88:91]
    v_mfma_f32_16x16x32_bf16 v[84:87], a[28:31], a[4:7], v[84:87]
    ds_read_b64_tr_b16 a[100:101], v11 offset:18464
    v_mfma_f32_16x16x32_bf16 v[80:83], a[28:31], a[0:3], v[80:83]
    ds_read_b64_tr_b16 a[102:103], v11 offset:19488
    v_mfma_f32_16x16x32_bf16 v[96:99], a[32:35], a[0:3], v[96:99]
    s_add_u32 m0, s39, 0
    v_mfma_f32_16x16x32_bf16 v[100:103], a[32:35], a[4:7], v[100:103]
    ds_read_b64_tr_b16 a[104:105], v11 offset:16448
    v_mfma_f32_16x16x32_bf16 v[104:107], a[32:35], a[8:11], v[104:107]
    ds_read_b64_tr_b16 a[106:107], v11 offset:17472
    v_mfma_f32_16x16x32_bf16 v[108:111], a[32:35], a[12:15], v[108:111]
    ds_read_b64_tr_b16 a[108:109], v11 offset:18496
    v_mfma_f32_16x16x32_bf16 v[124:127], a[36:39], a[12:15], v[124:127]
    buffer_load_dwordx4 v5, s[20:23], s81 offen offset:0 lds
    v_mfma_f32_16x16x32_bf16 v[120:123], a[36:39], a[8:11], v[120:123]
    ds_read_b64_tr_b16 a[110:111], v11 offset:19520
    v_mfma_f32_16x16x32_bf16 v[116:119], a[36:39], a[4:7], v[116:119]
    ds_read_b64_tr_b16 a[112:113], v11 offset:16480
    v_mfma_f32_16x16x32_bf16 v[112:115], a[36:39], a[0:3], v[112:115]
    buffer_load_dwordx4 v6, s[20:23], s81 offen offset:1024 lds
    v_mfma_f32_16x16x32_bf16 v[128:131], a[40:43], a[0:3], v[128:131]
    ds_read_b64_tr_b16 a[114:115], v11 offset:17504
    v_mfma_f32_16x16x32_bf16 v[132:135], a[40:43], a[4:7], v[132:135]
    ds_read_b64_tr_b16 a[116:117], v11 offset:18528
    v_mfma_f32_16x16x32_bf16 v[136:139], a[40:43], a[8:11], v[136:139]
    ds_read_b64_tr_b16 a[118:119], v11 offset:19552
    v_mfma_f32_16x16x32_bf16 v[140:143], a[40:43], a[12:15], v[140:143]
    v_mfma_f32_16x16x32_bf16 v[156:159], a[44:47], a[12:15], v[156:159]
    ds_read_b64_tr_b16 a[120:121], v11 offset:16512
    v_mfma_f32_16x16x32_bf16 v[152:155], a[44:47], a[8:11], v[152:155]
    ds_read_b64_tr_b16 a[122:123], v11 offset:17536
    v_mfma_f32_16x16x32_bf16 v[148:151], a[44:47], a[4:7], v[148:151]
    s_add_u32 m0, s39, 2048
    v_mfma_f32_16x16x32_bf16 v[144:147], a[44:47], a[0:3], v[144:147]
    ds_read_b64_tr_b16 a[124:125], v11 offset:18560
    v_mfma_f32_16x16x32_bf16 v[160:163], a[48:51], a[0:3], v[160:163]
    ds_read_b64_tr_b16 a[126:127], v11 offset:19584
    v_mfma_f32_16x16x32_bf16 v[164:167], a[48:51], a[4:7], v[164:167]
    buffer_load_dwordx4 v5, s[24:27], s81 offen offset:0 lds
    v_mfma_f32_16x16x32_bf16 v[168:171], a[48:51], a[8:11], v[168:171]
    ds_read_b64_tr_b16 a[128:129], v11 offset:16544
    v_mfma_f32_16x16x32_bf16 v[172:175], a[48:51], a[12:15], v[172:175]
    ds_read_b64_tr_b16 a[130:131], v11 offset:17568
    v_mfma_f32_16x16x32_bf16 v[188:191], a[52:55], a[12:15], v[188:191]
    ds_read_b64_tr_b16 a[132:133], v11 offset:18592
    v_mfma_f32_16x16x32_bf16 v[184:187], a[52:55], a[8:11], v[184:187]
    v_mfma_f32_16x16x32_bf16 v[180:183], a[52:55], a[4:7], v[180:183]
    ds_read_b64_tr_b16 a[134:135], v11 offset:19616
    v_mfma_f32_16x16x32_bf16 v[176:179], a[52:55], a[0:3], v[176:179]
    ds_read_b64_tr_b16 a[136:137], v11 offset:16576
    v_mfma_f32_16x16x32_bf16 v[192:195], a[56:59], a[0:3], v[192:195]
    buffer_load_dwordx4 v6, s[24:27], s81 offen offset:1024 lds
    v_mfma_f32_16x16x32_bf16 v[196:199], a[56:59], a[4:7], v[196:199]
    ds_read_b64_tr_b16 a[138:139], v11 offset:17600
    v_mfma_f32_16x16x32_bf16 v[200:203], a[56:59], a[8:11], v[200:203]
    ds_read_b64_tr_b16 a[140:141], v11 offset:18624
    v_mfma_f32_16x16x32_bf16 v[204:207], a[56:59], a[12:15], v[204:207]
    s_add_u32 m0, s38, 36864
    v_mfma_f32_16x16x32_bf16 v[220:223], a[60:63], a[12:15], v[220:223]
    ds_read_b64_tr_b16 a[142:143], v11 offset:19648
    v_mfma_f32_16x16x32_bf16 v[216:219], a[60:63], a[8:11], v[216:219]
    buffer_load_dwordx4 v24, s[16:19], s80 offen offset:0 lds
    v_mfma_f32_16x16x32_bf16 v[212:215], a[60:63], a[4:7], v[212:215]
    v_mfma_f32_16x16x32_bf16 v[208:211], a[60:63], a[0:3], v[208:211]
    buffer_load_dwordx4 v25, s[16:19], s80 offen offset:1024 lds
    v_mfma_f32_16x16x32_bf16 v[224:227], a[64:67], a[0:3], v[224:227]
    buffer_load_dwordx4 v26, s[16:19], s80 offen offset:2048 lds
    v_mfma_f32_16x16x32_bf16 v[228:231], a[64:67], a[4:7], v[228:231]
    v_mfma_f32_16x16x32_bf16 v[232:235], a[64:67], a[8:11], v[232:235]
    buffer_load_dwordx4 v27, s[16:19], s80 offen offset:3072 lds
    v_mfma_f32_16x16x32_bf16 v[236:239], a[64:67], a[12:15], v[236:239]
    v_mfma_f32_16x16x32_bf16 v[252:255], a[68:71], a[12:15], v[252:255]
    s_cmp_lg_u32 s56, 3
    s_cbranch_scc1 k_pf3
    buffer_load_dword a255, v28, s[52:55], s58 offen
    s_add_u32 s58, s58, 7168
    buffer_load_dword a255, v28, s[52:55], s58 offen
k_pf3:
    v_mfma_f32_16x16x32_bf16 v[248:251], a[68:71], a[8:11], v[248:251]
    v_mfma_f32_16x16x32_bf16 v[244:247], a[68:71], a[4:7], v[244:247]
    v_mfma_f32_16x16x32_bf16 v[240:243], a[68:71], a[0:3], v[240:243]
    s_waitcnt vmcnt(16) lgkmcnt(0)
    s_barrier
    v_mfma_f32_16x16x32_bf16 v[32:35], a[88:91], a[72:75], v[32:35]
    ds_read_b128 a[0:3], v7 offset:0
    v_mfma_f32_16x16x32_bf16 v[36:39], a[88:91], a[76:79], v[36:39]
    ds_read_b128 a[4:7], v7 offset:2048
    v_mfma_f32_16x16x32_bf16 v[40:43], a[88:91], a[80:83], v[40:43]
    ds_read_b128 a[8:11], v7 offset:4096
    v_mfma_f32_16x16x32_bf16 v[44:47], a[88:91], a[84:87], v[44:47]
    s_add_u32 s81, s81, 229376
    v_mfma_f32_16x16x32_bf16 v[60:63], a[92:95], a[84:87], v[60:63]
    ds_read_b128 a[12:15], v7 offset:6144
    v_mfma_f32_16x16x32_bf16 v[56:59], a[92:95], a[80:83], v[56:59]
    ds_read_b64_tr_b16 a[16:17], v11 offset:32768
    v_mfma_f32_16x16x32_bf16 v[52:55], a[92:95], a[76:79], v[52:55]
    s_add_u32 m0, s39, 16384
    v_mfma_f32_16x16x32_bf16 v[48:51], a[92:95], a[72:75], v[48:51]
    ds_read_b64_tr_b16 a[18:19], v11 offset:33792
    v_mfma_f32_16x16x32_bf16 v[64:67], a[96:99], a[72:75], v[64:67]
    ds_read_b64_tr_b16 a[20:21], v11 offset:34816
    v_mfma_f32_16x16x32_bf16 v[68:71], a[96:99], a[76:79], v[68:71]
    ds_read_b64_tr_b16 a[22:23], v11 offset:35840
    v_mfma_f32_16x16x32_bf16 v[72:75], a[96:99], a[80:83], v[72:75]
    buffer_load_dwordx4 v5, s[20:23], s81 offen offset:0 lds
    v_mfma_f32_16x16x32_bf16 v[76:79], a[96:99], a[84:87], v[76:79]
    ds_read_b64_tr_b16 a[24:25], v11 offset:32800
    v_mfma_f32_16x16x32_bf16 v[92:95], a[100:103], a[84:87], v[92:95]
    ds_read_b64_tr_b16 a[26:27], v11 offset:33824
    v_mfma_f32_16x16x32_bf16 v[88:91], a[100:103], a[80:83], v[88:91]
    buffer_load_dwordx4 v6, s[20:23], s81 offen offset:1024 lds
    v_mfma_f32_16x16x32_bf16 v[84:87], a[100:103], a[76:79], v[84:87]
    ds_read_b64_tr_b16 a[28:29], v11 offset:34848
    v_mfma_f32_16x16x32_bf16 v[80:83], a[100:103], a[72:75], v[80:83]
    ds_read_b64_tr_b16 a[30:31], v11 offset:35872
    v_mfma_f32_16x16x32_bf16 v[96:99], a[104:107], a[72:75], v[96:99]
    v_mfma_f32_16x16x32_bf16 v[100:103], a[104:107], a[76:79], v[100:103]
    ds_read_b64_tr_b16 a[32:33], v11 offset:32832
    v_mfma_f32_16x16x32_bf16 v[104:107], a[104:107], a[80:83], v[104:107]
    ds_read_b64_tr_b16 a[34:35], v11 offset:33856
    v_mfma_f32_16x16x32_bf16 v[108:111], a[104:107], a[84:87], v[108:111]
    ds_read_b64_tr_b16 a[36:37], v11 offset:34880
    v_mfma_f32_16x16x32_bf16 v[124:127], a[108:111], a[84:87], v[124:127]
    s_add_u32 m0, s39, 18432
    v_mfma_f32_16x16x32_bf16 v[120:123], a[108:111], a[80:83], v[120:123]
    ds_read_b64_tr_b16 a[38:39], v11 offset:35904
    v_mfma_f32_16x16x32_bf16 v[116:119], a[108:111], a[76:79], v[116:119]
    ds_read_b64_tr_b16 a[40:41], v11 offset:32864
    v_mfma_f32_16x16x32_bf16 v[112:115], a[108:111], a[72:75], v[112:115]
    buffer_load_dwordx4 v5, s[24:27], s81 offen offset:0 lds
    v_mfma_f32_16x16x32_bf16 v[128:131], a[112:115], a[72:75], v[128:131]
    ds_read_b64_tr_b16 a[42:43], v11 offset:33888
    v_mfma_f32_16x16x32_bf16 v[132:135], a[112:115], a[76:79], v[132:135]
    ds_read_b64_tr_b16 a[44:45], v11 offset:34912
    v_mfma_f32_16x16x32_bf16 v[136:139], a[112:115], a[80:83], v[136:139]
    ds_read_b64_tr_b16 a[46:47], v11 offset:35936
    v_mfma_f32_16x16x32_bf16 v[140:143], a[112:115], a[84:87], v[140:143]
    buffer_load_dwordx4 v6, s[24:27], s81 offen offset:1024 lds
    v_mfma_f32_16x16x32_bf16 v[156:159], a[116:119], a[84:87], v[156:159]
    ds_read_b64_tr_b16 a[48:49], v11 offset:32896
    v_mfma_f32_16x16x32_bf16 v[152:155], a[116:119], a[80:83], v[152:155]
    ds_read_b64_tr_b16 a[50:51], v11 offset:33920
    v_mfma_f32_16x16x32_bf16 v[148:151], a[116:119], a[76:79], v[148:151]
    v_mfma_f32_16x16x32_bf16 v[144:147], a[116:119], a[72:75], v[144:147]
    ds_read_b64_tr_b16 a[52:53], v11 offset:34944
    v_mfma_f32_16x16x32_bf16 v[160:163], a[120:123], a[72:75], v[160:163]
    ds_read_b64_tr_b16 a[54:55], v11 offset:35968
    v_mfma_f32_16x16x32_bf16 v[164:167], a[120:123], a[76:79], v[164:167]
    s_bfe_u32 s80, s61, 262156
    v_mfma_f32_16x16x32_bf16 v[168:171], a[120:123], a[80:83], v[168:171]
    ds_read_b64_tr_b16 a[56:57], v11 offset:32928
    v_mfma_f32_16x16x32_bf16 v[172:175], a[120:123], a[84:87], v[172:175]
    ds_read_b64_tr_b16 a[58:59], v11 offset:33952
    v_mfma_f32_16x16x32_bf16 v[188:191], a[124:127], a[84:87], v[188:191]
    ds_read_b64_tr_b16 a[60:61], v11 offset:34976
    v_mfma_f32_16x16x32_bf16 v[184:187], a[124:127], a[80:83], v[184:187]
    s_lshl_b32 s80, s80, 7
    v_mfma_f32_16x16x32_bf16 v[180:183], a[124:127], a[76:79], v[180:183]
    ds_read_b64_tr_b16 a[62:63], v11 offset:36000
    v_mfma_f32_16x16x32_bf16 v[176:179], a[124:127], a[72:75], v[176:179]
    ds_read_b64_tr_b16 a[64:65], v11 offset:32960
    v_mfma_f32_16x16x32_bf16 v[192:195], a[128:131], a[72:75], v[192:195]
    s_add_u32 s80, s80, s35
    v_mfma_f32_16x16x32_bf16 v[196:199], a[128:131], a[76:79], v[196:199]
    ds_read_b64_tr_b16 a[66:67], v11 offset:33984
    v_mfma_f32_16x16x32_bf16 v[200:203], a[128:131], a[80:83], v[200:203]
    ds_read_b64_tr_b16 a[68:69], v11 offset:35008
    v_mfma_f32_16x16x32_bf16 v[204:207], a[128:131], a[84:87], v[204:207]
    s_add_u32 m0, s38, 65536
    v_mfma_f32_16x16x32_bf16 v[220:223], a[132:135], a[84:87], v[220:223]
    ds_read_b64_tr_b16 a[70:71], v11 offset:36032
    v_mfma_f32_16x16x32_bf16 v[216:219], a[132:135], a[80:83], v[216:219]
    v_mfma_f32_16x16x32_bf16 v[212:215], a[132:135], a[76:79], v[212:215]
    buffer_load_dwordx4 v1, s[16:19], s80 offen offset:0 lds
    v_mfma_f32_16x16x32_bf16 v[208:211], a[132:135], a[72:75], v[208:211]
    buffer_load_dwordx4 v2, s[16:19], s80 offen offset:1024 lds
    v_mfma_f32_16x16x32_bf16 v[224:227], a[136:139], a[72:75], v[224:227]
    buffer_load_dwordx4 v3, s[16:19], s80 offen offset:2048 lds
    v_mfma_f32_16x16x32_bf16 v[228:231], a[136:139], a[76:79], v[228:231]
    v_mfma_f32_16x16x32_bf16 v[232:235], a[136:139], a[80:83], v[232:235]
    buffer_load_dwordx4 v4, s[16:19], s80 offen offset:3072 lds
    v_mfma_f32_16x16x32_bf16 v[236:239], a[136:139], a[84:87], v[236:239]
    v_mfma_f32_16x16x32_bf16 v[252:255], a[140:143], a[84:87], v[252:255]
    s_cmp_lg_u32 s56, 4
    s_cbranch_scc1 k_pf4
    buffer_load_dword a255, v28, s[52:55], s58 offen
    s_add_u32 s58, s58, 7168
    buffer_load_dword a255, v28, s[52:55], s58 offen
k_pf4:
    v_mfma_f32_16x16x32_bf16 v[248:251], a[140:143], a[80:83], v[248:251]
    v_mfma_f32_16x16x32_bf16 v[244:247], a[140:143], a[76:79], v[244:247]
    v_mfma_f32_16x16x32_bf16 v[240:243], a[140:143], a[72:75], v[240:243]
    s_waitcnt vmcnt(20) lgkmcnt(0)
    s_barrier
    v_mfma_f32_16x16x32_bf16 v[32:35], a[16:19], a[0:3], v[32:35]
    ds_read_b128 a[72:75], v9 offset:0
    v_mfma_f32_16x16x32_bf16 v[36:39], a[16:19], a[4:7], v[36:39]
    ds_read_b128 a[76:79], v9 offset:2048
    v_mfma_f32_16x16x32_bf16 v[40:43], a[16:19], a[8:11], v[40:43]
    ds_read_b128 a[80:83], v9 offset:4096
    v_mfma_f32_16x16x32_bf16 v[44:47], a[16:19], a[12:15], v[44:47]
    s_bfe_u32 s81, s61, 262156
    v_mfma_f32_16x16x32_bf16 v[60:63], a[20:23], a[12:15], v[60:63]
    ds_read_b128 a[84:87], v9 offset:6144
    v_mfma_f32_16x16x32_bf16 v[56:59], a[20:23], a[8:11], v[56:59]
    ds_read_b64_tr_b16 a[88:89], v11 offset:49152
    v_mfma_f32_16x16x32_bf16 v[52:55], a[20:23], a[4:7], v[52:55]
    s_mul_i32 s81, s81, 458752
    v_mfma_f32_16x16x32_bf16 v[48:51], a[20:23], a[0:3], v[48:51]
    ds_read_b64_tr_b16 a[90:91], v11 offset:50176
    v_mfma_f32_16x16x32_bf16 v[64:67], a[24:27], a[0:3], v[64:67]
    ds_read_b64_tr_b16 a[92:93], v11 offset:51200
    v_mfma_f32_16x16x32_bf16 v[68:71], a[24:27], a[4:7], v[68:71]
    ds_read_b64_tr_b16 a[94:95], v11 offset:52224
    v_mfma_f32_16x16x32_bf16 v[72:75], a[24:27], a[8:11], v[72:75]
    s_add_u32 s81, s81, s37
    v_mfma_f32_16x16x32_bf16 v[76:79], a[24:27], a[12:15], v[76:79]
    ds_read_b64_tr_b16 a[96:97], v11 offset:49184
    v_mfma_f32_16x16x32_bf16 v[92:95], a[28:31], a[12:15], v[92:95]
    ds_read_b64_tr_b16 a[98:99], v11 offset:50208
    v_mfma_f32_16x16x32_bf16 v[88:91], a[28:31], a[8:11], v[88:91]
    v_mfma_f32_16x16x32_bf16 v[84:87], a[28:31], a[4:7], v[84:87]
    ds_read_b64_tr_b16 a[100:101], v11 offset:51232
    v_mfma_f32_16x16x32_bf16 v[80:83], a[28:31], a[0:3], v[80:83]
    ds_read_b64_tr_b16 a[102:103], v11 offset:52256
    v_mfma_f32_16x16x32_bf16 v[96:99], a[32:35], a[0:3], v[96:99]
    s_add_u32 m0, s39, 32768
    v_mfma_f32_16x16x32_bf16 v[100:103], a[32:35], a[4:7], v[100:103]
    ds_read_b64_tr_b16 a[104:105], v11 offset:49216
    v_mfma_f32_16x16x32_bf16 v[104:107], a[32:35], a[8:11], v[104:107]
    ds_read_b64_tr_b16 a[106:107], v11 offset:50240
    v_mfma_f32_16x16x32_bf16 v[108:111], a[32:35], a[12:15], v[108:111]
    ds_read_b64_tr_b16 a[108:109], v11 offset:51264
    v_mfma_f32_16x16x32_bf16 v[124:127], a[36:39], a[12:15], v[124:127]
    buffer_load_dwordx4 v5, s[20:23], s81 offen offset:0 lds
    v_mfma_f32_16x16x32_bf16 v[120:123], a[36:39], a[8:11], v[120:123]
    ds_read_b64_tr_b16 a[110:111], v11 offset:52288
    v_mfma_f32_16x16x32_bf16 v[116:119], a[36:39], a[4:7], v[116:119]
    ds_read_b64_tr_b16 a[112:113], v11 offset:49248
    v_mfma_f32_16x16x32_bf16 v[112:115], a[36:39], a[0:3], v[112:115]
    buffer_load_dwordx4 v6, s[20:23], s81 offen offset:1024 lds
    v_mfma_f32_16x16x32_bf16 v[128:131], a[40:43], a[0:3], v[128:131]
    ds_read_b64_tr_b16 a[114:115], v11 offset:50272
    v_mfma_f32_16x16x32_bf16 v[132:135], a[40:43], a[4:7], v[132:135]
    ds_read_b64_tr_b16 a[116:117], v11 offset:51296
    v_mfma_f32_16x16x32_bf16 v[136:139], a[40:43], a[8:11], v[136:139]
    ds_read_b64_tr_b16 a[118:119], v11 offset:52320
    v_mfma_f32_16x16x32_bf16 v[140:143], a[40:43], a[12:15], v[140:143]
    v_mfma_f32_16x16x32_bf16 v[156:159], a[44:47], a[12:15], v[156:159]
    ds_read_b64_tr_b16 a[120:121], v11 offset:49280
    v_mfma_f32_16x16x32_bf16 v[152:155], a[44:47], a[8:11], v[152:155]
    ds_read_b64_tr_b16 a[122:123], v11 offset:50304
    v_mfma_f32_16x16x32_bf16 v[148:151], a[44:47], a[4:7], v[148:151]
    s_add_u32 m0, s39, 34816
    v_mfma_f32_16x16x32_bf16 v[144:147], a[44:47], a[0:3], v[144:147]
    ds_read_b64_tr_b16 a[124:125], v11 offset:51328
    v_mfma_f32_16x16x32_bf16 v[160:163], a[48:51], a[0:3], v[160:163]
    ds_read_b64_tr_b16 a[126:127], v11 offset:52352
    v_mfma_f32_16x16x32_bf16 v[164:167], a[48:51], a[4:7], v[164:167]
    buffer_load_dwordx4 v5, s[24:27], s81 offen offset:0 lds
    v_mfma_f32_16x16x32_bf16 v[168:171], a[48:51], a[8:11], v[168:171]
    ds_read_b64_tr_b16 a[128:129], v11 offset:49312
    v_mfma_f32_16x16x32_bf16 v[172:175], a[48:51], a[12:15], v[172:175]
    ds_read_b64_tr_b16 a[130:131], v11 offset:50336
    v_mfma_f32_16x16x32_bf16 v[188:191], a[52:55], a[12:15], v[188:191]
    ds_read_b64_tr_b16 a[132:133], v11 offset:51360
    v_mfma_f32_16x16x32_bf16 v[184:187], a[52:55], a[8:11], v[184:187]
    v_mfma_f32_16x16x32_bf16 v[180:183], a[52:55], a[4:7], v[180:183]
    ds_read_b64_tr_b16 a[134:135], v11 offset:52384
    v_mfma_f32_16x16x32_bf16 v[176:179], a[52:55], a[0:3], v[176:179]
    ds_read_b64_tr_b16 a[136:137], v11 offset:49344
    v_mfma_f32_16x16x32_bf16 v[192:195], a[56:59], a[0:3], v[192:195]
    buffer_load_dwordx4 v6, s[24:27], s81 offen offset:1024 lds
    v_mfma_f32_16x16x32_bf16 v[196:199], a[56:59], a[4:7], v[196:199]
    ds_read_b64_tr_b16 a[138:139], v11 offset:50368
    v_mfma_f32_16x16x32_bf16 v[200:203], a[56:59], a[8:11], v[200:203]
    ds_read_b64_tr_b16 a[140:141], v11 offset:51392
    v_mfma_f32_16x16x32_bf16 v[204:207], a[56:59], a[12:15], v[204:207]
    s_add_u32 m0, s38, 69632
    v_mfma_f32_16x16x32_bf16 v[220:223], a[60:63], a[12:15], v[220:223]
    ds_read_b64_tr_b16 a[142:143], v11 offset:52416
    v_mfma_f32_16x16x32_bf16 v[216:219], a[60:63], a[8:11], v[216:219]
    buffer_load_dwordx4 v24, s[16:19], s80 offen offset:0 lds
    v_mfma_f32_16x16x32_bf16 v[212:215], a[60:63], a[4:7], v[212:215]
    v_mfma_f32_16x16x32_bf16 v[208:211], a[60:63], a[0:3], v[208:211]
    buffer_load_dwordx4 v25, s[16:19], s80 offen offset:1024 lds
    v_mfma_f32_16x16x32_bf16 v[224:227], a[64:67], a[0:3], v[224:227]
    buffer_load_dwordx4 v26, s[16:19], s80 offen offset:2048 lds
    v_mfma_f32_16x16x32_bf16 v[228:231], a[64:67], a[4:7], v[228:231]
    v_mfma_f32_16x16x32_bf16 v[232:235], a[64:67], a[8:11], v[232:235]
    buffer_load_dwordx4 v27, s[16:19], s80 offen offset:3072 lds
    v_mfma_f32_16x16x32_bf16 v[236:239], a[64:67], a[12:15], v[236:239]
    v_mfma_f32_16x16x32_bf16 v[252:255], a[68:71], a[12:15], v[252:255]
    s_cmp_lg_u32 s56, 5
    s_cbranch_scc1 k_pf5
    buffer_load_dword a255, v28, s[52:55], s58 offen
    s_add_u32 s58, s58, 7168
    buffer_load_dword a255, v28, s[52:55], s58 offen
k_pf5:
    v_mfma_f32_16x16x32_bf16 v[248:251], a[68:71], a[8:11], v[248:251]
    v_mfma_f32_16x16x32_bf16 v[244:247], a[68:71], a[4:7], v[244:247]
    v_mfma_f32_16x16x32_bf16 v[240:243], a[68:71], a[0:3], v[240:243]
    s_waitcnt vmcnt(16) lgkmcnt(0)
    s_barrier
    v_mfma_f32_16x16x32_bf16 v[32:35], a[88:91], a[72:75], v[32:35]
    ds_read_b128 a[0:3], v7 offset:32768
    v_mfma_f32_16x16x32_bf16 v[36:39], a[88:91], a[76:79], v[36:39]
    ds_read_b128 a[4:7], v7 offset:34816
    v_mfma_f32_16x16x32_bf16 v[40:43], a[88:91], a[80:83], v[40:43]
    ds_read_b128 a[8:11], v7 offset:36864
    v_mfma_f32_16x16x32_bf16 v[44:47], a[88:91], a[84:87], v[44:47]
    s_add_u32 s81, s81, 229376
    v_mfma_f32_16x16x32_bf16 v[60:63], a[92:95], a[84:87], v[60:63]
    ds_read_b128 a[12:15], v7 offset:38912
    v_mfma_f32_16x16x32_bf16 v[56:59], a[92:95], a[80:83], v[56:59]
    ds_read_b64_tr_b16 a[16:17], v11 offset:0
    v_mfma_f32_16x16x32_bf16 v[52:55], a[92:95], a[76:79], v[52:55]
    s_add_u32 m0, s39, 49152
    v_mfma_f32_16x16x32_bf16 v[48:51], a[92:95], a[72:75], v[48:51]
    ds_read_b64_tr_b16 a[18:19], v11 offset:1024
    v_mfma_f32_16x16x32_bf16 v[64:67], a[96:99], a[72:75], v[64:67]
    ds_read_b64_tr_b16 a[20:21], v11 offset:2048
    v_mfma_f32_16x16x32_bf16 v[68:71], a[96:99], a[76:79], v[68:71]
    ds_read_b64_tr_b16 a[22:23], v11 offset:3072
    v_mfma_f32_16x16x32_bf16 v[72:75], a[96:99], a[80:83], v[72:75]
    buffer_load_dwordx4 v5, s[20:23], s81 offen offset:0 lds
    v_mfma_f32_16x16x32_bf16 v[76:79], a[96:99], a[84:87], v[76:79]
    ds_read_b64_tr_b16 a[24:25], v11 offset:32
    v_mfma_f32_16x16x32_bf16 v[92:95], a[100:103], a[84:87], v[92:95]
    ds_read_b64_tr_b16 a[26:27], v11 offset:1056
    v_mfma_f32_16x16x32_bf16 v[88:91], a[100:103], a[80:83], v[88:91]
    buffer_load_dwordx4 v6, s[20:23], s81 offen offset:1024 lds
    v_mfma_f32_16x16x32_bf16 v[84:87], a[100:103], a[76:79], v[84:87]
    ds_read_b64_tr_b16 a[28:29], v11 offset:2080
    v_mfma_f32_16x16x32_bf16 v[80:83], a[100:103], a[72:75], v[80:83]
    ds_read_b64_tr_b16 a[30:31], v11 offset:3104
    v_mfma_f32_16x16x32_bf16 v[96:99], a[104:107], a[72:75], v[96:99]
    v_mfma_f32_16x16x32_bf16 v[100:103], a[104:107], a[76:79], v[100:103]
    ds_read_b64_tr_b16 a[32:33], v11 offset:64
    v_mfma_f32_16x16x32_bf16 v[104:107], a[104:107], a[80:83], v[104:107]
    ds_read_b64_tr_b16 a[34:35], v11 offset:1088
    v_mfma_f32_16x16x32_bf16 v[108:111], a[104:107], a[84:87], v[108:111]
    ds_read_b64_tr_b16 a[36:37], v11 offset:2112
    v_mfma_f32_16x16x32_bf16 v[124:127], a[108:111], a[84:87], v[124:127]
    s_add_u32 m0, s39, 51200
    v_mfma_f32_16x16x32_bf16 v[120:123], a[108:111], a[80:83], v[120:123]
    ds_read_b64_tr_b16 a[38:39], v11 offset:3136
    v_mfma_f32_16x16x32_bf16 v[116:119], a[108:111], a[76:79], v[116:119]
    ds_read_b64_tr_b16 a[40:41], v11 offset:96
    v_mfma_f32_16x16x32_bf16 v[112:115], a[108:111], a[72:75], v[112:115]
    buffer_load_dwordx4 v5, s[24:27], s81 offen offset:0 lds
    v_mfma_f32_16x16x32_bf16 v[128:131], a[112:115], a[72:75], v[128:131]
    ds_read_b64_tr_b16 a[42:43], v11 offset:1120
    v_mfma_f32_16x16x32_bf16 v[132:135], a[112:115], a[76:79], v[132:135]
    ds_read_b64_tr_b16 a[44:45], v11 offset:2144
    v_mfma_f32_16x16x32_bf16 v[136:139], a[112:115], a[80:83], v[136:139]
    ds_read_b64_tr_b16 a[46:47], v11 offset:3168
    v_mfma_f32_16x16x32_bf16 v[140:143], a[112:115], a[84:87], v[140:143]
    buffer_load_dwordx4 v6, s[24:27], s81 offen offset:1024 lds
    v_mfma_f32_16x16x32_bf16 v[156:159], a[116:119], a[84:87], v[156:159]
    ds_read_b64_tr_b16 a[48:49], v11 offset:128
    v_mfma_f32_16x16x32_bf16 v[152:155], a[116:119], a[80:83], v[152:155]
    ds_read_b64_tr_b16 a[50:51], v11 offset:1152
    v_mfma_f32_16x16x32_bf16 v[148:151], a[116:119], a[76:79], v[148:151]
    v_mfma_f32_16x16x32_bf16 v[144:147], a[116:119], a[72:75], v[144:147]
    ds_read_b64_tr_b16 a[52:53], v11 offset:2176
    v_mfma_f32_16x16x32_bf16 v[160:163], a[120:123], a[72:75], v[160:163]
    ds_read_b64_tr_b16 a[54:55], v11 offset:3200
    v_mfma_f32_16x16x32_bf16 v[164:167], a[120:123], a[76:79], v[164:167]
    s_bfe_u32 s80, s61, 262160
    v_mfma_f32_16x16x32_bf16 v[168:171], a[120:123], a[80:83], v[168:171]
    ds_read_b64_tr_b16 a[56:57], v11 offset:160
    v_mfma_f32_16x16x32_bf16 v[172:175], a[120:123], a[84:87], v[172:175]
    ds_read_b64_tr_b16 a[58:59], v11 offset:1184
    v_mfma_f32_16x16x32_bf16 v[188:191], a[124:127], a[84:87], v[188:191]
    ds_read_b64_tr_b16 a[60:61], v11 offset:2208
    v_mfma_f32_16x16x32_bf16 v[184:187], a[124:127], a[80:83], v[184:187]
    s_lshl_b32 s80, s80, 7
    v_mfma_f32_16x16x32_bf16 v[180:183], a[124:127], a[76:79], v[180:183]
    ds_read_b64_tr_b16 a[62:63], v11 offset:3232
    v_mfma_f32_16x16x32_bf16 v[176:179], a[124:127], a[72:75], v[176:179]
    ds_read_b64_tr_b16 a[64:65], v11 offset:192
    v_mfma_f32_16x16x32_bf16 v[192:195], a[128:131], a[72:75], v[192:195]
    s_add_u32 s80, s80, s35
    v_mfma_f32_16x16x32_bf16 v[196:199], a[128:131], a[76:79], v[196:199]
    ds_read_b64_tr_b16 a[66:67], v11 offset:1216
    v_mfma_f32_16x16x32_bf16 v[200:203], a[128:131], a[80:83], v[200:203]
    ds_read_b64_tr_b16 a[68:69], v11 offset:2240
    v_mfma_f32_16x16x32_bf16 v[204:207], a[128:131], a[84:87], v[204:207]
    s_add_u32 m0, s38, 0
    v_mfma_f32_16x16x32_bf16 v[220:223], a[132:135], a[84:87], v[220:223]
    ds_read_b64_tr_b16 a[70:71], v11 offset:3264
    v_mfma_f32_16x16x32_bf16 v[216:219], a[132:135], a[80:83], v[216:219]
    v_mfma_f32_16x16x32_bf16 v[212:215], a[132:135], a[76:79], v[212:215]
    buffer_load_dwordx4 v1, s[16:19], s80 offen offset:0 lds
    v_mfma_f32_16x16x32_bf16 v[208:211], a[132:135], a[72:75], v[208:211]
    buffer_load_dwordx4 v2, s[16:19], s80 offen offset:1024 lds
    v_mfma_f32_16x16x32_bf16 v[224:227], a[136:139], a[72:75], v[224:227]
    buffer_load_dwordx4 v3, s[16:19], s80 offen offset:2048 lds
    v_mfma_f32_16x16x32_bf16 v[228:231], a[136:139], a[76:79], v[228:231]
    v_mfma_f32_16x16x32_bf16 v[232:235], a[136:139], a[80:83], v[232:235]
    buffer_load_dwordx4 v4, s[16:19], s80 offen offset:3072 lds
    v_mfma_f32_16x16x32_bf16 v[236:239], a[136:139], a[84:87], v[236:239]
    v_mfma_f32_16x16x32_bf16 v[252:255], a[140:143], a[84:87], v[252:255]
    s_cmp_lg_u32 s56, 6
    s_cbranch_scc1 k_pf6
    buffer_load_dword a255, v28, s[52:55], s58 offen
    s_add_u32 s58, s58, 7168
    buffer_load_dword a255, v28, s[52:55], s58 offen
k_pf6:
    v_mfma_f32_16x16x32_bf16 v[248:251], a[140:143], a[80:83], v[248:251]
    v_mfma_f32_16x16x32_bf16 v[244:247], a[140:143], a[76:79], v[244:247]
    v_mfma_f32_16x16x32_bf16 v[240:243], a[140:143], a[72:75], v[240:243]
    s_waitcnt vmcnt(20) lgkmcnt(0)
    s_barrier
    v_mfma_f32_16x16x32_bf16 v[32:35], a[16:19], a[0:3], v[32:35]
    ds_read_b128 a[72:75], v9 offset:32768
    v_mfma_f32_16x16x32_bf16 v[36:39], a[16:19], a[4:7], v[36:39]
    ds_read_b128 a[76:79], v9 offset:34816
    v_mfma_f32_16x16x32_bf16 v[40:43], a[16:19], a[8:11], v[40:43]
    ds_read_b128 a[80:83], v9 offset:36864
    v_mfma_f32_16x16x32_bf16 v[44:47], a[16:19], a[12:15], v[44:47]
    s_bfe_u32 s81, s61, 262160
    v_mfma_f32_16x16x32_bf16 v[60:63], a[20:23], a[12:15], v[60:63]
    ds_read_b128 a[84:87], v9 offset:38912
    v_mfma_f32_16x16x32_bf16 v[56:59], a[20:23], a[8:11], v[56:59]
    ds_read_b64_tr_b16 a[88:89], v11 offset:16384
    v_mfma_f32_16x16x32_bf16 v[52:55], a[20:23], a[4:7], v[52:55]
    s_mul_i32 s81, s81, 458752
    v_mfma_f32_16x16x32_bf16 v[48:51], a[20:23], a[0:3], v[48:51]
    ds_read_b64_tr_b16 a[90:91], v11 offset:17408
    v_mfma_f32_16x16x32_bf16 v[64:67], a[24:27], a[0:3], v[64:67]
    ds_read_b64_tr_b16 a[92:93], v11 offset:18432
    v_mfma_f32_16x16x32_bf16 v[68:71], a[24:27], a[4:7], v[68:71]
    ds_read_b64_tr_b16 a[94:95], v11 offset:19456
    v_mfma_f32_16x16x32_bf16 v[72:75], a[24:27], a[8:11], v[72:75]
    s_add_u32 s81, s81, s37
    v_mfma_f32_16x16x32_bf16 v[76:79], a[24:27], a[12:15], v[76:79]
    ds_read_b64_tr_b16 a[96:97], v11 offset:16416
    v_mfma_f32_16x16x32_bf16 v[92:95], a[28:31], a[12:15], v[92:95]
    ds_read_b64_tr_b16 a[98:99], v11 offset:17440
    v_mfma_f32_16x16x32_bf16 v[88:91], a[28:31], a[8:11], v[88:91]
    v_mfma_f32_16x16x32_bf16 v[84:87], a[28:31], a[4:7], v[84:87]
    ds_read_b64_tr_b16 a[100:101], v11 offset:18464
    v_mfma_f32_16x16x32_bf16 v[80:83], a[28:31], a[0:3], v[80:83]
    ds_read_b64_tr_b16 a[102:103], v11 offset:19488
    v_mfma_f32_16x16x32_bf16 v[96:99], a[32:35], a[0:3], v[96:99]
    s_add_u32 m0, s39, 0
    v_mfma_f32_16x16x32_bf16 v[100:103], a[32:35], a[4:7], v[100:103]
    ds_read_b64_tr_b16 a[104:105], v11 offset:16448
    v_mfma_f32_16x16x32_bf16 v[104:107], a[32:35], a[8:11], v[104:107]
    ds_read_b64_tr_b16 a[106:107], v11 offset:17472
    v_mfma_f32_16x16x32_bf16 v[108:111], a[32:35], a[12:15], v[108:111]
    ds_read_b64_tr_b16 a[108:109], v11 offset:18496
    v_mfma_f32_16x16x32_bf16 v[124:127], a[36:39], a[12:15], v[124:127]
    buffer_load_dwordx4 v5, s[20:23], s81 offen offset:0 lds
    v_mfma_f32_16x16x32_bf16 v[120:123], a[36:39], a[8:11], v[120:123]
    ds_read_b64_tr_b16 a[110:111], v11 offset:19520
    v_mfma_f32_16x16x32_bf16 v[116:119], a[36:39], a[4:7], v[116:119]
    ds_read_b64_tr_b16 a[112:113], v11 offset:16480
    v_mfma_f32_16x16x32_bf16 v[112:115], a[36:39], a[0:3], v[112:115]
    buffer_load_dwordx4 v6, s[20:23], s81 offen offset:1024 lds
    v_mfma_f32_16x16x32_bf16 v[128:131], a[40:43], a[0:3], v[128:131]
    ds_read_b64_tr_b16 a[114:115], v11 offset:17504
    v_mfma_f32_16x16x32_bf16 v[132:135], a[40:43], a[4:7], v[132:135]
    ds_read_b64_tr_b16 a[116:117], v11 offset:18528
    v_mfma_f32_16x16x32_bf16 v[136:139], a[40:43], a[8:11], v[136:139]
    ds_read_b64_tr_b16 a[118:119], v11 offset:19552
    v_mfma_f32_16x16x32_bf16 v[140:143], a[40:43], a[12:15], v[140:143]
    v_mfma_f32_16x16x32_bf16 v[156:159], a[44:47], a[12:15], v[156:159]
    ds_read_b64_tr_b16 a[120:121], v11 offset:16512
    v_mfma_f32_16x16x32_bf16 v[152:155], a[44:47], a[8:11], v[152:155]
    ds_read_b64_tr_b16 a[122:123], v11 offset:17536
    v_mfma_f32_16x16x32_bf16 v[148:151], a[44:47], a[4:7], v[148:151]
    s_add_u32 m0, s39, 2048
    v_mfma_f32_16x16x32_bf16 v[144:147], a[44:47], a[0:3], v[144:147]
    ds_read_b64_tr_b16 a[124:125], v11 offset:18560
    v_mfma_f32_16x16x32_bf16 v[160:163], a[48:51], a[0:3], v[160:163]
    ds_read_b64_tr_b16 a[126:127], v11 offset:19584
    v_mfma_f32_16x16x32_bf16 v[164:167], a[48:51], a[4:7], v[164:167]
    buffer_load_dwordx4 v5, s[24:27], s81 offen offset:0 lds
    v_mfma_f32_16x16x32_bf16 v[168:171], a[48:51], a[8:11], v[168:171]
    ds_read_b64_tr_b16 a[128:129], v11 offset:16544
    v_mfma_f32_16x16x32_bf16 v[172:175], a[48:51], a[12:15], v[172:175]
    ds_read_b64_tr_b16 a[130:131], v11 offset:17568
    v_mfma_f32_16x16x32_bf16 v[188:191], a[52:55], a[12:15], v[188:191]
    ds_read_b64_tr_b16 a[132:133], v11 offset:18592
    v_mfma_f32_16x16x32_bf16 v[184:187], a[52:55], a[8:11], v[184:187]
    v_mfma_f32_16x16x32_bf16 v[180:183], a[52:55], a[4:7], v[180:183]
    ds_read_b64_tr_b16 a[134:135], v11 offset:19616
    v_mfma_f32_16x16x32_bf16 v[176:179], a[52:55], a[0:3], v[176:179]
    ds_read_b64_tr_b16 a[136:137], v11 offset:16576
    v_mfma_f32_16x16x32_bf16 v[192:195], a[56:59], a[0:3], v[192:195]
    buffer_load_dwordx4 v6, s[24:27], s81 offen offset:1024 lds
    v_mfma_f32_16x16x32_bf16 v[196:199], a[56:59], a[4:7], v[196:199]
    ds_read_b64_tr_b16 a[138:139], v11 offset:17600
    v_mfma_f32_16x16x32_bf16 v[200:203], a[56:59], a[8:11], v[200:203]
    ds_read_b64_tr_b16 a[140:141], v11 offset:18624
    v_mfma_f32_16x16x32_bf16 v[204:207], a[56:59], a[12:15], v[204:207]
    s_add_u32 m0, s38, 4096
    v_mfma_f32_16x16x32_bf16 v[220:223], a[60:63], a[12:15], v[220:223]
    ds_read_b64_tr_b16 a[142:143], v11 offset:19648
    v_mfma_f32_16x16x32_bf16 v[216:219], a[60:63], a[8:11], v[216:219]
    buffer_load_dwordx4 v24, s[16:19], s80 offen offset:0 lds
    v_mfma_f32_16x16x32_bf16 v[212:215], a[60:63], a[4:7], v[212:215]
    v_mfma_f32_16x16x32_bf16 v[208:211], a[60:63], a[0:3], v[208:211]
    buffer_load_dwordx4 v25, s[16:19], s80 offen offset:1024 lds
    v_mfma_f32_16x16x32_bf16 v[224:227], a[64:67], a[0:3], v[224:227]
    buffer_load_dwordx4 v26, s[16:19], s80 offen offset:2048 lds
    v_mfma_f32_16x16x32_bf16 v[228:231], a[64:67], a[4:7], v[228:231]
    v_mfma_f32_16x16x32_bf16 v[232:235], a[64:67], a[8:11], v[232:235]
    buffer_load_dwordx4 v27, s[16:19], s80 offen offset:3072 lds
    v_mfma_f32_16x16x32_bf16 v[236:239], a[64:67], a[12:15], v[236:239]
    v_mfma_f32_16x16x32_bf16 v[252:255], a[68:71], a[12:15], v[252:255]
    s_cmp_lg_u32 s56, 7
    s_cbranch_scc1 k_pf7
    buffer_load_dword a255, v28, s[52:55], s58 offen
    s_add_u32 s58, s58, 7168
    buffer_load_dword a255, v28, s[52:55], s58 offen
k_pf7:
    v_mfma_f32_16x16x32_bf16 v[248:251], a[68:71], a[8:11], v[248:251]
    v_mfma_f32_16x16x32_bf16 v[244:247], a[68:71], a[4:7], v[244:247]
    v_mfma_f32_16x16x32_bf16 v[240:243], a[68:71], a[0:3], v[240:243]
    s_waitcnt vmcnt(16) lgkmcnt(0)
    s_barrier
    v_mfma_f32_16x16x32_bf16 v[32:35], a[88:91], a[72:75], v[32:35]
    ds_read_b128 a[0:3], v8 offset:0
    v_mfma_f32_16x16x32_bf16 v[36:39], a[88:91], a[76:79], v[36:39]
    ds_read_b128 a[4:7], v8 offset:2048
    v_mfma_f32_16x16x32_bf16 v[40:43], a[88:91], a[80:83], v[40:43]
    ds_read_b128 a[8:11], v8 offset:4096
    v_mfma_f32_16x16x32_bf16 v[44:47], a[88:91], a[84:87], v[44:47]
    s_add_u32 s81, s81, 229376
    v_mfma_f32_16x16x32_bf16 v[60:63], a[92:95], a[84:87], v[60:63]
    ds_read_b128 a[12:15], v8 offset:6144
    v_mfma_f32_16x16x32_bf16 v[56:59], a[92:95], a[80:83], v[56:59]
    ds_read_b64_tr_b16 a[16:17], v11 offset:32768
    v_mfma_f32_16x16x32_bf16 v[52:55], a[92:95], a[76:79], v[52:55]
    s_add_u32 m0, s39, 16384
    v_mfma_f32_16x16x32_bf16 v[48:51], a[92:95], a[72:75], v[48:51]
    ds_read_b64_tr_b16 a[18:19], v11 offset:33792
    v_mfma_f32_16x16x32_bf16 v[64:67], a[96:99], a[72:75], v[64:67]
    ds_read_b64_tr_b16 a[20:21], v11 offset:34816
    v_mfma_f32_16x16x32_bf16 v[68:71], a[96:99], a[76:79], v[68:71]
    ds_read_b64_tr_b16 a[22:23], v11 offset:35840
    v_mfma_f32_16x16x32_bf16 v[72:75], a[96:99], a[80:83], v[72:75]
    buffer_load_dwordx4 v5, s[20:23], s81 offen offset:0 lds
    v_mfma_f32_16x16x32_bf16 v[76:79], a[96:99], a[84:87], v[76:79]
    ds_read_b64_tr_b16 a[24:25], v11 offset:32800
    v_mfma_f32_16x16x32_bf16 v[92:95], a[100:103], a[84:87], v[92:95]
    ds_read_b64_tr_b16 a[26:27], v11 offset:33824
    v_mfma_f32_16x16x32_bf16 v[88:91], a[100:103], a[80:83], v[88:91]
    buffer_load_dwordx4 v6, s[20:23], s81 offen offset:1024 lds
    v_mfma_f32_16x16x32_bf16 v[84:87], a[100:103], a[76:79], v[84:87]
    ds_read_b64_tr_b16 a[28:29], v11 offset:34848
    v_mfma_f32_16x16x32_bf16 v[80:83], a[100:103], a[72:75], v[80:83]
    ds_read_b64_tr_b16 a[30:31], v11 offset:35872
    v_mfma_f32_16x16x32_bf16 v[96:99], a[104:107], a[72:75], v[96:99]
    v_mfma_f32_16x16x32_bf16 v[100:103], a[104:107], a[76:79], v[100:103]
    ds_read_b64_tr_b16 a[32:33], v11 offset:32832
    v_mfma_f32_16x16x32_bf16 v[104:107], a[104:107], a[80:83], v[104:107]
    ds_read_b64_tr_b16 a[34:35], v11 offset:33856
    v_mfma_f32_16x16x32_bf16 v[108:111], a[104:107], a[84:87], v[108:111]
    ds_read_b64_tr_b16 a[36:37], v11 offset:34880
    v_mfma_f32_16x16x32_bf16 v[124:127], a[108:111], a[84:87], v[124:127]
    s_add_u32 m0, s39, 18432
    v_mfma_f32_16x16x32_bf16 v[120:123], a[108:111], a[80:83], v[120:123]
    ds_read_b64_tr_b16 a[38:39], v11 offset:35904
    v_mfma_f32_16x16x32_bf16 v[116:119], a[108:111], a[76:79], v[116:119]
    ds_read_b64_tr_b16 a[40:41], v11 offset:32864
    v_mfma_f32_16x16x32_bf16 v[112:115], a[108:111], a[72:75], v[112:115]
    buffer_load_dwordx4 v5, s[24:27], s81 offen offset:0 lds
    v_mfma_f32_16x16x32_bf16 v[128:131], a[112:115], a[72:75], v[128:131]
    ds_read_b64_tr_b16 a[42:43], v11 offset:33888
    v_mfma_f32_16x16x32_bf16 v[132:135], a[112:115], a[76:79], v[132:135]
    ds_read_b64_tr_b16 a[44:45], v11 offset:34912
    v_mfma_f32_16x16x32_bf16 v[136:139], a[112:115], a[80:83], v[136:139]
    ds_read_b64_tr_b16 a[46:47], v11 offset:35936
    v_mfma_f32_16x16x32_bf16 v[140:143], a[112:115], a[84:87], v[140:143]
    buffer_load_dwordx4 v6, s[24:27], s81 offen offset:1024 lds
    v_mfma_f32_16x16x32_bf16 v[156:159], a[116:119], a[84:87], v[156:159]
    ds_read_b64_tr_b16 a[48:49], v11 offset:32896
    v_mfma_f32_16x16x32_bf16 v[152:155], a[116:119], a[80:83], v[152:155]
    ds_read_b64_tr_b16 a[50:51], v11 offset:33920
    v_mfma_f32_16x16x32_bf16 v[148:151], a[116:119], a[76:79], v[148:151]
    v_mfma_f32_16x16x32_bf16 v[144:147], a[116:119], a[72:75], v[144:147]
    ds_read_b64_tr_b16 a[52:53], v11 offset:34944
    v_mfma_f32_16x16x32_bf16 v[160:163], a[120:123], a[72:75], v[160:163]
    ds_read_b64_tr_b16 a[54:55], v11 offset:35968
    v_mfma_f32_16x16x32_bf16 v[164:167], a[120:123], a[76:79], v[164:167]
    s_bfe_u32 s80, s61, 262164
    v_mfma_f32_16x16x32_bf16 v[168:171], a[120:123], a[80:83], v[168:171]
    ds_read_b64_tr_b16 a[56:57], v11 offset:32928
    v_mfma_f32_16x16x32_bf16 v[172:175], a[120:123], a[84:87], v[172:175]
    ds_read_b64_tr_b16 a[58:59], v11 offset:33952
    v_mfma_f32_16x16x32_bf16 v[188:191], a[124:127], a[84:87], v[188:191]
    ds_read_b64_tr_b16 a[60:61], v11 offset:34976
    v_mfma_f32_16x16x32_bf16 v[184:187], a[124:127], a[80:83], v[184:187]
    s_lshl_b32 s80, s80, 7
    v_mfma_f32_16x16x32_bf16 v[180:183], a[124:127], a[76:79], v[180:183]
    ds_read_b64_tr_b16 a[62:63], v11 offset:36000
    v_mfma_f32_16x16x32_bf16 v[176:179], a[124:127], a[72:75], v[176:179]
    ds_read_b64_tr_b16 a[64:65], v11 offset:32960
    v_mfma_f32_16x16x32_bf16 v[192:195], a[128:131], a[72:75], v[192:195]
    s_add_u32 s80, s80, s35
    v_mfma_f32_16x16x32_bf16 v[196:199], a[128:131], a[76:79], v[196:199]
    ds_read_b64_tr_b16 a[66:67], v11 offset:33984
    v_mfma_f32_16x16x32_bf16 v[200:203], a[128:131], a[80:83], v[200:203]
    ds_read_b64_tr_b16 a[68:69], v11 offset:35008
    v_mfma_f32_16x16x32_bf16 v[204:207], a[128:131], a[84:87], v[204:207]
    s_add_u32 m0, s38, 32768
    v_mfma_f32_16x16x32_bf16 v[220:223], a[132:135], a[84:87], v[220:223]
    ds_read_b64_tr_b16 a[70:71], v11 offset:36032
    v_mfma_f32_16x16x32_bf16 v[216:219], a[132:135], a[80:83], v[216:219]
    v_mfma_f32_16x16x32_bf16 v[212:215], a[132:135], a[76:79], v[212:215]
    buffer_load_dwordx4 v1, s[16:19], s80 offen offset:0 lds
    v_mfma_f32_16x16x32_bf16 v[208:211], a[132:135], a[72:75], v[208:211]
    buffer_load_dwordx4 v2, s[16:19], s80 offen offset:1024 lds
    v_mfma_f32_16x16x32_bf16 v[224:227], a[136:139], a[72:75], v[224:227]
    buffer_load_dwordx4 v3, s[16:19], s80 offen offset:2048 lds
    v_mfma_f32_16x16x32_bf16 v[228:231], a[136:139], a[76:79], v[228:231]
    v_mfma_f32_16x16x32_bf16 v[232:235], a[136:139], a[80:83], v[232:235]
    buffer_load_dwordx4 v4, s[16:19], s80 offen offset:3072 lds
    v_mfma_f32_16x16x32_bf16 v[236:239], a[136:139], a[84:87], v[236:239]
    v_mfma_f32_16x16x32_bf16 v[252:255], a[140:143], a[84:87], v[252:255]
    v_mfma_f32_16x16x32_bf16 v[248:251], a[140:143], a[80:83], v[248:251]
    v_mfma_f32_16x16x32_bf16 v[244:247], a[140:143], a[76:79], v[244:247]
    v_mfma_f32_16x16x32_bf16 v[240:243], a[140:143], a[72:75], v[240:243]
    s_waitcnt vmcnt(20) lgkmcnt(0)
    s_barrier
    v_mfma_f32_16x16x32_bf16 v[32:35], a[16:19], a[0:3], v[32:35]
    ds_read_b128 a[72:75], v10 offset:0
    s_lshl_b32 s43, s33, 3
    v_mfma_f32_16x16x32_bf16 v[36:39], a[16:19], a[4:7], v[36:39]
    ds_read_b128 a[76:79], v10 offset:2048
    v_mfma_f32_16x16x32_bf16 v[40:43], a[16:19], a[8:11], v[40:43]
    ds_read_b128 a[80:83], v10 offset:4096
    s_lshl_b32 s3, s32, 1
    v_mfma_f32_16x16x32_bf16 v[44:47], a[16:19], a[12:15], v[44:47]
    s_bfe_u32 s81, s61, 262164
    v_mfma_f32_16x16x32_bf16 v[60:63], a[20:23], a[12:15], v[60:63]
    ds_read_b128 a[84:87], v10 offset:6144
    s_add_u32 s43, s43, s3
    v_mfma_f32_16x16x32_bf16 v[56:59], a[20:23], a[8:11], v[56:59]
    ds_read_b64_tr_b16 a[88:89], v11 offset:49152
    v_mfma_f32_16x16x32_bf16 v[52:55], a[20:23], a[4:7], v[52:55]
    s_mul_i32 s81, s81, 458752
    s_mul_i32 s48, s43, 229376
    v_mfma_f32_16x16x32_bf16 v[48:51], a[20:23], a[0:3], v[48:51]
    ds_read_b64_tr_b16 a[90:91], v11 offset:50176
    v_mfma_f32_16x16x32_bf16 v[64:67], a[24:27], a[0:3], v[64:67]
    ds_read_b64_tr_b16 a[92:93], v11 offset:51200
    s_mul_i32 s3, s34, 7
    v_mfma_f32_16x16x32_bf16 v[68:71], a[24:27], a[4:7], v[68:71]
    ds_read_b64_tr_b16 a[94:95], v11 offset:52224
    v_mfma_f32_16x16x32_bf16 v[72:75], a[24:27], a[8:11], v[72:75]
    s_add_u32 s81, s81, s37
    s_lshr_b32 s3, s3, 1
    v_mfma_f32_16x16x32_bf16 v[76:79], a[24:27], a[12:15], v[76:79]
    ds_read_b64_tr_b16 a[96:97], v11 offset:49184
    v_mfma_f32_16x16x32_bf16 v[92:95], a[28:31], a[12:15], v[92:95]
    ds_read_b64_tr_b16 a[98:99], v11 offset:50208
    s_lshl_b32 s3, s3, 11
    v_mfma_f32_16x16x32_bf16 v[88:91], a[28:31], a[8:11], v[88:91]
    v_mfma_f32_16x16x32_bf16 v[84:87], a[28:31], a[4:7], v[84:87]
    ds_read_b64_tr_b16 a[100:101], v11 offset:51232
    s_add_u32 s48, s48, s3
    v_mfma_f32_16x16x32_bf16 v[80:83], a[28:31], a[0:3], v[80:83]
    ds_read_b64_tr_b16 a[102:103], v11 offset:52256
    v_mfma_f32_16x16x32_bf16 v[96:99], a[32:35], a[0:3], v[96:99]
    s_add_u32 m0, s39, 32768
    s_and_b32 s43, s34, 1
    v_mfma_f32_16x16x32_bf16 v[100:103], a[32:35], a[4:7], v[100:103]
    ds_read_b64_tr_b16 a[104:105], v11 offset:49216
    v_mfma_f32_16x16x32_bf16 v[104:107], a[32:35], a[8:11], v[104:107]
    ds_read_b64_tr_b16 a[106:107], v11 offset:50240
    s_mul_i32 s3, s43, 5632
    v_mfma_f32_16x16x32_bf16 v[108:111], a[32:35], a[12:15], v[108:111]
    ds_read_b64_tr_b16 a[108:109], v11 offset:51264
    v_mfma_f32_16x16x32_bf16 v[124:127], a[36:39], a[12:15], v[124:127]
    buffer_load_dwordx4 v5, s[20:23], s81 offen offset:0 lds
    s_sub_u32 s3, 6144, s3
    v_mfma_f32_16x16x32_bf16 v[120:123], a[36:39], a[8:11], v[120:123]
    ds_read_b64_tr_b16 a[110:111], v11 offset:52288
    v_mfma_f32_16x16x32_bf16 v[116:119], a[36:39], a[4:7], v[116:119]
    ds_read_b64_tr_b16 a[112:113], v11 offset:49248
    s_add_u32 s56, s48, s3
    v_mfma_f32_16x16x32_bf16 v[112:115], a[36:39], a[0:3], v[112:115]
    buffer_load_dwordx4 v6, s[20:23], s81 offen offset:1024 lds
    v_mfma_f32_16x16x32_bf16 v[128:131], a[40:43], a[0:3], v[128:131]
    ds_read_b64_tr_b16 a[114:115], v11 offset:50272
    s_add_u32 s57, s56, 229376
    v_mfma_f32_16x16x32_bf16 v[132:135], a[40:43], a[4:7], v[132:135]
    ds_read_b64_tr_b16 a[116:117], v11 offset:51296
    v_mfma_f32_16x16x32_bf16 v[136:139], a[40:43], a[8:11], v[136:139]
    ds_read_b64_tr_b16 a[118:119], v11 offset:52320
    s_lshl_b32 s3, s43, 11
    v_mfma_f32_16x16x32_bf16 v[140:143], a[40:43], a[12:15], v[140:143]
    v_mfma_f32_16x16x32_bf16 v[156:159], a[44:47], a[12:15], v[156:159]
    ds_read_b64_tr_b16 a[120:121], v11 offset:49280
    s_add_u32 s43, s48, s3
    v_mfma_f32_16x16x32_bf16 v[152:155], a[44:47], a[8:11], v[152:155]
    ds_read_b64_tr_b16 a[122:123], v11 offset:50304
    v_mfma_f32_16x16x32_bf16 v[148:151], a[44:47], a[4:7], v[148:151]
    s_add_u32 m0, s39, 34816
    s_and_b32 s3, s34, 2
    v_mfma_f32_16x16x32_bf16 v[144:147], a[44:47], a[0:3], v[144:147]
    ds_read_b64_tr_b16 a[124:125], v11 offset:51328
    v_mfma_f32_16x16x32_bf16 v[160:163], a[48:51], a[0:3], v[160:163]
    ds_read_b64_tr_b16 a[126:127], v11 offset:52352
    s_lshl_b32 s3, s3, 10
    v_mfma_f32_16x16x32_bf16 v[164:167], a[48:51], a[4:7], v[164:167]
    buffer_load_dwordx4 v5, s[24:27], s81 offen offset:0 lds
    v_mfma_f32_16x16x32_bf16 v[168:171], a[48:51], a[8:11], v[168:171]
    ds_read_b64_tr_b16 a[128:129], v11 offset:49312
    s_add_u32 s48, s43, s3
    v_mfma_f32_16x16x32_bf16 v[172:175], a[48:51], a[12:15], v[172:175]
    ds_read_b64_tr_b16 a[130:131], v11 offset:50336
    v_mfma_f32_16x16x32_bf16 v[188:191], a[52:55], a[12:15], v[188:191]
    ds_read_b64_tr_b16 a[132:133], v11 offset:51360
    s_add_u32 s50, s48, 2048
    v_mfma_f32_16x16x32_bf16 v[184:187], a[52:55], a[8:11], v[184:187]
    v_mfma_f32_16x16x32_bf16 v[180:183], a[52:55], a[4:7], v[180:183]
    ds_read_b64_tr_b16 a[134:135], v11 offset:52384
    s_lshl_b32 s3, s3, 1
    v_mfma_f32_16x16x32_bf16 v[176:179], a[52:55], a[0:3], v[176:179]
    ds_read_b64_tr_b16 a[136:137], v11 offset:49344
    v_mfma_f32_16x16x32_bf16 v[192:195], a[56:59], a[0:3], v[192:195]
    buffer_load_dwordx4 v6, s[24:27], s81 offen offset:1024 lds
    s_sub_u32 s3, 4096, s3
    v_mfma_f32_16x16x32_bf16 v[196:199], a[56:59], a[4:7], v[196:199]
    ds_read_b64_tr_b16 a[138:139], v11 offset:50368
    v_mfma_f32_16x16x32_bf16 v[200:203], a[56:59], a[8:11], v[200:203]
    ds_read_b64_tr_b16 a[140:141], v11 offset:51392
    s_add_u32 s40, s43, s3
    v_mfma_f32_16x16x32_bf16 v[204:207], a[56:59], a[12:15], v[204:207]
    s_add_u32 m0, s38, 36864
    v_mfma_f32_16x16x32_bf16 v[220:223], a[60:63], a[12:15], v[220:223]
    ds_read_b64_tr_b16 a[142:143], v11 offset:52416
    s_add_u32 s49, s48, 229376
    v_mfma_f32_16x16x32_bf16 v[216:219], a[60:63], a[8:11], v[216:219]
    buffer_load_dwordx4 v24, s[16:19], s80 offen offset:0 lds
    v_mfma_f32_16x16x32_bf16 v[212:215], a[60:63], a[4:7], v[212:215]
    s_add_u32 s51, s50, 229376
    v_mfma_f32_16x16x32_bf16 v[208:211], a[60:63], a[0:3], v[208:211]
    buffer_load_dwordx4 v25, s[16:19], s80 offen offset:1024 lds
    v_mfma_f32_16x16x32_bf16 v[224:227], a[64:67], a[0:3], v[224:227]
    buffer_load_dwordx4 v26, s[16:19], s80 offen offset:2048 lds
    s_add_u32 s41, s40, 229376
    v_mfma_f32_16x16x32_bf16 v[228:231], a[64:67], a[4:7], v[228:231]
    v_mfma_f32_16x16x32_bf16 v[232:235], a[64:67], a[8:11], v[232:235]
    buffer_load_dwordx4 v27, s[16:19], s80 offen offset:3072 lds
    v_mfma_f32_16x16x32_bf16 v[236:239], a[64:67], a[12:15], v[236:239]
    v_mfma_f32_16x16x32_bf16 v[252:255], a[68:71], a[12:15], v[252:255]
    v_mfma_f32_16x16x32_bf16 v[248:251], a[68:71], a[8:11], v[248:251]
    v_mfma_f32_16x16x32_bf16 v[244:247], a[68:71], a[4:7], v[244:247]
    v_mfma_f32_16x16x32_bf16 v[240:243], a[68:71], a[0:3], v[240:243]
    s_waitcnt vmcnt(16) lgkmcnt(0)
    s_barrier
    v_mfma_f32_16x16x32_bf16 v[32:35], a[88:91], a[72:75], v[32:35]
    ds_read_b128 a[0:3], v7 offset:0
    v_mfma_f32_16x16x32_bf16 v[36:39], a[88:91], a[76:79], v[36:39]
    ds_read_b128 a[4:7], v7 offset:2048
    v_mfma_f32_16x16x32_bf16 v[40:43], a[88:91], a[80:83], v[40:43]
    ds_read_b128 a[8:11], v7 offset:4096
    v_mfma_f32_16x16x32_bf16 v[44:47], a[88:91], a[84:87], v[44:47]
    s_add_u32 s81, s81, 229376
    v_mfma_f32_16x16x32_bf16 v[60:63], a[92:95], a[84:87], v[60:63]
    ds_read_b128 a[12:15], v7 offset:6144
    v_mfma_f32_16x16x32_bf16 v[56:59], a[92:95], a[80:83], v[56:59]
    ds_read_b64_tr_b16 a[16:17], v11 offset:0
    v_mfma_f32_16x16x32_bf16 v[52:55], a[92:95], a[76:79], v[52:55]
    s_add_u32 m0, s39, 49152
    v_mfma_f32_16x16x32_bf16 v[48:51], a[92:95], a[72:75], v[48:51]
    ds_read_b64_tr_b16 a[18:19], v11 offset:1024
    v_mfma_f32_16x16x32_bf16 v[64:67], a[96:99], a[72:75], v[64:67]
    ds_read_b64_tr_b16 a[20:21], v11 offset:2048
    v_mfma_f32_16x16x32_bf16 v[68:71], a[96:99], a[76:79], v[68:71]
    ds_read_b64_tr_b16 a[22:23], v11 offset:3072
    v_mfma_f32_16x16x32_bf16 v[72:75], a[96:99], a[80:83], v[72:75]
    buffer_load_dwordx4 v5, s[20:23], s81 offen offset:0 lds
    v_mfma_f32_16x16x32_bf16 v[76:79], a[96:99], a[84:87], v[76:79]
    ds_read_b64_tr_b16 a[24:25], v11 offset:32
    v_mfma_f32_16x16x32_bf16 v[92:95], a[100:103], a[84:87], v[92:95]
    ds_read_b64_tr_b16 a[26:27], v11 offset:1056
    v_mfma_f32_16x16x32_bf16 v[88:91], a[100:103], a[80:83], v[88:91]
    buffer_load_dwordx4 v6, s[20:23], s81 offen offset:1024 lds
    v_mfma_f32_16x16x32_bf16 v[84:87], a[100:103], a[76:79], v[84:87]
    ds_read_b64_tr_b16 a[28:29], v11 offset:2080
    v_mfma_f32_16x16x32_bf16 v[80:83], a[100:103], a[72:75], v[80:83]
    ds_read_b64_tr_b16 a[30:31], v11 offset:3104
    v_mfma_f32_16x16x32_bf16 v[96:99], a[104:107], a[72:75], v[96:99]
    v_mfma_f32_16x16x32_bf16 v[100:103], a[104:107], a[76:79], v[100:103]
    ds_read_b64_tr_b16 a[32:33], v11 offset:64
    v_mfma_f32_16x16x32_bf16 v[104:107], a[104:107], a[80:83], v[104:107]
    ds_read_b64_tr_b16 a[34:35], v11 offset:1088
    v_mfma_f32_16x16x32_bf16 v[108:111], a[104:107], a[84:87], v[108:111]
    ds_read_b64_tr_b16 a[36:37], v11 offset:2112
    v_mfma_f32_16x16x32_bf16 v[124:127], a[108:111], a[84:87], v[124:127]
    s_add_u32 m0, s39, 51200
    v_mfma_f32_16x16x32_bf16 v[120:123], a[108:111], a[80:83], v[120:123]
    ds_read_b64_tr_b16 a[38:39], v11 offset:3136
    v_mfma_f32_16x16x32_bf16 v[116:119], a[108:111], a[76:79], v[116:119]
    ds_read_b64_tr_b16 a[40:41], v11 offset:96
    v_mfma_f32_16x16x32_bf16 v[112:115], a[108:111], a[72:75], v[112:115]
    buffer_load_dwordx4 v5, s[24:27], s81 offen offset:0 lds
    v_mfma_f32_16x16x32_bf16 v[128:131], a[112:115], a[72:75], v[128:131]
    ds_read_b64_tr_b16 a[42:43], v11 offset:1120
    v_mfma_f32_16x16x32_bf16 v[132:135], a[112:115], a[76:79], v[132:135]
    ds_read_b64_tr_b16 a[44:45], v11 offset:2144
    v_mfma_f32_16x16x32_bf16 v[136:139], a[112:115], a[80:83], v[136:139]
    ds_read_b64_tr_b16 a[46:47], v11 offset:3168
    v_mfma_f32_16x16x32_bf16 v[140:143], a[112:115], a[84:87], v[140:143]
    buffer_load_dwordx4 v6, s[24:27], s81 offen offset:1024 lds
    v_mfma_f32_16x16x32_bf16 v[156:159], a[116:119], a[84:87], v[156:159]
    ds_read_b64_tr_b16 a[48:49], v11 offset:128
    v_mfma_f32_16x16x32_bf16 v[152:155], a[116:119], a[80:83], v[152:155]
    ds_read_b64_tr_b16 a[50:51], v11 offset:1152
    v_mfma_f32_16x16x32_bf16 v[148:151], a[116:119], a[76:79], v[148:151]
    v_mfma_f32_16x16x32_bf16 v[144:147], a[116:119], a[72:75], v[144:147]
    ds_read_b64_tr_b16 a[52:53], v11 offset:2176
    v_mfma_f32_16x16x32_bf16 v[160:163], a[120:123], a[72:75], v[160:163]
    ds_read_b64_tr_b16 a[54:55], v11 offset:3200
    v_mfma_f32_16x16x32_bf16 v[164:167], a[120:123], a[76:79], v[164:167]
    s_bfe_u32 s80, s61, 262168
    v_mfma_f32_16x16x32_bf16 v[168:171], a[120:123], a[80:83], v[168:171]
    ds_read_b64_tr_b16 a[56:57], v11 offset:160
    v_mfma_f32_16x16x32_bf16 v[172:175], a[120:123], a[84:87], v[172:175]
    ds_read_b64_tr_b16 a[58:59], v11 offset:1184
    v_mfma_f32_16x16x32_bf16 v[188:191], a[124:127], a[84:87], v[188:191]
    ds_read_b64_tr_b16 a[60:61], v11 offset:2208
    v_mfma_f32_16x16x32_bf16 v[184:187], a[124:127], a[80:83], v[184:187]
    s_lshl_b32 s80, s80, 7
    v_mfma_f32_16x16x32_bf16 v[180:183], a[124:127], a[76:79], v[180:183]
    ds_read_b64_tr_b16 a[62:63], v11 offset:3232
    v_mfma_f32_16x16x32_bf16 v[176:179], a[124:127], a[72:75], v[176:179]
    ds_read_b64_tr_b16 a[64:65], v11 offset:192
    v_mfma_f32_16x16x32_bf16 v[192:195], a[128:131], a[72:75], v[192:195]
    s_add_u32 s80, s80, s35
    v_mfma_f32_16x16x32_bf16 v[196:199], a[128:131], a[76:79], v[196:199]
    ds_read_b64_tr_b16 a[66:67], v11 offset:1216
    v_mfma_f32_16x16x32_bf16 v[200:203], a[128:131], a[80:83], v[200:203]
    ds_read_b64_tr_b16 a[68:69], v11 offset:2240
    v_mfma_f32_16x16x32_bf16 v[204:207], a[128:131], a[84:87], v[204:207]
    s_add_u32 m0, s38, 65536
    v_mfma_f32_16x16x32_bf16 v[220:223], a[132:135], a[84:87], v[220:223]
    ds_read_b64_tr_b16 a[70:71], v11 offset:3264
    v_mfma_f32_16x16x32_bf16 v[216:219], a[132:135], a[80:83], v[216:219]
    v_mfma_f32_16x16x32_bf16 v[212:215], a[132:135], a[76:79], v[212:215]
    buffer_load_dwordx4 v1, s[16:19], s80 offen offset:0 lds
    v_mfma_f32_16x16x32_bf16 v[208:211], a[132:135], a[72:75], v[208:211]
    buffer_load_dwordx4 v2, s[16:19], s80 offen offset:1024 lds
    v_mfma_f32_16x16x32_bf16 v[224:227], a[136:139], a[72:75], v[224:227]
    buffer_load_dwordx4 v3, s[16:19], s80 offen offset:2048 lds
    v_mfma_f32_16x16x32_bf16 v[228:231], a[136:139], a[76:79], v[228:231]
    v_mfma_f32_16x16x32_bf16 v[232:235], a[136:139], a[80:83], v[232:235]
    buffer_load_dwordx4 v4, s[16:19], s80 offen offset:3072 lds
    v_mfma_f32_16x16x32_bf16 v[236:239], a[136:139], a[84:87], v[236:239]
    v_mfma_f32_16x16x32_bf16 v[252:255], a[140:143], a[84:87], v[252:255]
    v_mfma_f32_16x16x32_bf16 v[248:251], a[140:143], a[80:83], v[248:251]
    v_mfma_f32_16x16x32_bf16 v[244:247], a[140:143], a[76:79], v[244:247]
    v_mfma_f32_16x16x32_bf16 v[240:243], a[140:143], a[72:75], v[240:243]
    s_waitcnt vmcnt(20) lgkmcnt(0)
    s_barrier
    v_mfma_f32_16x16x32_bf16 v[32:35], a[16:19], a[0:3], v[32:35]
    ds_read_b128 a[72:75], v9 offset:0
    v_mfma_f32_16x16x32_bf16 v[36:39], a[16:19], a[4:7], v[36:39]
    ds_read_b128 a[76:79], v9 offset:2048
    v_mfma_f32_16x16x32_bf16 v[40:43], a[16:19], a[8:11], v[40:43]
    ds_read_b128 a[80:83], v9 offset:4096
    v_mfma_f32_16x16x32_bf16 v[44:47], a[16:19], a[12:15], v[44:47]
    s_bfe_u32 s81, s61, 262168
    v_mfma_f32_16x16x32_bf16 v[60:63], a[20:23], a[12:15], v[60:63]
    ds_read_b128 a[84:87], v9 offset:6144
    v_mfma_f32_16x16x32_bf16 v[56:59], a[20:23], a[8:11], v[56:59]
    ds_read_b64_tr_b16 a[88:89], v11 offset:16384
    v_mfma_f32_16x16x32_bf16 v[52:55], a[20:23], a[4:7], v[52:55]
    s_mul_i32 s81, s81, 458752
    v_mfma_f32_16x16x32_bf16 v[48:51], a[20:23], a[0:3], v[48:51]
    ds_read_b64_tr_b16 a[90:91], v11 offset:17408
    v_mfma_f32_16x16x32_bf16 v[64:67], a[24:27], a[0:3], v[64:67]
    ds_read_b64_tr_b16 a[92:93], v11 offset:18432
    v_mfma_f32_16x16x32_bf16 v[68:71], a[24:27], a[4:7], v[68:71]
    ds_read_b64_tr_b16 a[94:95], v11 offset:19456
    v_mfma_f32_16x16x32_bf16 v[72:75], a[24:27], a[8:11], v[72:75]
    s_add_u32 s81, s81, s37
    v_mfma_f32_16x16x32_bf16 v[76:79], a[24:27], a[12:15], v[76:79]
    ds_read_b64_tr_b16 a[96:97], v11 offset:16416
    v_mfma_f32_16x16x32_bf16 v[92:95], a[28:31], a[12:15], v[92:95]
    ds_read_b64_tr_b16 a[98:99], v11 offset:17440
    v_mfma_f32_16x16x32_bf16 v[88:91], a[28:31], a[8:11], v[88:91]
    v_mfma_f32_16x16x32_bf16 v[84:87], a[28:31], a[4:7], v[84:87]
    ds_read_b64_tr_b16 a[100:101], v11 offset:18464
    v_mfma_f32_16x16x32_bf16 v[80:83], a[28:31], a[0:3], v[80:83]
    ds_read_b64_tr_b16 a[102:103], v11 offset:19488
    v_mfma_f32_16x16x32_bf16 v[96:99], a[32:35], a[0:3], v[96:99]
    s_add_u32 m0, s39, 0
    v_mfma_f32_16x16x32_bf16 v[100:103], a[32:35], a[4:7], v[100:103]
    ds_read_b64_tr_b16 a[104:105], v11 offset:16448
    v_mfma_f32_16x16x32_bf16 v[104:107], a[32:35], a[8:11], v[104:107]
    ds_read_b64_tr_b16 a[106:107], v11 offset:17472
    v_mfma_f32_16x16x32_bf16 v[108:111], a[32:35], a[12:15], v[108:111]
    ds_read_b64_tr_b16 a[108:109], v11 offset:18496
    v_mfma_f32_16x16x32_bf16 v[124:127], a[36:39], a[12:15], v[124:127]
    buffer_load_dwordx4 v5, s[20:23], s81 offen offset:0 lds
    v_mfma_f32_16x16x32_bf16 v[120:123], a[36:39], a[8:11], v[120:123]
    ds_read_b64_tr_b16 a[110:111], v11 offset:19520
    v_mfma_f32_16x16x32_bf16 v[116:119], a[36:39], a[4:7], v[116:119]
    ds_read_b64_tr_b16 a[112:113], v11 offset:16480
    v_mfma_f32_16x16x32_bf16 v[112:115], a[36:39], a[0:3], v[112:115]
    buffer_load_dwordx4 v6, s[20:23], s81 offen offset:1024 lds
    v_mfma_f32_16x16x32_bf16 v[128:131], a[40:43], a[0:3], v[128:131]
    ds_read_b64_tr_b16 a[114:115], v11 offset:17504
    v_mfma_f32_16x16x32_bf16 v[132:135], a[40:43], a[4:7], v[132:135]
    ds_read_b64_tr_b16 a[116:117], v11 offset:18528
    v_mfma_f32_16x16x32_bf16 v[136:139], a[40:43], a[8:11], v[136:139]
    ds_read_b64_tr_b16 a[118:119], v11 offset:19552
    v_mfma_f32_16x16x32_bf16 v[140:143], a[40:43], a[12:15], v[140:143]
    v_mfma_f32_16x16x32_bf16 v[156:159], a[44:47], a[12:15], v[156:159]
    ds_read_b64_tr_b16 a[120:121], v11 offset:16512
    v_mfma_f32_16x16x32_bf16 v[152:155], a[44:47], a[8:11], v[152:155]
    ds_read_b64_tr_b16 a[122:123], v11 offset:17536
    v_mfma_f32_16x16x32_bf16 v[148:151], a[44:47], a[4:7], v[148:151]
    s_add_u32 m0, s39, 2048
    v_mfma_f32_16x16x32_bf16 v[144:147], a[44:47], a[0:3], v[144:147]
    ds_read_b64_tr_b16 a[124:125], v11 offset:18560
    v_mfma_f32_16x16x32_bf16 v[160:163], a[48:51], a[0:3], v[160:163]
    ds_read_b64_tr_b16 a[126:127], v11 offset:19584
    v_mfma_f32_16x16x32_bf16 v[164:167], a[48:51], a[4:7], v[164:167]
    buffer_load_dwordx4 v5, s[24:27], s81 offen offset:0 lds
    v_mfma_f32_16x16x32_bf16 v[168:171], a[48:51], a[8:11], v[168:171]
    ds_read_b64_tr_b16 a[128:129], v11 offset:16544
    v_mfma_f32_16x16x32_bf16 v[172:175], a[48:51], a[12:15], v[172:175]
    ds_read_b64_tr_b16 a[130:131], v11 offset:17568
    v_mfma_f32_16x16x32_bf16 v[188:191], a[52:55], a[12:15], v[188:191]
    ds_read_b64_tr_b16 a[132:133], v11 offset:18592
    v_mfma_f32_16x16x32_bf16 v[184:187], a[52:55], a[8:11], v[184:187]
    v_mfma_f32_16x16x32_bf16 v[180:183], a[52:55], a[4:7], v[180:183]
    ds_read_b64_tr_b16 a[134:135], v11 offset:19616
    v_mfma_f32_16x16x32_bf16 v[176:179], a[52:55], a[0:3], v[176:179]
    ds_read_b64_tr_b16 a[136:137], v11 offset:16576
    v_mfma_f32_16x16x32_bf16 v[192:195], a[56:59], a[0:3], v[192:195]
    buffer_load_dwordx4 v6, s[24:27], s81 offen offset:1024 lds
    v_mfma_f32_16x16x32_bf16 v[196:199], a[56:59], a[4:7], v[196:199]
    ds_read_b64_tr_b16 a[138:139], v11 offset:17600
    v_mfma_f32_16x16x32_bf16 v[200:203], a[56:59], a[8:11], v[200:203]
    ds_read_b64_tr_b16 a[140:141], v11 offset:18624
    v_mfma_f32_16x16x32_bf16 v[204:207], a[56:59], a[12:15], v[204:207]
    s_add_u32 m0, s38, 69632
    v_mfma_f32_16x16x32_bf16 v[220:223], a[60:63], a[12:15], v[220:223]
    ds_read_b64_tr_b16 a[142:143], v11 offset:19648
    v_mfma_f32_16x16x32_bf16 v[216:219], a[60:63], a[8:11], v[216:219]
    buffer_load_dwordx4 v24, s[16:19], s80 offen offset:0 lds
    v_mfma_f32_16x16x32_bf16 v[212:215], a[60:63], a[4:7], v[212:215]
    v_mfma_f32_16x16x32_bf16 v[208:211], a[60:63], a[0:3], v[208:211]
    buffer_load_dwordx4 v25, s[16:19], s80 offen offset:1024 lds
    v_mfma_f32_16x16x32_bf16 v[224:227], a[64:67], a[0:3], v[224:227]
    buffer_load_dwordx4 v26, s[16:19], s80 offen offset:2048 lds
    v_mfma_f32_16x16x32_bf16 v[228:231], a[64:67], a[4:7], v[228:231]
    v_mfma_f32_16x16x32_bf16 v[232:235], a[64:67], a[8:11], v[232:235]
    buffer_load_dwordx4 v27, s[16:19], s80 offen offset:3072 lds
    v_mfma_f32_16x16x32_bf16 v[236:239], a[64:67], a[12:15], v[236:239]
    v_mfma_f32_16x16x32_bf16 v[252:255], a[68:71], a[12:15], v[252:255]
    buffer_load_dword v29, v30, s[88:91], 0 offen sc1
    v_mfma_f32_16x16x32_bf16 v[248:251], a[68:71], a[8:11], v[248:251]
    v_mfma_f32_16x16x32_bf16 v[244:247], a[68:71], a[4:7], v[244:247]
    v_mfma_f32_16x16x32_bf16 v[240:243], a[68:71], a[0:3], v[240:243]
    s_waitcnt vmcnt(17) lgkmcnt(0)
    s_barrier
    v_mfma_f32_16x16x32_bf16 v[32:35], a[88:91], a[72:75], v[32:35]
    ds_read_b128 a[0:3], v7 offset:32768
    v_mfma_f32_16x16x32_bf16 v[36:39], a[88:91], a[76:79], v[36:39]
    ds_read_b128 a[4:7], v7 offset:34816
    v_mfma_f32_16x16x32_bf16 v[40:43], a[88:91], a[80:83], v[40:43]
    ds_read_b128 a[8:11], v7 offset:36864
    v_mfma_f32_16x16x32_bf16 v[44:47], a[88:91], a[84:87], v[44:47]
    s_add_u32 s81, s81, 229376
    v_mfma_f32_16x16x32_bf16 v[60:63], a[92:95], a[84:87], v[60:63]
    ds_read_b128 a[12:15], v7 offset:38912
    v_mfma_f32_16x16x32_bf16 v[56:59], a[92:95], a[80:83], v[56:59]
    ds_read_b64_tr_b16 a[16:17], v11 offset:32768
    v_mfma_f32_16x16x32_bf16 v[52:55], a[92:95], a[76:79], v[52:55]
    s_add_u32 m0, s39, 16384
    v_mfma_f32_16x16x32_bf16 v[48:51], a[92:95], a[72:75], v[48:51]
    ds_read_b64_tr_b16 a[18:19], v11 offset:33792
    v_mfma_f32_16x16x32_bf16 v[64:67], a[96:99], a[72:75], v[64:67]
    ds_read_b64_tr_b16 a[20:21], v11 offset:34816
    v_mfma_f32_16x16x32_bf16 v[68:71], a[96:99], a[76:79], v[68:71]
    ds_read_b64_tr_b16 a[22:23], v11 offset:35840
    v_mfma_f32_16x16x32_bf16 v[72:75], a[96:99], a[80:83], v[72:75]
    buffer_load_dwordx4 v5, s[20:23], s81 offen offset:0 lds
    v_mfma_f32_16x16x32_bf16 v[76:79], a[96:99], a[84:87], v[76:79]
    ds_read_b64_tr_b16 a[24:25], v11 offset:32800
    v_mfma_f32_16x16x32_bf16 v[92:95], a[100:103], a[84:87], v[92:95]
    ds_read_b64_tr_b16 a[26:27], v11 offset:33824
    v_mfma_f32_16x16x32_bf16 v[88:91], a[100:103], a[80:83], v[88:91]
    buffer_load_dwordx4 v6, s[20:23], s81 offen offset:1024 lds
    v_mfma_f32_16x16x32_bf16 v[84:87], a[100:103], a[76:79], v[84:87]
    ds_read_b64_tr_b16 a[28:29], v11 offset:34848
    v_mfma_f32_16x16x32_bf16 v[80:83], a[100:103], a[72:75], v[80:83]
    ds_read_b64_tr_b16 a[30:31], v11 offset:35872
    v_mfma_f32_16x16x32_bf16 v[96:99], a[104:107], a[72:75], v[96:99]
    v_mfma_f32_16x16x32_bf16 v[100:103], a[104:107], a[76:79], v[100:103]
    ds_read_b64_tr_b16 a[32:33], v11 offset:32832
    v_mfma_f32_16x16x32_bf16 v[104:107], a[104:107], a[80:83], v[104:107]
    ds_read_b64_tr_b16 a[34:35], v11 offset:33856
    v_mfma_f32_16x16x32_bf16 v[108:111], a[104:107], a[84:87], v[108:111]
    ds_read_b64_tr_b16 a[36:37], v11 offset:34880
    v_mfma_f32_16x16x32_bf16 v[124:127], a[108:111], a[84:87], v[124:127]
    s_add_u32 m0, s39, 18432
    v_mfma_f32_16x16x32_bf16 v[120:123], a[108:111], a[80:83], v[120:123]
    ds_read_b64_tr_b16 a[38:39], v11 offset:35904
    v_mfma_f32_16x16x32_bf16 v[116:119], a[108:111], a[76:79], v[116:119]
    ds_read_b64_tr_b16 a[40:41], v11 offset:32864
    v_mfma_f32_16x16x32_bf16 v[112:115], a[108:111], a[72:75], v[112:115]
    buffer_load_dwordx4 v5, s[24:27], s81 offen offset:0 lds
    v_mfma_f32_16x16x32_bf16 v[128:131], a[112:115], a[72:75], v[128:131]
    ds_read_b64_tr_b16 a[42:43], v11 offset:33888
    v_mfma_f32_16x16x32_bf16 v[132:135], a[112:115], a[76:79], v[132:135]
    ds_read_b64_tr_b16 a[44:45], v11 offset:34912
    v_mfma_f32_16x16x32_bf16 v[136:139], a[112:115], a[80:83], v[136:139]
    ds_read_b64_tr_b16 a[46:47], v11 offset:35936
    v_mfma_f32_16x16x32_bf16 v[140:143], a[112:115], a[84:87], v[140:143]
    buffer_load_dwordx4 v6, s[24:27], s81 offen offset:1024 lds
    v_mfma_f32_16x16x32_bf16 v[156:159], a[116:119], a[84:87], v[156:159]
    ds_read_b64_tr_b16 a[48:49], v11 offset:32896
    v_mfma_f32_16x16x32_bf16 v[152:155], a[116:119], a[80:83], v[152:155]
    ds_read_b64_tr_b16 a[50:51], v11 offset:33920
    v_mfma_f32_16x16x32_bf16 v[148:151], a[116:119], a[76:79], v[148:151]
    v_mfma_f32_16x16x32_bf16 v[144:147], a[116:119], a[72:75], v[144:147]
    ds_read_b64_tr_b16 a[52:53], v11 offset:34944
    v_mfma_f32_16x16x32_bf16 v[160:163], a[120:123], a[72:75], v[160:163]
    ds_read_b64_tr_b16 a[54:55], v11 offset:35968
    v_mfma_f32_16x16x32_bf16 v[164:167], a[120:123], a[76:79], v[164:167]
    s_bfe_u32 s80, s61, 262172
    v_mfma_f32_16x16x32_bf16 v[168:171], a[120:123], a[80:83], v[168:171]
    ds_read_b64_tr_b16 a[56:57], v11 offset:32928
    v_mfma_f32_16x16x32_bf16 v[172:175], a[120:123], a[84:87], v[172:175]
    ds_read_b64_tr_b16 a[58:59], v11 offset:33952
    v_mfma_f32_16x16x32_bf16 v[188:191], a[124:127], a[84:87], v[188:191]
    ds_read_b64_tr_b16 a[60:61], v11 offset:34976
    v_mfma_f32_16x16x32_bf16 v[184:187], a[124:127], a[80:83], v[184:187]
    s_lshl_b32 s80, s80, 7
    v_mfma_f32_16x16x32_bf16 v[180:183], a[124:127], a[76:79], v[180:183]
    ds_read_b64_tr_b16 a[62:63], v11 offset:36000
    v_mfma_f32_16x16x32_bf16 v[176:179], a[124:127], a[72:75], v[176:179]
    ds_read_b64_tr_b16 a[64:65], v11 offset:32960
    v_mfma_f32_16x16x32_bf16 v[192:195], a[128:131], a[72:75], v[192:195]
    s_add_u32 s80, s80, s35
    v_mfma_f32_16x16x32_bf16 v[196:199], a[128:131], a[76:79], v[196:199]
    ds_read_b64_tr_b16 a[66:67], v11 offset:33984
    v_mfma_f32_16x16x32_bf16 v[200:203], a[128:131], a[80:83], v[200:203]
    ds_read_b64_tr_b16 a[68:69], v11 offset:35008
    v_mfma_f32_16x16x32_bf16 v[204:207], a[128:131], a[84:87], v[204:207]
    s_add_u32 m0, s38, 0
    v_mfma_f32_16x16x32_bf16 v[220:223], a[132:135], a[84:87], v[220:223]
    ds_read_b64_tr_b16 a[70:71], v11 offset:36032
    v_mfma_f32_16x16x32_bf16 v[216:219], a[132:135], a[80:83], v[216:219]
    v_mfma_f32_16x16x32_bf16 v[212:215], a[132:135], a[76:79], v[212:215]
    buffer_load_dwordx4 v1, s[16:19], s80 offen offset:0 lds
    v_mfma_f32_16x16x32_bf16 v[208:211], a[132:135], a[72:75], v[208:211]
    buffer_load_dwordx4 v2, s[16:19], s80 offen offset:1024 lds
    v_mfma_f32_16x16x32_bf16 v[224:227], a[136:139], a[72:75], v[224:227]
    buffer_load_dwordx4 v3, s[16:19], s80 offen offset:2048 lds
    v_mfma_f32_16x16x32_bf16 v[228:231], a[136:139], a[76:79], v[228:231]
    v_mfma_f32_16x16x32_bf16 v[232:235], a[136:139], a[80:83], v[232:235]
    buffer_load_dwordx4 v4, s[16:19], s80 offen offset:3072 lds
    v_mfma_f32_16x16x32_bf16 v[236:239], a[136:139], a[84:87], v[236:239]
    v_mfma_f32_16x16x32_bf16 v[252:255], a[140:143], a[84:87], v[252:255]
    v_mfma_f32_16x16x32_bf16 v[248:251], a[140:143], a[80:83], v[248:251]
    v_mfma_f32_16x16x32_bf16 v[244:247], a[140:143], a[76:79], v[244:247]
    v_mfma_f32_16x16x32_bf16 v[240:243], a[140:143], a[72:75], v[240:243]
    s_waitcnt vmcnt(21) lgkmcnt(0)
    s_barrier
    v_mfma_f32_16x16x32_bf16 v[32:35], a[16:19], a[0:3], v[32:35]
    ds_read_b128 a[72:75], v9 offset:32768
    v_mfma_f32_16x16x32_bf16 v[36:39], a[16:19], a[4:7], v[36:39]
    ds_read_b128 a[76:79], v9 offset:34816
    v_mfma_f32_16x16x32_bf16 v[40:43], a[16:19], a[8:11], v[40:43]
    ds_read_b128 a[80:83], v9 offset:36864
    v_mfma_f32_16x16x32_bf16 v[44:47], a[16:19], a[12:15], v[44:47]
    s_bfe_u32 s81, s61, 262172
    v_mfma_f32_16x16x32_bf16 v[60:63], a[20:23], a[12:15], v[60:63]
    ds_read_b128 a[84:87], v9 offset:38912
    v_mfma_f32_16x16x32_bf16 v[56:59], a[20:23], a[8:11], v[56:59]
    ds_read_b64_tr_b16 a[88:89], v11 offset:49152
    v_mfma_f32_16x16x32_bf16 v[52:55], a[20:23], a[4:7], v[52:55]
    s_mul_i32 s81, s81, 458752
    v_mfma_f32_16x16x32_bf16 v[48:51], a[20:23], a[0:3], v[48:51]
    ds_read_b64_tr_b16 a[90:91], v11 offset:50176
    v_mfma_f32_16x16x32_bf16 v[64:67], a[24:27], a[0:3], v[64:67]
    ds_read_b64_tr_b16 a[92:93], v11 offset:51200
    v_mfma_f32_16x16x32_bf16 v[68:71], a[24:27], a[4:7], v[68:71]
    ds_read_b64_tr_b16 a[94:95], v11 offset:52224
    v_mfma_f32_16x16x32_bf16 v[72:75], a[24:27], a[8:11], v[72:75]
    s_add_u32 s81, s81, s37
    v_mfma_f32_16x16x32_bf16 v[76:79], a[24:27], a[12:15], v[76:79]
    ds_read_b64_tr_b16 a[96:97], v11 offset:49184
    v_mfma_f32_16x16x32_bf16 v[92:95], a[28:31], a[12:15], v[92:95]
    ds_read_b64_tr_b16 a[98:99], v11 offset:50208
    v_mfma_f32_16x16x32_bf16 v[88:91], a[28:31], a[8:11], v[88:91]
    v_mfma_f32_16x16x32_bf16 v[84:87], a[28:31], a[4:7], v[84:87]
    ds_read_b64_tr_b16 a[100:101], v11 offset:51232
    v_mfma_f32_16x16x32_bf16 v[80:83], a[28:31], a[0:3], v[80:83]
    ds_read_b64_tr_b16 a[102:103], v11 offset:52256
    v_mfma_f32_16x16x32_bf16 v[96:99], a[32:35], a[0:3], v[96:99]
    s_add_u32 m0, s39, 32768
    v_mfma_f32_16x16x32_bf16 v[100:103], a[32:35], a[4:7], v[100:103]
    ds_read_b64_tr_b16 a[104:105], v11 offset:49216
    v_mfma_f32_16x16x32_bf16 v[104:107], a[32:35], a[8:11], v[104:107]
    ds_read_b64_tr_b16 a[106:107], v11 offset:50240
    v_mfma_f32_16x16x32_bf16 v[108:111], a[32:35], a[12:15], v[108:111]
    ds_read_b64_tr_b16 a[108:109], v11 offset:51264
    v_mfma_f32_16x16x32_bf16 v[124:127], a[36:39], a[12:15], v[124:127]
    buffer_load_dwordx4 v5, s[20:23], s81 offen offset:0 lds
    v_mfma_f32_16x16x32_bf16 v[120:123], a[36:39], a[8:11], v[120:123]
    ds_read_b64_tr_b16 a[110:111], v11 offset:52288
    v_mfma_f32_16x16x32_bf16 v[116:119], a[36:39], a[4:7], v[116:119]
    ds_read_b64_tr_b16 a[112:113], v11 offset:49248
    v_mfma_f32_16x16x32_bf16 v[112:115], a[36:39], a[0:3], v[112:115]
    buffer_load_dwordx4 v6, s[20:23], s81 offen offset:1024 lds
    v_mfma_f32_16x16x32_bf16 v[128:131], a[40:43], a[0:3], v[128:131]
    ds_read_b64_tr_b16 a[114:115], v11 offset:50272
    v_mfma_f32_16x16x32_bf16 v[132:135], a[40:43], a[4:7], v[132:135]
    ds_read_b64_tr_b16 a[116:117], v11 offset:51296
    v_mfma_f32_16x16x32_bf16 v[136:139], a[40:43], a[8:11], v[136:139]
    ds_read_b64_tr_b16 a[118:119], v11 offset:52320
    v_mfma_f32_16x16x32_bf16 v[140:143], a[40:43], a[12:15], v[140:143]
    v_mfma_f32_16x16x32_bf16 v[156:159], a[44:47], a[12:15], v[156:159]
    ds_read_b64_tr_b16 a[120:121], v11 offset:49280
    v_mfma_f32_16x16x32_bf16 v[152:155], a[44:47], a[8:11], v[152:155]
    ds_read_b64_tr_b16 a[122:123], v11 offset:50304
    v_mfma_f32_16x16x32_bf16 v[148:151], a[44:47], a[4:7], v[148:151]
    s_add_u32 m0, s39, 34816
    v_mfma_f32_16x16x32_bf16 v[144:147], a[44:47], a[0:3], v[144:147]
    ds_read_b64_tr_b16 a[124:125], v11 offset:51328
    v_mfma_f32_16x16x32_bf16 v[160:163], a[48:51], a[0:3], v[160:163]
    ds_read_b64_tr_b16 a[126:127], v11 offset:52352
    v_mfma_f32_16x16x32_bf16 v[164:167], a[48:51], a[4:7], v[164:167]
    buffer_load_dwordx4 v5, s[24:27], s81 offen offset:0 lds
    v_mfma_f32_16x16x32_bf16 v[168:171], a[48:51], a[8:11], v[168:171]
    ds_read_b64_tr_b16 a[128:129], v11 offset:49312
    v_mfma_f32_16x16x32_bf16 v[172:175], a[48:51], a[12:15], v[172:175]
    ds_read_b64_tr_b16 a[130:131], v11 offset:50336
    v_mfma_f32_16x16x32_bf16 v[188:191], a[52:55], a[12:15], v[188:191]
    ds_read_b64_tr_b16 a[132:133], v11 offset:51360
    v_mfma_f32_16x16x32_bf16 v[184:187], a[52:55], a[8:11], v[184:187]
    v_mfma_f32_16x16x32_bf16 v[180:183], a[52:55], a[4:7], v[180:183]
    ds_read_b64_tr_b16 a[134:135], v11 offset:52384
    v_mfma_f32_16x16x32_bf16 v[176:179], a[52:55], a[0:3], v[176:179]
    ds_read_b64_tr_b16 a[136:137], v11 offset:49344
    v_mfma_f32_16x16x32_bf16 v[192:195], a[56:59], a[0:3], v[192:195]
    buffer_load_dwordx4 v6, s[24:27], s81 offen offset:1024 lds
    v_mfma_f32_16x16x32_bf16 v[196:199], a[56:59], a[4:7], v[196:199]
    ds_read_b64_tr_b16 a[138:139], v11 offset:50368
    v_mfma_f32_16x16x32_bf16 v[200:203], a[56:59], a[8:11], v[200:203]
    ds_read_b64_tr_b16 a[140:141], v11 offset:51392
    v_mfma_f32_16x16x32_bf16 v[204:207], a[56:59], a[12:15], v[204:207]
    s_add_u32 m0, s38, 4096
    v_mfma_f32_16x16x32_bf16 v[220:223], a[60:63], a[12:15], v[220:223]
    ds_read_b64_tr_b16 a[142:143], v11 offset:52416
    v_mfma_f32_16x16x32_bf16 v[216:219], a[60:63], a[8:11], v[216:219]
    buffer_load_dwordx4 v24, s[16:19], s80 offen offset:0 lds
    v_mfma_f32_16x16x32_bf16 v[212:215], a[60:63], a[4:7], v[212:215]
    v_mfma_f32_16x16x32_bf16 v[208:211], a[60:63], a[0:3], v[208:211]
    buffer_load_dwordx4 v25, s[16:19], s80 offen offset:1024 lds
    v_mfma_f32_16x16x32_bf16 v[224:227], a[64:67], a[0:3], v[224:227]
    buffer_load_dwordx4 v26, s[16:19], s80 offen offset:2048 lds
    v_mfma_f32_16x16x32_bf16 v[228:231], a[64:67], a[4:7], v[228:231]
    v_mfma_f32_16x16x32_bf16 v[232:235], a[64:67], a[8:11], v[232:235]
    buffer_load_dwordx4 v27, s[16:19], s80 offen offset:3072 lds
    v_mfma_f32_16x16x32_bf16 v[236:239], a[64:67], a[12:15], v[236:239]
    v_mfma_f32_16x16x32_bf16 v[252:255], a[68:71], a[12:15], v[252:255]
    v_mfma_f32_16x16x32_bf16 v[248:251], a[68:71], a[8:11], v[248:251]
    v_mfma_f32_16x16x32_bf16 v[244:247], a[68:71], a[4:7], v[244:247]
    v_mfma_f32_16x16x32_bf16 v[240:243], a[68:71], a[0:3], v[240:243]
    s_waitcnt vmcnt(17) lgkmcnt(0)
    s_barrier
    v_mfma_f32_16x16x32_bf16 v[32:35], a[88:91], a[72:75], v[32:35]
    ds_read_b128 a[0:3], v8 offset:0
    v_mfma_f32_16x16x32_bf16 v[36:39], a[88:91], a[76:79], v[36:39]
    s_add_u32 s81, s81, 229376
    v_mfma_f32_16x16x32_bf16 v[40:43], a[88:91], a[80:83], v[40:43]
    ds_read_b128 a[4:7], v8 offset:2048
    v_mfma_f32_16x16x32_bf16 v[44:47], a[88:91], a[84:87], v[44:47]
    s_add_u32 m0, s39, 49152
    v_mfma_f32_16x16x32_bf16 v[60:63], a[92:95], a[84:87], v[60:63]
    v_mfma_f32_16x16x32_bf16 v[56:59], a[92:95], a[80:83], v[56:59]
    ds_read_b128 a[8:11], v8 offset:4096
    v_mfma_f32_16x16x32_bf16 v[52:55], a[92:95], a[76:79], v[52:55]
    buffer_load_dwordx4 v5, s[20:23], s81 offen offset:0 lds
    v_mfma_f32_16x16x32_bf16 v[48:51], a[92:95], a[72:75], v[48:51]
    v_mfma_f32_16x16x32_bf16 v[64:67], a[96:99], a[72:75], v[64:67]
    ds_read_b128 a[12:15], v8 offset:6144
    v_mfma_f32_16x16x32_bf16 v[68:71], a[96:99], a[76:79], v[68:71]
    buffer_load_dwordx4 v6, s[20:23], s81 offen offset:1024 lds
    v_mfma_f32_16x16x32_bf16 v[72:75], a[96:99], a[80:83], v[72:75]
    v_mfma_f32_16x16x32_bf16 v[76:79], a[96:99], a[84:87], v[76:79]
    ds_read_b64_tr_b16 a[144:145], v11 offset:0
    v_mfma_f32_16x16x32_bf16 v[92:95], a[100:103], a[84:87], v[92:95]
    s_add_u32 m0, s39, 51200
    v_mfma_f32_16x16x32_bf16 v[88:91], a[100:103], a[80:83], v[88:91]
    v_mfma_f32_16x16x32_bf16 v[84:87], a[100:103], a[76:79], v[84:87]
    ds_read_b64_tr_b16 a[146:147], v11 offset:1024
    v_mfma_f32_16x16x32_bf16 v[80:83], a[100:103], a[72:75], v[80:83]
    buffer_load_dwordx4 v5, s[24:27], s81 offen offset:0 lds
    v_mfma_f32_16x16x32_bf16 v[96:99], a[104:107], a[72:75], v[96:99]
    v_mfma_f32_16x16x32_bf16 v[100:103], a[104:107], a[76:79], v[100:103]
    ds_read_b64_tr_b16 a[148:149], v11 offset:2048
    v_mfma_f32_16x16x32_bf16 v[104:107], a[104:107], a[80:83], v[104:107]
    buffer_load_dwordx4 v6, s[24:27], s81 offen offset:1024 lds
    v_mfma_f32_16x16x32_bf16 v[108:111], a[104:107], a[84:87], v[108:111]
    v_mfma_f32_16x16x32_bf16 v[124:127], a[108:111], a[84:87], v[124:127]
    ds_read_b64_tr_b16 a[150:151], v11 offset:3072
    v_mfma_f32_16x16x32_bf16 v[120:123], a[108:111], a[80:83], v[120:123]
    s_add_u32 m0, s63, 98304
    v_mfma_f32_16x16x32_bf16 v[116:119], a[108:111], a[76:79], v[116:119]
    v_mfma_f32_16x16x32_bf16 v[112:115], a[108:111], a[72:75], v[112:115]
    ds_read_b64_tr_b16 a[152:153], v11 offset:32
    v_mfma_f32_16x16x32_bf16 v[128:131], a[112:115], a[72:75], v[128:131]
    buffer_load_dwordx4 v14, s[52:55], s4 offen lds
    v_mfma_f32_16x16x32_bf16 v[132:135], a[112:115], a[76:79], v[132:135]
    v_mfma_f32_16x16x32_bf16 v[136:139], a[112:115], a[80:83], v[136:139]
    ds_read_b64_tr_b16 a[154:155], v11 offset:1056
    v_mfma_f32_16x16x32_bf16 v[140:143], a[112:115], a[84:87], v[140:143]
    buffer_load_dwordx4 v0, s[52:55], s4 offen offset:1024 lds
    v_mfma_f32_16x16x32_bf16 v[156:159], a[116:119], a[84:87], v[156:159]
    s_add_u32 m0, s63, 106496
    v_mfma_f32_16x16x32_bf16 v[152:155], a[116:119], a[80:83], v[152:155]
    ds_read_b64_tr_b16 a[156:157], v11 offset:2080
    v_mfma_f32_16x16x32_bf16 v[148:151], a[116:119], a[76:79], v[148:151]
    v_mfma_f32_16x16x32_bf16 v[144:147], a[116:119], a[72:75], v[144:147]
    buffer_load_dwordx4 v12, s[52:55], s4 offen lds
    v_mfma_f32_16x16x32_bf16 v[160:163], a[120:123], a[72:75], v[160:163]
    ds_read_b64_tr_b16 a[158:159], v11 offset:3104
    v_mfma_f32_16x16x32_bf16 v[164:167], a[120:123], a[76:79], v[164:167]
    v_mfma_f32_16x16x32_bf16 v[168:171], a[120:123], a[80:83], v[168:171]
    buffer_load_dwordx4 v13, s[52:55], s4 offen offset:1024 lds
    v_mfma_f32_16x16x32_bf16 v[172:175], a[120:123], a[84:87], v[172:175]
    ds_read_b128 a[16:19], v10 offset:0
    v_mfma_f32_16x16x32_bf16 v[188:191], a[124:127], a[84:87], v[188:191]
    v_mfma_f32_16x16x32_bf16 v[184:187], a[124:127], a[80:83], v[184:187]
    s_add_u32 m0, s63, 114688
    v_mfma_f32_16x16x32_bf16 v[180:183], a[124:127], a[76:79], v[180:183]
    ds_read_b128 a[20:23], v10 offset:2048
    v_mfma_f32_16x16x32_bf16 v[176:179], a[124:127], a[72:75], v[176:179]
    v_mfma_f32_16x16x32_bf16 v[192:195], a[128:131], a[72:75], v[192:195]
    buffer_load_dwordx4 v14, s[52:55], s5 offen lds
    v_mfma_f32_16x16x32_bf16 v[196:199], a[128:131], a[76:79], v[196:199]
    ds_read_b128 a[24:27], v10 offset:4096
    v_mfma_f32_16x16x32_bf16 v[200:203], a[128:131], a[80:83], v[200:203]
    v_mfma_f32_16x16x32_bf16 v[204:207], a[128:131], a[84:87], v[204:207]
    buffer_load_dwordx4 v0, s[52:55], s5 offen offset:1024 lds
    v_mfma_f32_16x16x32_bf16 v[220:223], a[132:135], a[84:87], v[220:223]
    ds_read_b128 a[28:31], v10 offset:6144
    v_mfma_f32_16x16x32_bf16 v[216:219], a[132:135], a[80:83], v[216:219]
    v_mfma_f32_16x16x32_bf16 v[212:215], a[132:135], a[76:79], v[212:215]
    s_add_u32 m0, s63, 122880
    v_mfma_f32_16x16x32_bf16 v[208:211], a[132:135], a[72:75], v[208:211]
    v_mfma_f32_16x16x32_bf16 v[224:227], a[136:139], a[72:75], v[224:227]
    buffer_load_dwordx4 v12, s[52:55], s5 offen lds
    v_mfma_f32_16x16x32_bf16 v[228:231], a[136:139], a[76:79], v[228:231]
    v_mfma_f32_16x16x32_bf16 v[232:235], a[136:139], a[80:83], v[232:235]
    buffer_load_dwordx4 v13, s[52:55], s5 offen offset:1024 lds
    v_mfma_f32_16x16x32_bf16 v[236:239], a[136:139], a[84:87], v[236:239]
    v_mfma_f32_16x16x32_bf16 v[252:255], a[140:143], a[84:87], v[252:255]
    v_mfma_f32_16x16x32_bf16 v[248:251], a[140:143], a[80:83], v[248:251]
    v_mfma_f32_16x16x32_bf16 v[244:247], a[140:143], a[76:79], v[244:247]
    v_mfma_f32_16x16x32_bf16 v[240:243], a[140:143], a[72:75], v[240:243]
    s_waitcnt vmcnt(24) lgkmcnt(0)
    s_barrier
    v_mfma_f32_16x16x32_bf16 v[32:35], a[144:147], a[0:3], v[32:35]
    ds_read_b64_tr_b16 a[160:161], v11 offset:16384
    s_add_u32 m0, s63, 131072
    s_lshl_b32 s43, s14, 2
    s_add_u32 s43, s43, s32
    v_mfma_f32_16x16x32_bf16 v[48:51], a[148:151], a[0:3], v[48:51]
    ds_read_b64_tr_b16 a[162:163], v11 offset:17408
    buffer_load_dwordx4 v14, s[52:55], s6 offen lds
    s_mul_i32 s3, s43, 229376
    v_mfma_f32_16x16x32_bf16 v[64:67], a[152:155], a[0:3], v[64:67]
    ds_read_b64_tr_b16 a[164:165], v11 offset:18432
    s_mul_i32 s43, s101, 114688
    v_mfma_f32_16x16x32_bf16 v[80:83], a[156:159], a[0:3], v[80:83]
    ds_read_b64_tr_b16 a[166:167], v11 offset:19456
    s_add_u32 s3, s3, s43
    v_mfma_f32_16x16x32_bf16 v[36:39], a[144:147], a[4:7], v[36:39]
    buffer_load_dwordx4 v0, s[52:55], s6 offen offset:1024 lds
    v_lshlrev_b32 v1, 4, v15
    v_mfma_f32_16x16x32_bf16 v[52:55], a[148:151], a[4:7], v[52:55]
    ds_read_b64_tr_b16 a[168:169], v11 offset:16416
    v_add_u32 v2, s3, v1
    v_mfma_f32_16x16x32_bf16 v[68:71], a[152:155], a[4:7], v[68:71]
    ds_read_b64_tr_b16 a[170:171], v11 offset:17440
    s_add_u32 m0, s63, 139264
    v_mov_b32 v3, 0
    v_mfma_f32_16x16x32_bf16 v[84:87], a[156:159], a[4:7], v[84:87]
    ds_read_b64_tr_b16 a[172:173], v11 offset:18464
    buffer_load_dwordx4 v12, s[52:55], s6 offen lds
    v_mov_b32 v4, 1
    v_mov_b32 v5, 0
    v_mfma_f32_16x16x32_bf16 v[40:43], a[144:147], a[8:11], v[40:43]
    v_and_b32 v6, 15, v15
    v_mfma_f32_16x16x32_bf16 v[56:59], a[148:151], a[8:11], v[56:59]
    ds_read_b64_tr_b16 a[174:175], v11 offset:19488
    v_lshlrev_b32 v6, 2, v6
    v_mfma_f32_16x16x32_bf16 v[72:75], a[152:155], a[8:11], v[72:75]
    buffer_load_dwordx4 v13, s[52:55], s6 offen offset:1024 lds
    s_add_u32 s60, s42, 0
    v_mfma_f32_16x16x32_bf16 v[88:91], a[156:159], a[8:11], v[88:91]
    s_sub_u32 s43, s60, 6
    v_mfma_f32_16x16x32_bf16 v[44:47], a[144:147], a[12:15], v[44:47]
    s_min_u32 s60, s60, s43
    v_mfma_f32_16x16x32_bf16 v[60:63], a[148:151], a[12:15], v[60:63]
    s_sub_u32 s43, s60, 6
    v_mfma_f32_16x16x32_bf16 v[76:79], a[152:155], a[12:15], v[76:79]
    s_min_u32 s60, s60, s43
    v_mfma_f32_16x16x32_bf16 v[92:95], a[156:159], a[12:15], v[92:95]
    s_lshl1_add_u32 s60, s60, 1
    s_waitcnt lgkmcnt(0)
    v_mfma_f32_16x16x32_bf16 v[32:35], a[160:163], a[16:19], v[32:35]
    ds_read_b64_tr_b16 a[144:145], v11 offset:64
    s_add_u32 m0, s63, 147456
    s_add_u32 s43, s60, 1
    s_lshr_b32 s43, s43, 3
    v_mfma_f32_16x16x32_bf16 v[48:51], a[164:167], a[16:19], v[48:51]
    ds_read_b64_tr_b16 a[146:147], v11 offset:1088
    buffer_load_dwordx4 v14, s[52:55], s7 offen lds
    s_add_u32 s60, s60, s43
    v_mfma_f32_16x16x32_bf16 v[64:67], a[168:171], a[16:19], v[64:67]
    ds_read_b64_tr_b16 a[148:149], v11 offset:2112
    s_lshl_b32 s60, s60, 17
    v_mfma_f32_16x16x32_bf16 v[80:83], a[172:175], a[16:19], v[80:83]
    ds_read_b64_tr_b16 a[150:151], v11 offset:3136
    s_add_u32 s61, s42, 1
    v_mfma_f32_16x16x32_bf16 v[36:39], a[160:163], a[20:23], v[36:39]
    buffer_load_dwordx4 v0, s[52:55], s7 offen offset:1024 lds
    s_sub_u32 s43, s61, 6
    v_mfma_f32_16x16x32_bf16 v[52:55], a[164:167], a[20:23], v[52:55]
    ds_read_b64_tr_b16 a[152:153], v11 offset:96
    s_min_u32 s61, s61, s43
    v_mfma_f32_16x16x32_bf16 v[68:71], a[168:171], a[20:23], v[68:71]
    ds_read_b64_tr_b16 a[154:155], v11 offset:1120
    s_add_u32 m0, s63, 155648
    s_sub_u32 s43, s61, 6
    v_mfma_f32_16x16x32_bf16 v[84:87], a[172:175], a[20:23], v[84:87]
    ds_read_b64_tr_b16 a[156:157], v11 offset:2144
    buffer_load_dwordx4 v12, s[52:55], s7 offen lds
    s_min_u32 s61, s61, s43
    s_lshl1_add_u32 s61, s61, 1
    v_mfma_f32_16x16x32_bf16 v[40:43], a[160:163], a[24:27], v[40:43]
    s_add_u32 s43, s61, 1
    v_mfma_f32_16x16x32_bf16 v[56:59], a[164:167], a[24:27], v[56:59]
    ds_read_b64_tr_b16 a[158:159], v11 offset:3168
    s_lshr_b32 s43, s43, 3
    v_mfma_f32_16x16x32_bf16 v[72:75], a[168:171], a[24:27], v[72:75]
    buffer_load_dwordx4 v13, s[52:55], s7 offen offset:1024 lds
    s_add_u32 s61, s61, s43
    v_mfma_f32_16x16x32_bf16 v[88:91], a[172:175], a[24:27], v[88:91]
    s_lshl_b32 s61, s61, 17
    v_mfma_f32_16x16x32_bf16 v[44:47], a[160:163], a[28:31], v[44:47]
    s_add_u32 s38, s42, 2
    v_mfma_f32_16x16x32_bf16 v[60:63], a[164:167], a[28:31], v[60:63]
    s_sub_u32 s43, s38, 6
    v_mfma_f32_16x16x32_bf16 v[76:79], a[168:171], a[28:31], v[76:79]
    s_min_u32 s38, s38, s43
    v_mfma_f32_16x16x32_bf16 v[92:95], a[172:175], a[28:31], v[92:95]
    s_sub_u32 s43, s38, 6
    s_waitcnt lgkmcnt(0)
    v_mfma_f32_16x16x32_bf16 v[96:99], a[144:147], a[0:3], v[96:99]
    ds_read_b64_tr_b16 a[160:161], v11 offset:16448
    s_min_u32 s38, s38, s43
    s_lshl1_add_u32 s38, s38, 1
    v_mfma_f32_16x16x32_bf16 v[112:115], a[148:151], a[0:3], v[112:115]
    ds_read_b64_tr_b16 a[162:163], v11 offset:17472
    s_add_u32 s43, s38, 1
    v_mfma_f32_16x16x32_bf16 v[128:131], a[152:155], a[0:3], v[128:131]
    ds_read_b64_tr_b16 a[164:165], v11 offset:18496
    s_lshr_b32 s43, s43, 3
    v_mfma_f32_16x16x32_bf16 v[144:147], a[156:159], a[0:3], v[144:147]
    ds_read_b64_tr_b16 a[166:167], v11 offset:19520
    s_add_u32 s38, s38, s43
    v_mfma_f32_16x16x32_bf16 v[100:103], a[144:147], a[4:7], v[100:103]
    s_lshl_b32 s38, s38, 17
    v_mfma_f32_16x16x32_bf16 v[116:119], a[148:151], a[4:7], v[116:119]
    ds_read_b64_tr_b16 a[168:169], v11 offset:16480
    s_add_u32 s39, s42, 3
    v_mfma_f32_16x16x32_bf16 v[132:135], a[152:155], a[4:7], v[132:135]
    ds_read_b64_tr_b16 a[170:171], v11 offset:17504
    s_sub_u32 s43, s39, 6
    v_mfma_f32_16x16x32_bf16 v[148:151], a[156:159], a[4:7], v[148:151]
    ds_read_b64_tr_b16 a[172:173], v11 offset:18528
    s_min_u32 s39, s39, s43
    s_sub_u32 s43, s39, 6
    v_mfma_f32_16x16x32_bf16 v[104:107], a[144:147], a[8:11], v[104:107]
    s_min_u32 s39, s39, s43
    v_mfma_f32_16x16x32_bf16 v[120:123], a[148:151], a[8:11], v[120:123]
    ds_read_b64_tr_b16 a[174:175], v11 offset:19552
    s_lshl1_add_u32 s39, s39, 1
    v_mfma_f32_16x16x32_bf16 v[136:139], a[152:155], a[8:11], v[136:139]
    s_add_u32 s43, s39, 1
    v_mfma_f32_16x16x32_bf16 v[152:155], a[156:159], a[8:11], v[152:155]
    s_lshr_b32 s43, s43, 3
    v_mfma_f32_16x16x32_bf16 v[108:111], a[144:147], a[12:15], v[108:111]
    s_add_u32 s39, s39, s43
    v_mfma_f32_16x16x32_bf16 v[124:127], a[148:151], a[12:15], v[124:127]
    s_lshl_b32 s39, s39, 17
    v_mfma_f32_16x16x32_bf16 v[140:143], a[152:155], a[12:15], v[140:143]
    s_add_u32 s80, s42, 4
    v_mfma_f32_16x16x32_bf16 v[156:159], a[156:159], a[12:15], v[156:159]
    s_sub_u32 s43, s80, 6
    s_waitcnt vmcnt(16) lgkmcnt(0)
    s_barrier
    v_mfma_f32_16x16x32_bf16 v[96:99], a[160:163], a[16:19], v[96:99]
    ds_read_b128 a[32:35], v7 offset:0
    ds_read_b128 a[36:39], v7 offset:2048
    s_min_u32 s80, s80, s43
    s_sub_u32 s43, s80, 6
    v_mfma_f32_16x16x32_bf16 v[112:115], a[164:167], a[16:19], v[112:115]
    ds_read_b128 a[40:43], v7 offset:4096
    s_min_u32 s80, s80, s43
    v_mfma_f32_16x16x32_bf16 v[128:131], a[168:171], a[16:19], v[128:131]
    ds_read_b128 a[44:47], v7 offset:6144
    s_lshl1_add_u32 s80, s80, 1
    v_mfma_f32_16x16x32_bf16 v[144:147], a[172:175], a[16:19], v[144:147]
    ds_read_b64_tr_b16 a[144:145], v11 offset:32768
    s_add_u32 s43, s80, 1
    v_mfma_f32_16x16x32_bf16 v[100:103], a[160:163], a[20:23], v[100:103]
    ds_read_b64_tr_b16 a[146:147], v11 offset:33792
    ds_read_b64_tr_b16 a[148:149], v11 offset:34816
    s_lshr_b32 s43, s43, 3
    v_mfma_f32_16x16x32_bf16 v[116:119], a[164:167], a[20:23], v[116:119]
    ds_read_b64_tr_b16 a[150:151], v11 offset:35840
    s_add_u32 s80, s80, s43
    v_mfma_f32_16x16x32_bf16 v[132:135], a[168:171], a[20:23], v[132:135]
    ds_read_b64_tr_b16 a[152:153], v11 offset:32800
    s_lshl_b32 s80, s80, 17
    v_mfma_f32_16x16x32_bf16 v[148:151], a[172:175], a[20:23], v[148:151]
    ds_read_b64_tr_b16 a[154:155], v11 offset:33824
    s_add_u32 s81, s42, 5
    s_sub_u32 s43, s81, 6
    v_mfma_f32_16x16x32_bf16 v[104:107], a[160:163], a[24:27], v[104:107]
    ds_read_b64_tr_b16 a[156:157], v11 offset:34848
    s_min_u32 s81, s81, s43
    v_mfma_f32_16x16x32_bf16 v[120:123], a[164:167], a[24:27], v[120:123]
    ds_read_b64_tr_b16 a[158:159], v11 offset:35872
    s_sub_u32 s43, s81, 6
    v_mfma_f32_16x16x32_bf16 v[136:139], a[168:171], a[24:27], v[136:139]
    s_min_u32 s81, s81, s43
    v_mfma_f32_16x16x32_bf16 v[152:155], a[172:175], a[24:27], v[152:155]
    s_lshl1_add_u32 s81, s81, 1
    v_mfma_f32_16x16x32_bf16 v[108:111], a[160:163], a[28:31], v[108:111]
    s_add_u32 s43, s81, 1
    v_mfma_f32_16x16x32_bf16 v[124:127], a[164:167], a[28:31], v[124:127]
    s_lshr_b32 s43, s43, 3
    v_mfma_f32_16x16x32_bf16 v[140:143], a[168:171], a[28:31], v[140:143]
    s_add_u32 s81, s81, s43
    v_mfma_f32_16x16x32_bf16 v[156:159], a[172:175], a[28:31], v[156:159]
    s_lshl_b32 s81, s81, 17
    s_waitcnt lgkmcnt(0)
    v_mfma_f32_16x16x32_bf16 v[32:35], a[144:147], a[32:35], v[32:35]
    ds_read_b128 a[48:51], v9 offset:0
    ds_read_b128 a[52:55], v9 offset:2048
    s_lshr_b32 s16, s4, 5
    s_lshr_b32 s17, s5, 5
    v_mfma_f32_16x16x32_bf16 v[48:51], a[148:151], a[32:35], v[48:51]
    ds_read_b128 a[56:59], v9 offset:4096
    s_lshr_b32 s18, s6, 5
    v_mfma_f32_16x16x32_bf16 v[64:67], a[152:155], a[32:35], v[64:67]
    ds_read_b128 a[60:63], v9 offset:6144
    s_lshr_b32 s19, s7, 5
    v_mfma_f32_16x16x32_bf16 v[80:83], a[156:159], a[32:35], v[80:83]
    ds_read_b64_tr_b16 a[160:161], v11 offset:49152
    s_lshr_b32 s20, s8, 5
    v_mfma_f32_16x16x32_bf16 v[36:39], a[144:147], a[36:39], v[36:39]
    ds_read_b64_tr_b16 a[162:163], v11 offset:50176
    ds_read_b64_tr_b16 a[164:165], v11 offset:51200
    s_lshr_b32 s21, s9, 5
    v_mfma_f32_16x16x32_bf16 v[52:55], a[148:151], a[36:39], v[52:55]
    ds_read_b64_tr_b16 a[166:167], v11 offset:52224
    s_lshr_b32 s22, s10, 5
    v_mfma_f32_16x16x32_bf16 v[68:71], a[152:155], a[36:39], v[68:71]
    ds_read_b64_tr_b16 a[168:169], v11 offset:49184
    s_lshr_b32 s23, s11, 5
    v_mfma_f32_16x16x32_bf16 v[84:87], a[156:159], a[36:39], v[84:87]
    ds_read_b64_tr_b16 a[170:171], v11 offset:50208
    s_lshr_b32 s24, s60, 5
    s_lshr_b32 s25, s61, 5
    v_mfma_f32_16x16x32_bf16 v[40:43], a[144:147], a[40:43], v[40:43]
    ds_read_b64_tr_b16 a[172:173], v11 offset:51232
    s_lshr_b32 s26, s38, 5
    v_mfma_f32_16x16x32_bf16 v[56:59], a[148:151], a[40:43], v[56:59]
    ds_read_b64_tr_b16 a[174:175], v11 offset:52256
    s_lshr_b32 s27, s39, 5
    v_mfma_f32_16x16x32_bf16 v[72:75], a[152:155], a[40:43], v[72:75]
    s_lshr_b32 s35, s80, 5
    v_mfma_f32_16x16x32_bf16 v[88:91], a[156:159], a[40:43], v[88:91]
    s_lshr_b32 s33, s81, 5
    v_mfma_f32_16x16x32_bf16 v[44:47], a[144:147], a[44:47], v[44:47]
    s_ashr_i32 s36, s59, 5
    v_mfma_f32_16x16x32_bf16 v[60:63], a[148:151], a[44:47], v[60:63]
    s_ashr_i32 s58, s62, 5
    v_mfma_f32_16x16x32_bf16 v[76:79], a[152:155], a[44:47], v[76:79]
    v_mfma_f32_16x16x32_bf16 v[92:95], a[156:159], a[44:47], v[92:95]
    s_waitcnt vmcnt(36) lgkmcnt(0)
    s_barrier
    v_cmp_gt_u32 vcc, 4, v29
    s_cbranch_vccz k_arr_ok
    s_mov_b32 s3, 0x20000
k_arr:
    s_sub_u32 s3, s3, 1
    s_cbranch_scc1 k_arr_ok
    buffer_load_dword v29, v30, s[88:91], 0 offen sc1
    s_waitcnt vmcnt(0)
    v_cmp_gt_u32 vcc, 4, v29
    s_cbranch_vccnz k_arr
k_arr_ok:
    v_and_b32 v10, 15, v15
    v_bfe_u32 v9, v15, 4, 1
    v_lshl_add_u32 v10, v9, 5, v10
    v_lshrrev_b32 v9, 5, v15
    v_lshl_add_u32 v10, v9, 4, v10
    v_lshlrev_b32 v10, 4, v10
    v_mfma_f32_16x16x32_bf16 v[32:35], a[160:163], a[48:51], v[32:35]
    ds_read_b64_tr_b16 a[144:145], v11 offset:32832
    s_add_u32 m0, s63, 65536
    v_mfma_f32_16x16x32_bf16 v[48:51], a[164:167], a[48:51], v[48:51]
    ds_read_b64_tr_b16 a[146:147], v11 offset:33856
    buffer_load_dwordx4 v14, s[52:55], s8 offen lds
    v_mfma_f32_16x16x32_bf16 v[64:67], a[168:171], a[48:51], v[64:67]
    ds_read_b64_tr_b16 a[148:149], v11 offset:34880
    v_mfma_f32_16x16x32_bf16 v[80:83], a[172:175], a[48:51], v[80:83]
    ds_read_b64_tr_b16 a[150:151], v11 offset:35904
    v_mfma_f32_16x16x32_bf16 v[36:39], a[160:163], a[52:55], v[36:39]
    buffer_load_dwordx4 v0, s[52:55], s8 offen offset:1024 lds
    v_mfma_f32_16x16x32_bf16 v[52:55], a[164:167], a[52:55], v[52:55]
    ds_read_b64_tr_b16 a[152:153], v11 offset:32864
    v_mfma_f32_16x16x32_bf16 v[68:71], a[168:171], a[52:55], v[68:71]
    ds_read_b64_tr_b16 a[154:155], v11 offset:33888
    s_add_u32 m0, s63, 73728
    v_mfma_f32_16x16x32_bf16 v[84:87], a[172:175], a[52:55], v[84:87]
    ds_read_b64_tr_b16 a[156:157], v11 offset:34912
    buffer_load_dwordx4 v12, s[52:55], s8 offen lds
    v_mfma_f32_16x16x32_bf16 v[40:43], a[160:163], a[56:59], v[40:43]
    v_mfma_f32_16x16x32_bf16 v[56:59], a[164:167], a[56:59], v[56:59]
    ds_read_b64_tr_b16 a[158:159], v11 offset:35936
    v_mfma_f32_16x16x32_bf16 v[72:75], a[168:171], a[56:59], v[72:75]
    buffer_load_dwordx4 v13, s[52:55], s8 offen offset:1024 lds
    v_mfma_f32_16x16x32_bf16 v[88:91], a[172:175], a[56:59], v[88:91]
    v_mfma_f32_16x16x32_bf16 v[44:47], a[160:163], a[60:63], v[44:47]
    v_mfma_f32_16x16x32_bf16 v[60:63], a[164:167], a[60:63], v[60:63]
    v_mfma_f32_16x16x32_bf16 v[76:79], a[168:171], a[60:63], v[76:79]
    v_mfma_f32_16x16x32_bf16 v[92:95], a[172:175], a[60:63], v[92:95]
    s_waitcnt lgkmcnt(0)
    v_mfma_f32_16x16x32_bf16 v[96:99], a[144:147], a[32:35], v[96:99]
    ds_read_b64_tr_b16 a[160:161], v11 offset:49216
    s_add_u32 m0, s63, 81920
    v_mfma_f32_16x16x32_bf16 v[112:115], a[148:151], a[32:35], v[112:115]
    ds_read_b64_tr_b16 a[162:163], v11 offset:50240
    buffer_load_dwordx4 v14, s[52:55], s9 offen lds
    v_mfma_f32_16x16x32_bf16 v[128:131], a[152:155], a[32:35], v[128:131]
    ds_read_b64_tr_b16 a[164:165], v11 offset:51264
    v_mul_f32 v16, s44, v32
    v_mul_f32 v17, s45, v33
    v_mul_f32 v18, s44, v34
    v_mul_f32 v19, s45, v35
    v_mul_f32 v20, s44, v64
    v_mul_f32 v21, s45, v65
    v_mul_f32 v22, s44, v66
    v_mul_f32 v23, s45, v67
    v_exp_f32 v16, v16
    v_exp_f32 v17, v17
    v_mfma_f32_16x16x32_bf16 v[144:147], a[156:159], a[32:35], v[144:147]
    ds_read_b64_tr_b16 a[166:167], v11 offset:52288
    v_exp_f32 v18, v18
    v_exp_f32 v19, v19
    v_exp_f32 v20, v20
    v_exp_f32 v21, v21
    v_exp_f32 v22, v22
    v_exp_f32 v23, v23
    v_add_f32 v16, s46, v16
    v_add_f32 v17, s47, v17
    v_add_f32 v18, s46, v18
    v_add_f32 v19, s47, v19
    v_mfma_f32_16x16x32_bf16 v[100:103], a[144:147], a[36:39], v[100:103]
    buffer_load_dwordx4 v0, s[52:55], s9 offen offset:1024 lds
    v_add_f32 v20, s46, v20
    v_add_f32 v21, s47, v21
    v_add_f32 v22, s46, v22
    v_add_f32 v23, s47, v23
    v_rcp_f32 v16, v16
    v_rcp_f32 v17, v17
    v_rcp_f32 v18, v18
    v_rcp_f32 v19, v19
    v_rcp_f32 v20, v20
    v_rcp_f32 v21, v21
    v_mfma_f32_16x16x32_bf16 v[116:119], a[148:151], a[36:39], v[116:119]
    ds_read_b64_tr_b16 a[168:169], v11 offset:49248
    v_rcp_f32 v22, v22
    v_rcp_f32 v23, v23
    v_mul_f32 v16, v32, v16
    v_mul_f32 v17, v33, v17
    v_mul_f32 v18, v34, v18
    v_mul_f32 v19, v35, v19
    v_mul_f32 v20, v64, v20
    v_mul_f32 v21, v65, v21
    v_mul_f32 v22, v66, v22
    v_mul_f32 v23, v67, v23
    v_mfma_f32_16x16x32_bf16 v[132:135], a[152:155], a[36:39], v[132:135]
    ds_read_b64_tr_b16 a[170:171], v11 offset:50272
    s_add_u32 m0, s63, 90112
    v_mul_f32 v16, v48, v16
    v_mul_f32 v17, v49, v17
    v_mul_f32 v18, v50, v18
    v_mul_f32 v19, v51, v19
    v_mul_f32 v20, v80, v20
    v_mul_f32 v21, v81, v21
    v_mul_f32 v22, v82, v22
    v_mul_f32 v23, v83, v23
    v_cvt_pk_bf16_f32 v32, v16, v17
    v_cvt_pk_bf16_f32 v33, v18, v19
    v_mfma_f32_16x16x32_bf16 v[148:151], a[156:159], a[36:39], v[148:151]
    ds_read_b64_tr_b16 a[172:173], v11 offset:51296
    buffer_load_dwordx4 v12, s[52:55], s9 offen lds
    v_cvt_pk_bf16_f32 v34, v20, v21
    v_cvt_pk_bf16_f32 v35, v22, v23
    s_nop 1
    v_permlane16_swap_b32 v32, v34
    v_permlane16_swap_b32 v33, v35
    buffer_store_dwordx4 v[32:35], v10, s[28:31], s48 offen offset:0 sc0 sc1
    v_mul_f32 v24, s44, v36
    v_mul_f32 v25, s45, v37
    v_mul_f32 v26, s44, v38
    v_mul_f32 v27, s45, v39
    v_mfma_f32_16x16x32_bf16 v[104:107], a[144:147], a[40:43], v[104:107]
    v_mul_f32 v28, s44, v68
    v_mul_f32 v29, s45, v69
    v_mul_f32 v30, s44, v70
    v_mul_f32 v31, s45, v71
    v_exp_f32 v24, v24
    v_exp_f32 v25, v25
    v_exp_f32 v26, v26
    v_exp_f32 v27, v27
    v_exp_f32 v28, v28
    v_exp_f32 v29, v29
    v_mfma_f32_16x16x32_bf16 v[120:123], a[148:151], a[40:43], v[120:123]
    ds_read_b64_tr_b16 a[174:175], v11 offset:52320
    v_exp_f32 v30, v30
    v_exp_f32 v31, v31
    v_add_f32 v24, s46, v24
    v_add_f32 v25, s47, v25
    v_add_f32 v26, s46, v26
    v_add_f32 v27, s47, v27
    v_add_f32 v28, s46, v28
    v_add_f32 v29, s47, v29
    v_add_f32 v30, s46, v30
    v_add_f32 v31, s47, v31
    v_mfma_f32_16x16x32_bf16 v[136:139], a[152:155], a[40:43], v[136:139]
    buffer_load_dwordx4 v13, s[52:55], s9 offen offset:1024 lds
    v_rcp_f32 v24, v24
    v_rcp_f32 v25, v25
    v_rcp_f32 v26, v26
    v_rcp_f32 v27, v27
    v_rcp_f32 v28, v28
    v_rcp_f32 v29, v29
    v_rcp_f32 v30, v30
    v_rcp_f32 v31, v31
    v_mul_f32 v24, v36, v24
    v_mul_f32 v25, v37, v25
    v_mfma_f32_16x16x32_bf16 v[152:155], a[156:159], a[40:43], v[152:155]
    v_mul_f32 v26, v38, v26
    v_mul_f32 v27, v39, v27
    v_mul_f32 v28, v68, v28
    v_mul_f32 v29, v69, v29
    v_mul_f32 v30, v70, v30
    v_mul_f32 v31, v71, v31
    v_mul_f32 v24, v52, v24
    v_mul_f32 v25, v53, v25
    v_mul_f32 v26, v54, v26
    v_mul_f32 v27, v55, v27
    v_mfma_f32_16x16x32_bf16 v[108:111], a[144:147], a[44:47], v[108:111]
    v_mul_f32 v28, v84, v28
    v_mul_f32 v29, v85, v29
    v_mul_f32 v30, v86, v30
    v_mul_f32 v31, v87, v31
    v_cvt_pk_bf16_f32 v36, v24, v25
    v_cvt_pk_bf16_f32 v37, v26, v27
    v_cvt_pk_bf16_f32 v38, v28, v29
    v_cvt_pk_bf16_f32 v39, v30, v31
    s_nop 1
    v_permlane16_swap_b32 v36, v38
    v_mfma_f32_16x16x32_bf16 v[124:127], a[148:151], a[44:47], v[124:127]
    v_permlane16_swap_b32 v37, v39
    buffer_store_dwordx4 v[36:39], v10, s[28:31], s48 offen offset:1024 sc0 sc1
    v_mul_f32 v16, s44, v40
    v_mul_f32 v17, s45, v41
    v_mul_f32 v18, s44, v42
    v_mul_f32 v19, s45, v43
    v_mul_f32 v20, s44, v72
    v_mul_f32 v21, s45, v73
    v_mul_f32 v22, s44, v74
    v_mul_f32 v23, s45, v75
    v_mfma_f32_16x16x32_bf16 v[140:143], a[152:155], a[44:47], v[140:143]
    v_exp_f32 v16, v16
    v_exp_f32 v17, v17
    v_exp_f32 v18, v18
    v_exp_f32 v19, v19
    v_exp_f32 v20, v20
    v_exp_f32 v21, v21
    v_exp_f32 v22, v22
    v_exp_f32 v23, v23
    v_add_f32 v16, s46, v16
    v_add_f32 v17, s47, v17
    v_mfma_f32_16x16x32_bf16 v[156:159], a[156:159], a[44:47], v[156:159]
    v_add_f32 v18, s46, v18
    v_add_f32 v19, s47, v19
    v_add_f32 v20, s46, v20
    v_add_f32 v21, s47, v21
    v_add_f32 v22, s46, v22
    v_add_f32 v23, s47, v23
    v_rcp_f32 v16, v16
    v_rcp_f32 v17, v17
    v_rcp_f32 v18, v18
    v_rcp_f32 v19, v19
    s_waitcnt lgkmcnt(0)
    v_mfma_f32_16x16x32_bf16 v[96:99], a[160:163], a[48:51], v[96:99]
    ds_read_b64_tr_b16 a[144:145], v11 offset:192
    v_rcp_f32 v20, v20
    v_rcp_f32 v21, v21
    v_rcp_f32 v22, v22
    v_rcp_f32 v23, v23
    v_mul_f32 v16, v40, v16
    v_mul_f32 v17, v41, v17
    v_mul_f32 v18, v42, v18
    v_mul_f32 v19, v43, v19
    v_mul_f32 v20, v72, v20
    v_mul_f32 v21, v73, v21
    v_mfma_f32_16x16x32_bf16 v[112:115], a[164:167], a[48:51], v[112:115]
    ds_read_b64_tr_b16 a[146:147], v11 offset:1216
    v_mul_f32 v22, v74, v22
    v_mul_f32 v23, v75, v23
    v_mul_f32 v16, v56, v16
    v_mul_f32 v17, v57, v17
    v_mul_f32 v18, v58, v18
    v_mul_f32 v19, v59, v19
    v_mul_f32 v20, v88, v20
    v_mul_f32 v21, v89, v21
    v_mul_f32 v22, v90, v22
    v_mul_f32 v23, v91, v23
    v_mfma_f32_16x16x32_bf16 v[128:131], a[168:171], a[48:51], v[128:131]
    ds_read_b64_tr_b16 a[148:149], v11 offset:2240
    v_cvt_pk_bf16_f32 v40, v16, v17
    v_cvt_pk_bf16_f32 v41, v18, v19
    v_cvt_pk_bf16_f32 v42, v20, v21
    v_cvt_pk_bf16_f32 v43, v22, v23
    s_nop 1
    v_permlane16_swap_b32 v40, v42
    v_permlane16_swap_b32 v41, v43
    buffer_store_dwordx4 v[40:43], v10, s[28:31], s49 offen offset:0 sc0 sc1
    v_mul_f32 v24, s44, v44
    v_mul_f32 v25, s45, v45
    v_mfma_f32_16x16x32_bf16 v[144:147], a[172:175], a[48:51], v[144:147]
    ds_read_b64_tr_b16 a[150:151], v11 offset:3264
    v_mul_f32 v26, s44, v46
    v_mul_f32 v27, s45, v47
    v_mul_f32 v28, s44, v76
    v_mul_f32 v29, s45, v77
    v_mul_f32 v30, s44, v78
    v_mul_f32 v31, s45, v79
    v_exp_f32 v24, v24
    v_exp_f32 v25, v25
    v_exp_f32 v26, v26
    v_exp_f32 v27, v27
    v_mfma_f32_16x16x32_bf16 v[100:103], a[160:163], a[52:55], v[100:103]
    v_exp_f32 v28, v28
    v_exp_f32 v29, v29
    v_exp_f32 v30, v30
    v_exp_f32 v31, v31
    v_add_f32 v24, s46, v24
    v_add_f32 v25, s47, v25
    v_add_f32 v26, s46, v26
    v_add_f32 v27, s47, v27
    v_add_f32 v28, s46, v28
    v_add_f32 v29, s47, v29
    v_mfma_f32_16x16x32_bf16 v[116:119], a[164:167], a[52:55], v[116:119]
    ds_read_b64_tr_b16 a[152:153], v11 offset:16576
    v_add_f32 v30, s46, v30
    v_add_f32 v31, s47, v31
    v_rcp_f32 v24, v24
    v_rcp_f32 v25, v25
    v_rcp_f32 v26, v26
    v_rcp_f32 v27, v27
    v_rcp_f32 v28, v28
    v_rcp_f32 v29, v29
    v_rcp_f32 v30, v30
    v_rcp_f32 v31, v31
    v_mfma_f32_16x16x32_bf16 v[132:135], a[168:171], a[52:55], v[132:135]
    ds_read_b64_tr_b16 a[154:155], v11 offset:17600
    v_mul_f32 v24, v44, v24
    v_mul_f32 v25, v45, v25
    v_mul_f32 v26, v46, v26
    v_mul_f32 v27, v47, v27
    v_mul_f32 v28, v76, v28
    v_mul_f32 v29, v77, v29
    v_mul_f32 v30, v78, v30
    v_mul_f32 v31, v79, v31
    v_mul_f32 v24, v60, v24
    v_mul_f32 v25, v61, v25
    v_mfma_f32_16x16x32_bf16 v[148:151], a[172:175], a[52:55], v[148:151]
    ds_read_b64_tr_b16 a[156:157], v11 offset:18624
    v_mul_f32 v26, v62, v26
    v_mul_f32 v27, v63, v27
    v_mul_f32 v28, v92, v28
    v_mul_f32 v29, v93, v29
    v_mul_f32 v30, v94, v30
    v_mul_f32 v31, v95, v31
    v_cvt_pk_bf16_f32 v44, v24, v25
    v_cvt_pk_bf16_f32 v45, v26, v27
    v_cvt_pk_bf16_f32 v46, v28, v29
    v_cvt_pk_bf16_f32 v47, v30, v31
    v_mfma_f32_16x16x32_bf16 v[104:107], a[160:163], a[56:59], v[104:107]
    s_nop 1
    v_permlane16_swap_b32 v44, v46
    v_permlane16_swap_b32 v45, v47
    buffer_store_dwordx4 v[44:47], v10, s[28:31], s49 offen offset:1024 sc0 sc1
    v_mfma_f32_16x16x32_bf16 v[120:123], a[164:167], a[56:59], v[120:123]
    ds_read_b64_tr_b16 a[158:159], v11 offset:19648
    v_mfma_f32_16x16x32_bf16 v[136:139], a[168:171], a[56:59], v[136:139]
    v_mfma_f32_16x16x32_bf16 v[152:155], a[172:175], a[56:59], v[152:155]
    v_mfma_f32_16x16x32_bf16 v[108:111], a[160:163], a[60:63], v[108:111]
    v_mfma_f32_16x16x32_bf16 v[124:127], a[164:167], a[60:63], v[124:127]
    v_mfma_f32_16x16x32_bf16 v[140:143], a[168:171], a[60:63], v[140:143]
    v_mfma_f32_16x16x32_bf16 v[156:159], a[172:175], a[60:63], v[156:159]
    s_waitcnt lgkmcnt(0)
    v_mfma_f32_16x16x32_bf16 v[224:227], a[144:147], a[0:3], v[224:227]
    ds_read_b64_tr_b16 a[160:161], v11 offset:32960
    v_mfma_f32_16x16x32_bf16 v[240:243], a[148:151], a[0:3], v[240:243]
    ds_read_b64_tr_b16 a[162:163], v11 offset:33984
    v_mfma_f32_16x16x32_bf16 v[228:231], a[144:147], a[4:7], v[228:231]
    ds_read_b64_tr_b16 a[164:165], v11 offset:35008
    v_mul_f32 v16, s44, v96
    v_mul_f32 v17, s45, v97
    v_mul_f32 v18, s44, v98
    v_mul_f32 v19, s45, v99
    v_mul_f32 v20, s44, v128
    v_mul_f32 v21, s45, v129
    v_mul_f32 v22, s44, v130
    v_mul_f32 v23, s45, v131
    v_exp_f32 v16, v16
    v_exp_f32 v17, v17
    v_mfma_f32_16x16x32_bf16 v[244:247], a[148:151], a[4:7], v[244:247]
    ds_read_b64_tr_b16 a[166:167], v11 offset:36032
    v_exp_f32 v18, v18
    v_exp_f32 v19, v19
    v_exp_f32 v20, v20
    v_exp_f32 v21, v21
    v_exp_f32 v22, v22
    v_exp_f32 v23, v23
    v_add_f32 v16, s46, v16
    v_add_f32 v17, s47, v17
    v_add_f32 v18, s46, v18
    v_add_f32 v19, s47, v19
    v_mfma_f32_16x16x32_bf16 v[232:235], a[144:147], a[8:11], v[232:235]
    v_add_f32 v20, s46, v20
    v_add_f32 v21, s47, v21
    v_add_f32 v22, s46, v22
    v_add_f32 v23, s47, v23
    v_rcp_f32 v16, v16
    v_rcp_f32 v17, v17
    v_rcp_f32 v18, v18
    v_rcp_f32 v19, v19
    v_rcp_f32 v20, v20
    v_rcp_f32 v21, v21
    v_mfma_f32_16x16x32_bf16 v[248:251], a[148:151], a[8:11], v[248:251]
    ds_read_b64_tr_b16 a[168:169], v11 offset:49344
    v_rcp_f32 v22, v22
    v_rcp_f32 v23, v23
    v_mul_f32 v16, v96, v16
    v_mul_f32 v17, v97, v17
    v_mul_f32 v18, v98, v18
    v_mul_f32 v19, v99, v19
    v_mul_f32 v20, v128, v20
    v_mul_f32 v21, v129, v21
    v_mul_f32 v22, v130, v22
    v_mul_f32 v23, v131, v23
    v_mfma_f32_16x16x32_bf16 v[236:239], a[144:147], a[12:15], v[236:239]
    ds_read_b64_tr_b16 a[170:171], v11 offset:50368
    v_mul_f32 v16, v112, v16
    v_mul_f32 v17, v113, v17
    v_mul_f32 v18, v114, v18
    v_mul_f32 v19, v115, v19
    v_mul_f32 v20, v144, v20
    v_mul_f32 v21, v145, v21
    v_mul_f32 v22, v146, v22
    v_mul_f32 v23, v147, v23
    v_cvt_pk_bf16_f32 v96, v16, v17
    v_cvt_pk_bf16_f32 v97, v18, v19
    v_mfma_f32_16x16x32_bf16 v[252:255], a[148:151], a[12:15], v[252:255]
    ds_read_b64_tr_b16 a[172:173], v11 offset:51392
    v_cvt_pk_bf16_f32 v98, v20, v21
    v_cvt_pk_bf16_f32 v99, v22, v23
    s_nop 1
    v_permlane16_swap_b32 v96, v98
    v_permlane16_swap_b32 v97, v99
    buffer_store_dwordx4 v[96:99], v10, s[28:31], s50 offen offset:0 sc0 sc1
    v_mul_f32 v24, s44, v100
    v_mul_f32 v25, s45, v101
    v_mul_f32 v26, s44, v102
    v_mul_f32 v27, s45, v103
    v_mfma_f32_16x16x32_bf16 v[224:227], a[152:155], a[16:19], v[224:227]
    v_mul_f32 v28, s44, v132
    v_mul_f32 v29, s45, v133
    v_mul_f32 v30, s44, v134
    v_mul_f32 v31, s45, v135
    v_exp_f32 v24, v24
    v_exp_f32 v25, v25
    v_exp_f32 v26, v26
    v_exp_f32 v27, v27
    v_exp_f32 v28, v28
    v_exp_f32 v29, v29
    v_mfma_f32_16x16x32_bf16 v[240:243], a[156:159], a[16:19], v[240:243]
    ds_read_b64_tr_b16 a[174:175], v11 offset:52416
    v_exp_f32 v30, v30
    v_exp_f32 v31, v31
    v_add_f32 v24, s46, v24
    v_add_f32 v25, s47, v25
    v_add_f32 v26, s46, v26
    v_add_f32 v27, s47, v27
    v_add_f32 v28, s46, v28
    v_add_f32 v29, s47, v29
    v_add_f32 v30, s46, v30
    v_add_f32 v31, s47, v31
    v_mfma_f32_16x16x32_bf16 v[228:231], a[152:155], a[20:23], v[228:231]
    v_rcp_f32 v24, v24
    v_rcp_f32 v25, v25
    v_rcp_f32 v26, v26
    v_rcp_f32 v27, v27
    v_rcp_f32 v28, v28
    v_rcp_f32 v29, v29
    v_rcp_f32 v30, v30
    v_rcp_f32 v31, v31
    v_mul_f32 v24, v100, v24
    v_mul_f32 v25, v101, v25
    v_mfma_f32_16x16x32_bf16 v[244:247], a[156:159], a[20:23], v[244:247]
    v_mul_f32 v26, v102, v26
    v_mul_f32 v27, v103, v27
    v_mul_f32 v28, v132, v28
    v_mul_f32 v29, v133, v29
    v_mul_f32 v30, v134, v30
    v_mul_f32 v31, v135, v31
    v_mul_f32 v24, v116, v24
    v_mul_f32 v25, v117, v25
    v_mul_f32 v26, v118, v26
    v_mul_f32 v27, v119, v27
    v_mfma_f32_16x16x32_bf16 v[232:235], a[152:155], a[24:27], v[232:235]
    v_mul_f32 v28, v148, v28
    v_mul_f32 v29, v149, v29
    v_mul_f32 v30, v150, v30
    v_mul_f32 v31, v151, v31
    v_cvt_pk_bf16_f32 v100, v24, v25
    v_cvt_pk_bf16_f32 v101, v26, v27
    v_cvt_pk_bf16_f32 v102, v28, v29
    v_cvt_pk_bf16_f32 v103, v30, v31
    s_nop 1
    v_permlane16_swap_b32 v100, v102
    v_mfma_f32_16x16x32_bf16 v[248:251], a[156:159], a[24:27], v[248:251]
    v_permlane16_swap_b32 v101, v103
    buffer_store_dwordx4 v[100:103], v10, s[28:31], s50 offen offset:1024 sc0 sc1
    v_mul_f32 v16, s44, v104
    v_mul_f32 v17, s45, v105
    v_mul_f32 v18, s44, v106
    v_mul_f32 v19, s45, v107
    v_mul_f32 v20, s44, v136
    v_mul_f32 v21, s45, v137
    v_mul_f32 v22, s44, v138
    v_mul_f32 v23, s45, v139
    v_mfma_f32_16x16x32_bf16 v[236:239], a[152:155], a[28:31], v[236:239]
    v_exp_f32 v16, v16
    v_exp_f32 v17, v17
    v_exp_f32 v18, v18
    v_exp_f32 v19, v19
    v_exp_f32 v20, v20
    v_exp_f32 v21, v21
    v_exp_f32 v22, v22
    v_exp_f32 v23, v23
    v_add_f32 v16, s46, v16
    v_add_f32 v17, s47, v17
    v_mfma_f32_16x16x32_bf16 v[252:255], a[156:159], a[28:31], v[252:255]
    v_add_f32 v18, s46, v18
    v_add_f32 v19, s47, v19
    v_add_f32 v20, s46, v20
    v_add_f32 v21, s47, v21
    v_add_f32 v22, s46, v22
    v_add_f32 v23, s47, v23
    v_rcp_f32 v16, v16
    v_rcp_f32 v17, v17
    v_rcp_f32 v18, v18
    v_rcp_f32 v19, v19
    s_waitcnt lgkmcnt(0)
    v_mfma_f32_16x16x32_bf16 v[224:227], a[160:163], a[32:35], v[224:227]
    ds_read_b64_tr_b16 a[144:145], v11 offset:128
    v_rcp_f32 v20, v20
    v_rcp_f32 v21, v21
    v_rcp_f32 v22, v22
    v_rcp_f32 v23, v23
    v_mul_f32 v16, v104, v16
    v_mul_f32 v17, v105, v17
    v_mul_f32 v18, v106, v18
    v_mul_f32 v19, v107, v19
    v_mul_f32 v20, v136, v20
    v_mul_f32 v21, v137, v21
    v_mfma_f32_16x16x32_bf16 v[240:243], a[164:167], a[32:35], v[240:243]
    ds_read_b64_tr_b16 a[146:147], v11 offset:1152
    v_mul_f32 v22, v138, v22
    v_mul_f32 v23, v139, v23
    v_mul_f32 v16, v120, v16
    v_mul_f32 v17, v121, v17
    v_mul_f32 v18, v122, v18
    v_mul_f32 v19, v123, v19
    v_mul_f32 v20, v152, v20
    v_mul_f32 v21, v153, v21
    v_mul_f32 v22, v154, v22
    v_mul_f32 v23, v155, v23
    v_mfma_f32_16x16x32_bf16 v[228:231], a[160:163], a[36:39], v[228:231]
    ds_read_b64_tr_b16 a[148:149], v11 offset:2176
    v_cvt_pk_bf16_f32 v104, v16, v17
    v_cvt_pk_bf16_f32 v105, v18, v19
    v_cvt_pk_bf16_f32 v106, v20, v21
    v_cvt_pk_bf16_f32 v107, v22, v23
    s_nop 1
    v_permlane16_swap_b32 v104, v106
    v_permlane16_swap_b32 v105, v107
    buffer_store_dwordx4 v[104:107], v10, s[28:31], s51 offen offset:0 sc0 sc1
    v_mul_f32 v24, s44, v108
    v_mul_f32 v25, s45, v109
    v_mfma_f32_16x16x32_bf16 v[244:247], a[164:167], a[36:39], v[244:247]
    ds_read_b64_tr_b16 a[150:151], v11 offset:3200
    v_mul_f32 v26, s44, v110
    v_mul_f32 v27, s45, v111
    v_mul_f32 v28, s44, v140
    v_mul_f32 v29, s45, v141
    v_mul_f32 v30, s44, v142
    v_mul_f32 v31, s45, v143
    v_exp_f32 v24, v24
    v_exp_f32 v25, v25
    v_exp_f32 v26, v26
    v_exp_f32 v27, v27
    v_mfma_f32_16x16x32_bf16 v[232:235], a[160:163], a[40:43], v[232:235]
    v_exp_f32 v28, v28
    v_exp_f32 v29, v29
    v_exp_f32 v30, v30
    v_exp_f32 v31, v31
    v_add_f32 v24, s46, v24
    v_add_f32 v25, s47, v25
    v_add_f32 v26, s46, v26
    v_add_f32 v27, s47, v27
    v_add_f32 v28, s46, v28
    v_add_f32 v29, s47, v29
    v_mfma_f32_16x16x32_bf16 v[248:251], a[164:167], a[40:43], v[248:251]
    ds_read_b64_tr_b16 a[152:153], v11 offset:160
    v_add_f32 v30, s46, v30
    v_add_f32 v31, s47, v31
    v_rcp_f32 v24, v24
    v_rcp_f32 v25, v25
    v_rcp_f32 v26, v26
    v_rcp_f32 v27, v27
    v_rcp_f32 v28, v28
    v_rcp_f32 v29, v29
    v_rcp_f32 v30, v30
    v_rcp_f32 v31, v31
    v_mfma_f32_16x16x32_bf16 v[236:239], a[160:163], a[44:47], v[236:239]
    ds_read_b64_tr_b16 a[154:155], v11 offset:1184
    v_mul_f32 v24, v108, v24
    v_mul_f32 v25, v109, v25
    v_mul_f32 v26, v110, v26
    v_mul_f32 v27, v111, v27
    v_mul_f32 v28, v140, v28
    v_mul_f32 v29, v141, v29
    v_mul_f32 v30, v142, v30
    v_mul_f32 v31, v143, v31
    v_mul_f32 v24, v124, v24
    v_mul_f32 v25, v125, v25
    v_mfma_f32_16x16x32_bf16 v[252:255], a[164:167], a[44:47], v[252:255]
    ds_read_b64_tr_b16 a[156:157], v11 offset:2208
    v_mul_f32 v26, v126, v26
    v_mul_f32 v27, v127, v27
    v_mul_f32 v28, v156, v28
    v_mul_f32 v29, v157, v29
    v_mul_f32 v30, v158, v30
    v_mul_f32 v31, v159, v31
    v_cvt_pk_bf16_f32 v108, v24, v25
    v_cvt_pk_bf16_f32 v109, v26, v27
    v_cvt_pk_bf16_f32 v110, v28, v29
    v_cvt_pk_bf16_f32 v111, v30, v31
    v_mfma_f32_16x16x32_bf16 v[224:227], a[168:171], a[48:51], v[224:227]
    s_nop 1
    v_permlane16_swap_b32 v108, v110
    v_permlane16_swap_b32 v109, v111
    buffer_store_dwordx4 v[108:111], v10, s[28:31], s51 offen offset:1024 sc0 sc1
    v_mfma_f32_16x16x32_bf16 v[240:243], a[172:175], a[48:51], v[240:243]
    ds_read_b64_tr_b16 a[158:159], v11 offset:3232
    v_mfma_f32_16x16x32_bf16 v[228:231], a[168:171], a[52:55], v[228:231]
    v_mfma_f32_16x16x32_bf16 v[244:247], a[172:175], a[52:55], v[244:247]
    v_mfma_f32_16x16x32_bf16 v[232:235], a[168:171], a[56:59], v[232:235]
    v_mfma_f32_16x16x32_bf16 v[248:251], a[172:175], a[56:59], v[248:251]
    v_mfma_f32_16x16x32_bf16 v[236:239], a[168:171], a[60:63], v[236:239]
    v_mfma_f32_16x16x32_bf16 v[252:255], a[172:175], a[60:63], v[252:255]
    s_waitcnt lgkmcnt(0)
    v_mfma_f32_16x16x32_bf16 v[160:163], a[144:147], a[0:3], v[160:163]
    ds_read_b64_tr_b16 a[160:161], v11 offset:16512
    v_mfma_f32_16x16x32_bf16 v[176:179], a[148:151], a[0:3], v[176:179]
    ds_read_b64_tr_b16 a[162:163], v11 offset:17536
    v_mfma_f32_16x16x32_bf16 v[192:195], a[152:155], a[0:3], v[192:195]
    ds_read_b64_tr_b16 a[164:165], v11 offset:18560
    v_mul_f32 v16, s44, v224
    v_mul_f32 v17, s45, v225
    v_mfma_f32_16x16x32_bf16 v[208:211], a[156:159], a[0:3], v[208:211]
    ds_read_b64_tr_b16 a[166:167], v11 offset:19584
    v_mul_f32 v18, s44, v226
    v_mul_f32 v19, s45, v227
    v_mfma_f32_16x16x32_bf16 v[164:167], a[144:147], a[4:7], v[164:167]
    v_mul_f32 v20, s44, v228
    v_mul_f32 v21, s45, v229
    v_mfma_f32_16x16x32_bf16 v[180:183], a[148:151], a[4:7], v[180:183]
    ds_read_b64_tr_b16 a[168:169], v11 offset:16544
    v_mul_f32 v22, s44, v230
    v_mul_f32 v23, s45, v231
    v_mfma_f32_16x16x32_bf16 v[196:199], a[152:155], a[4:7], v[196:199]
    ds_read_b64_tr_b16 a[170:171], v11 offset:17568
    v_exp_f32 v16, v16
    v_exp_f32 v17, v17
    v_mfma_f32_16x16x32_bf16 v[212:215], a[156:159], a[4:7], v[212:215]
    ds_read_b64_tr_b16 a[172:173], v11 offset:18592
    v_exp_f32 v18, v18
    v_exp_f32 v19, v19
    v_mfma_f32_16x16x32_bf16 v[168:171], a[144:147], a[8:11], v[168:171]
    v_exp_f32 v20, v20
    v_exp_f32 v21, v21
    v_mfma_f32_16x16x32_bf16 v[184:187], a[148:151], a[8:11], v[184:187]
    ds_read_b64_tr_b16 a[174:175], v11 offset:19616
    v_exp_f32 v22, v22
    v_exp_f32 v23, v23
    v_mfma_f32_16x16x32_bf16 v[200:203], a[152:155], a[8:11], v[200:203]
    v_add_f32 v16, s46, v16
    v_add_f32 v17, s47, v17
    v_mfma_f32_16x16x32_bf16 v[216:219], a[156:159], a[8:11], v[216:219]
    v_add_f32 v18, s46, v18
    v_add_f32 v19, s47, v19
    v_mfma_f32_16x16x32_bf16 v[172:175], a[144:147], a[12:15], v[172:175]
    v_add_f32 v20, s46, v20
    v_add_f32 v21, s47, v21
    v_mfma_f32_16x16x32_bf16 v[188:191], a[148:151], a[12:15], v[188:191]
    buffer_load_dword v5, v6, s[28:31], s83 offen sc1
    v_add_f32 v22, s46, v22
    v_add_f32 v23, s47, v23
    v_mfma_f32_16x16x32_bf16 v[204:207], a[152:155], a[12:15], v[204:207]
    v_rcp_f32 v16, v16
    v_rcp_f32 v17, v17
    v_mfma_f32_16x16x32_bf16 v[220:223], a[156:159], a[12:15], v[220:223]
    v_rcp_f32 v18, v18
    v_rcp_f32 v19, v19
    s_waitcnt lgkmcnt(0)
    s_barrier
    v_mfma_f32_16x16x32_bf16 v[160:163], a[160:163], a[16:19], v[160:163]
    ds_read_b64_tr_b16 a[144:145], v11 offset:32896
    s_add_u32 m0, s63, 0
    v_rcp_f32 v20, v20
    v_rcp_f32 v21, v21
    v_mfma_f32_16x16x32_bf16 v[176:179], a[164:167], a[16:19], v[176:179]
    ds_read_b64_tr_b16 a[146:147], v11 offset:33920
    buffer_load_dwordx4 v14, s[52:55], s10 offen lds
    v_rcp_f32 v22, v22
    v_rcp_f32 v23, v23
    v_mfma_f32_16x16x32_bf16 v[192:195], a[168:171], a[16:19], v[192:195]
    ds_read_b64_tr_b16 a[148:149], v11 offset:34944
    v_mul_f32 v16, v224, v16
    v_mul_f32 v17, v225, v17
    v_mfma_f32_16x16x32_bf16 v[208:211], a[172:175], a[16:19], v[208:211]
    ds_read_b64_tr_b16 a[150:151], v11 offset:35968
    v_mul_f32 v18, v226, v18
    v_mul_f32 v19, v227, v19
    v_mfma_f32_16x16x32_bf16 v[164:167], a[160:163], a[20:23], v[164:167]
    buffer_load_dwordx4 v0, s[52:55], s10 offen offset:1024 lds
    v_mul_f32 v20, v228, v20
    v_mul_f32 v21, v229, v21
    v_mfma_f32_16x16x32_bf16 v[180:183], a[164:167], a[20:23], v[180:183]
    ds_read_b64_tr_b16 a[152:153], v11 offset:32928
    v_mul_f32 v22, v230, v22
    v_mul_f32 v23, v231, v23
    v_mfma_f32_16x16x32_bf16 v[196:199], a[168:171], a[20:23], v[196:199]
    ds_read_b64_tr_b16 a[154:155], v11 offset:33952
    s_add_u32 m0, s63, 8192
    v_mul_f32 v16, v240, v16
    v_mul_f32 v17, v241, v17
    v_mfma_f32_16x16x32_bf16 v[212:215], a[172:175], a[20:23], v[212:215]
    ds_read_b64_tr_b16 a[156:157], v11 offset:34976
    buffer_load_dwordx4 v12, s[52:55], s10 offen lds
    v_mul_f32 v18, v242, v18
    v_mul_f32 v19, v243, v19
    v_mfma_f32_16x16x32_bf16 v[168:171], a[160:163], a[24:27], v[168:171]
    v_mul_f32 v20, v244, v20
    v_mul_f32 v21, v245, v21
    v_mfma_f32_16x16x32_bf16 v[184:187], a[164:167], a[24:27], v[184:187]
    ds_read_b64_tr_b16 a[158:159], v11 offset:36000
    v_mul_f32 v22, v246, v22
    v_mul_f32 v23, v247, v23
    v_mfma_f32_16x16x32_bf16 v[200:203], a[168:171], a[24:27], v[200:203]
    buffer_load_dwordx4 v13, s[52:55], s10 offen offset:1024 lds
    v_cvt_pk_bf16_f32 v224, v16, v17
    v_cvt_pk_bf16_f32 v225, v18, v19
    v_mfma_f32_16x16x32_bf16 v[216:219], a[172:175], a[24:27], v[216:219]
    v_cvt_pk_bf16_f32 v226, v20, v21
    v_cvt_pk_bf16_f32 v227, v22, v23
    v_mfma_f32_16x16x32_bf16 v[172:175], a[160:163], a[28:31], v[172:175]
    s_nop 1
    v_permlane16_swap_b32 v224, v226
    v_mfma_f32_16x16x32_bf16 v[188:191], a[164:167], a[28:31], v[188:191]
    v_permlane16_swap_b32 v225, v227
    v_mul_f32 v24, s44, v232
    v_mfma_f32_16x16x32_bf16 v[204:207], a[168:171], a[28:31], v[204:207]
    v_mul_f32 v25, s45, v233
    v_mul_f32 v26, s44, v234
    v_mfma_f32_16x16x32_bf16 v[220:223], a[172:175], a[28:31], v[220:223]
    v_mul_f32 v27, s45, v235
    v_mul_f32 v28, s44, v236
    s_waitcnt lgkmcnt(0)
    s_waitcnt vmcnt(5)
    s_mov_b64 exec, 1
    buffer_store_dword v4, v3, s[28:31], s82 offen sc1
    s_mov_b64 exec, -1
    v_mfma_f32_16x16x32_bf16 v[160:163], a[144:147], a[32:35], v[160:163]
    ds_read_b64_tr_b16 a[160:161], v11 offset:49280
    s_add_u32 m0, s63, 16384
    v_mul_f32 v29, s45, v237
    v_mul_f32 v30, s44, v238
    v_mfma_f32_16x16x32_bf16 v[176:179], a[148:151], a[32:35], v[176:179]
    ds_read_b64_tr_b16 a[162:163], v11 offset:50304
    buffer_load_dwordx4 v14, s[52:55], s11 offen lds
    v_mul_f32 v31, s45, v239
    v_exp_f32 v24, v24
    v_mfma_f32_16x16x32_bf16 v[192:195], a[152:155], a[32:35], v[192:195]
    ds_read_b64_tr_b16 a[164:165], v11 offset:51328
    v_exp_f32 v25, v25
    v_exp_f32 v26, v26
    v_mfma_f32_16x16x32_bf16 v[208:211], a[156:159], a[32:35], v[208:211]
    ds_read_b64_tr_b16 a[166:167], v11 offset:52352
    v_exp_f32 v27, v27
    v_exp_f32 v28, v28
    v_mfma_f32_16x16x32_bf16 v[164:167], a[144:147], a[36:39], v[164:167]
    buffer_load_dwordx4 v0, s[52:55], s11 offen offset:1024 lds
    v_exp_f32 v29, v29
    v_exp_f32 v30, v30
    v_mfma_f32_16x16x32_bf16 v[180:183], a[148:151], a[36:39], v[180:183]
    ds_read_b64_tr_b16 a[168:169], v11 offset:49312
    v_exp_f32 v31, v31
    v_add_f32 v24, s46, v24
    v_mfma_f32_16x16x32_bf16 v[196:199], a[152:155], a[36:39], v[196:199]
    ds_read_b64_tr_b16 a[170:171], v11 offset:50336
    s_add_u32 m0, s63, 24576
    v_add_f32 v25, s47, v25
    v_add_f32 v26, s46, v26
    v_mfma_f32_16x16x32_bf16 v[212:215], a[156:159], a[36:39], v[212:215]
    ds_read_b64_tr_b16 a[172:173], v11 offset:51360
    buffer_load_dwordx4 v12, s[52:55], s11 offen lds
    v_add_f32 v27, s47, v27
    v_add_f32 v28, s46, v28
    v_mfma_f32_16x16x32_bf16 v[168:171], a[144:147], a[40:43], v[168:171]
    v_add_f32 v29, s47, v29
    v_add_f32 v30, s46, v30
    v_mfma_f32_16x16x32_bf16 v[184:187], a[148:151], a[40:43], v[184:187]
    ds_read_b64_tr_b16 a[174:175], v11 offset:52384
    v_add_f32 v31, s47, v31
    v_rcp_f32 v24, v24
    v_mfma_f32_16x16x32_bf16 v[200:203], a[152:155], a[40:43], v[200:203]
    buffer_load_dwordx4 v13, s[52:55], s11 offen offset:1024 lds
    v_rcp_f32 v25, v25
    v_rcp_f32 v26, v26
    v_mfma_f32_16x16x32_bf16 v[216:219], a[156:159], a[40:43], v[216:219]
    v_rcp_f32 v27, v27
    v_rcp_f32 v28, v28
    v_mfma_f32_16x16x32_bf16 v[172:175], a[144:147], a[44:47], v[172:175]
    v_rcp_f32 v29, v29
    v_rcp_f32 v30, v30
    v_mfma_f32_16x16x32_bf16 v[188:191], a[148:151], a[44:47], v[188:191]
    buffer_load_dword v5, v6, s[28:31], s83 offen sc1
    v_rcp_f32 v31, v31
    v_mul_f32 v24, v232, v24
    v_mfma_f32_16x16x32_bf16 v[204:207], a[152:155], a[44:47], v[204:207]
    v_mul_f32 v25, v233, v25
    v_mul_f32 v26, v234, v26
    v_mfma_f32_16x16x32_bf16 v[220:223], a[156:159], a[44:47], v[220:223]
    v_mul_f32 v27, v235, v27
    v_mul_f32 v28, v236, v28
    s_waitcnt vmcnt(27) lgkmcnt(0)
    s_barrier
    v_mfma_f32_16x16x32_bf16 v[160:163], a[160:163], a[48:51], v[160:163]
    s_add_u32 s4, s4, s59
    s_add_u32 m0, s63, 32768
    v_mul_f32 v29, v237, v29
    v_mul_f32 v30, v238, v30
    v_mfma_f32_16x16x32_bf16 v[176:179], a[164:167], a[48:51], v[176:179]
    buffer_load_dwordx4 v14, s[52:55], s4 offen lds
    v_mul_f32 v31, v239, v31
    v_mul_f32 v24, v248, v24
    v_mfma_f32_16x16x32_bf16 v[192:195], a[168:171], a[48:51], v[192:195]
    v_mul_f32 v25, v249, v25
    v_mul_f32 v26, v250, v26
    v_mfma_f32_16x16x32_bf16 v[208:211], a[172:175], a[48:51], v[208:211]
    buffer_load_dwordx4 v0, s[52:55], s4 offen offset:1024 lds
    v_mul_f32 v27, v251, v27
    v_mul_f32 v28, v252, v28
    v_mfma_f32_16x16x32_bf16 v[164:167], a[160:163], a[52:55], v[164:167]
    s_add_u32 m0, s63, 40960
    v_mul_f32 v29, v253, v29
    v_mul_f32 v30, v254, v30
    v_mfma_f32_16x16x32_bf16 v[180:183], a[164:167], a[52:55], v[180:183]
    buffer_load_dwordx4 v12, s[52:55], s4 offen lds
    v_mul_f32 v31, v255, v31
    v_cvt_pk_bf16_f32 v232, v24, v25
    v_mfma_f32_16x16x32_bf16 v[196:199], a[168:171], a[52:55], v[196:199]
    v_cvt_pk_bf16_f32 v233, v26, v27
    v_cvt_pk_bf16_f32 v234, v28, v29
    v_mfma_f32_16x16x32_bf16 v[212:215], a[172:175], a[52:55], v[212:215]
    buffer_load_dwordx4 v13, s[52:55], s4 offen offset:1024 lds
    v_cvt_pk_bf16_f32 v235, v30, v31
    s_nop 1
    v_mfma_f32_16x16x32_bf16 v[168:171], a[160:163], a[56:59], v[168:171]
    s_add_u32 s5, s5, s62
    s_add_u32 m0, s63, 49152
    v_permlane16_swap_b32 v232, v234
    v_permlane16_swap_b32 v233, v235
    v_mfma_f32_16x16x32_bf16 v[184:187], a[164:167], a[56:59], v[184:187]
    buffer_load_dwordx4 v14, s[52:55], s5 offen lds
    v_lshrrev_b32 v7, 2, v15
    v_lshlrev_b32 v240, 7, v7
    v_mfma_f32_16x16x32_bf16 v[200:203], a[168:171], a[56:59], v[200:203]
    v_bfe_u32 v7, v15, 3, 2
    v_lshl_add_u32 v240, v7, 5, v240
    v_mfma_f32_16x16x32_bf16 v[216:219], a[172:175], a[56:59], v[216:219]
    buffer_load_dwordx4 v0, s[52:55], s5 offen offset:1024 lds
    v_and_b32 v7, 3, v15
    v_lshl_add_u32 v240, v7, 3, v240
    v_mfma_f32_16x16x32_bf16 v[172:175], a[160:163], a[60:63], v[172:175]
    s_add_u32 m0, s63, 57344
    v_mov_b32 v8, 2
    v_mov_b32 v9, 3
    v_mfma_f32_16x16x32_bf16 v[188:191], a[164:167], a[60:63], v[188:191]
    buffer_load_dwordx4 v12, s[52:55], s5 offen lds
    v_and_b32 v7, 512, v10
    v_add_u32 v7, v7, v10
    v_mfma_f32_16x16x32_bf16 v[204:207], a[168:171], a[60:63], v[204:207]
    s_xor_b32 s34, s82, 128
    v_xor_b32 v241, 32, v240
    v_mfma_f32_16x16x32_bf16 v[220:223], a[172:175], a[60:63], v[220:223]
    buffer_load_dwordx4 v13, s[52:55], s5 offen offset:1024 lds
    v_xor_b32 v242, 64, v240
    v_xor_b32 v243, 96, v240
    v_cmp_eq_u32 vcc, 0, v5
    s_and_b32 s37, vcc_lo, 39321
    s_cbranch_scc1 k_np0
    buffer_load_dwordx4 a[64:67], v2, s[28:31], s16 offen offset:0 sc1
    buffer_load_dwordx4 a[68:71], v2, s[28:31], s16 offen offset:1024 sc1
    buffer_load_dwordx4 a[72:75], v2, s[28:31], s16 offen offset:2048 sc1
    buffer_load_dwordx4 a[76:79], v2, s[28:31], s16 offen offset:3072 sc1
    buffer_load_dwordx4 a[80:83], v2, s[28:31], s17 offen offset:0 sc1
    buffer_load_dwordx4 a[84:87], v2, s[28:31], s17 offen offset:1024 sc1
    buffer_load_dwordx4 a[88:91], v2, s[28:31], s17 offen offset:2048 sc1
    buffer_load_dwordx4 a[92:95], v2, s[28:31], s17 offen offset:3072 sc1
    buffer_load_dwordx4 a[96:99], v2, s[28:31], s18 offen offset:0 sc1
    buffer_load_dwordx4 a[100:103], v2, s[28:31], s18 offen offset:1024 sc1
    buffer_load_dwordx4 a[104:107], v2, s[28:31], s18 offen offset:2048 sc1
    buffer_load_dwordx4 a[108:111], v2, s[28:31], s18 offen offset:3072 sc1
    buffer_load_dwordx4 a[112:115], v2, s[28:31], s19 offen offset:0 sc1
    buffer_load_dwordx4 a[116:119], v2, s[28:31], s19 offen offset:1024 sc1
    buffer_load_dwordx4 a[120:123], v2, s[28:31], s19 offen offset:2048 sc1
    buffer_load_dwordx4 a[124:127], v2, s[28:31], s19 offen offset:3072 sc1
    s_branch k_nf0
k_np0:
    buffer_load_dword v5, v6, s[28:31], s83 offen sc1
k_nf0:
    v_add_u32 v244, 65536, v240
    v_add_u32 v245, 65536, v241
    v_add_u32 v246, 65536, v242
    v_add_u32 v247, 65536, v243
    v_add_u32 v248, 131072, v240
    v_add_u32 v249, 131072, v241
    v_add_u32 v250, 131072, v242
    v_add_u32 v251, 131072, v243
    s_mov_b32 s88, s84
    s_and_b32 s89, s85, 0xffff
    s_mov_b32 s90, 4194304
    s_mov_b32 s91, 0x00020000
    v_pk_mul_f32 v[16:17], v[160:161], s[44:45]
    v_pk_mul_f32 v[18:19], v[162:163], s[44:45]
    v_pk_mul_f32 v[20:21], v[192:193], s[44:45]
    v_pk_mul_f32 v[22:23], v[194:195], s[44:45]
    v_exp_f32 v16, v16
    v_exp_f32 v17, v17
    v_exp_f32 v18, v18
    v_exp_f32 v19, v19
    v_exp_f32 v20, v20
    v_exp_f32 v21, v21
    v_exp_f32 v22, v22
    v_exp_f32 v23, v23
    v_pk_add_f32 v[16:17], v[16:17], s[46:47]
    v_pk_add_f32 v[18:19], v[18:19], s[46:47]
    v_pk_add_f32 v[20:21], v[20:21], s[46:47]
    v_pk_add_f32 v[22:23], v[22:23], s[46:47]
    v_rcp_f32 v16, v16
    v_rcp_f32 v17, v17
    v_rcp_f32 v18, v18
    v_rcp_f32 v19, v19
    v_rcp_f32 v20, v20
    v_rcp_f32 v21, v21
    v_rcp_f32 v22, v22
    v_rcp_f32 v23, v23
    s_cmp_eq_u32 s37, 0
    s_cbranch_scc1 k_nf1
    v_cmp_eq_u32 vcc, 0, v5
    s_and_b32 s37, vcc_lo, 39321
    s_cbranch_scc1 k_np1
    buffer_load_dwordx4 a[64:67], v2, s[28:31], s16 offen offset:0 sc1
    buffer_load_dwordx4 a[68:71], v2, s[28:31], s16 offen offset:1024 sc1
    buffer_load_dwordx4 a[72:75], v2, s[28:31], s16 offen offset:2048 sc1
    buffer_load_dwordx4 a[76:79], v2, s[28:31], s16 offen offset:3072 sc1
    buffer_load_dwordx4 a[80:83], v2, s[28:31], s17 offen offset:0 sc1
    buffer_load_dwordx4 a[84:87], v2, s[28:31], s17 offen offset:1024 sc1
    buffer_load_dwordx4 a[88:91], v2, s[28:31], s17 offen offset:2048 sc1
    buffer_load_dwordx4 a[92:95], v2, s[28:31], s17 offen offset:3072 sc1
    buffer_load_dwordx4 a[96:99], v2, s[28:31], s18 offen offset:0 sc1
    buffer_load_dwordx4 a[100:103], v2, s[28:31], s18 offen offset:1024 sc1
    buffer_load_dwordx4 a[104:107], v2, s[28:31], s18 offen offset:2048 sc1
    buffer_load_dwordx4 a[108:111], v2, s[28:31], s18 offen offset:3072 sc1
    buffer_load_dwordx4 a[112:115], v2, s[28:31], s19 offen offset:0 sc1
    buffer_load_dwordx4 a[116:119], v2, s[28:31], s19 offen offset:1024 sc1
    buffer_load_dwordx4 a[120:123], v2, s[28:31], s19 offen offset:2048 sc1
    buffer_load_dwordx4 a[124:127], v2, s[28:31], s19 offen offset:3072 sc1
    s_branch k_nf1
k_np1:
    buffer_load_dword v5, v6, s[28:31], s83 offen sc1
k_nf1:
    v_pk_mul_f32 v[16:17], v[16:17], v[160:161]
    v_pk_mul_f32 v[18:19], v[18:19], v[162:163]
    v_pk_mul_f32 v[20:21], v[20:21], v[192:193]
    v_pk_mul_f32 v[22:23], v[22:23], v[194:195]
    v_pk_mul_f32 v[16:17], v[16:17], v[176:177]
    v_pk_mul_f32 v[18:19], v[18:19], v[178:179]
    v_pk_mul_f32 v[20:21], v[20:21], v[208:209]
    v_pk_mul_f32 v[22:23], v[22:23], v[210:211]
    v_cvt_pk_bf16_f32 v160, v16, v17
    v_cvt_pk_bf16_f32 v161, v18, v19
    v_cvt_pk_bf16_f32 v162, v20, v21
    v_cvt_pk_bf16_f32 v163, v22, v23
    s_nop 1
    v_permlane16_swap_b32 v160, v162
    v_permlane16_swap_b32 v161, v163
    v_pk_mul_f32 v[24:25], v[164:165], s[44:45]
    v_pk_mul_f32 v[26:27], v[166:167], s[44:45]
    v_pk_mul_f32 v[28:29], v[196:197], s[44:45]
    v_pk_mul_f32 v[30:31], v[198:199], s[44:45]
    v_exp_f32 v24, v24
    v_exp_f32 v25, v25
    v_exp_f32 v26, v26
    v_exp_f32 v27, v27
    v_exp_f32 v28, v28
    v_exp_f32 v29, v29
    v_exp_f32 v30, v30
    v_exp_f32 v31, v31
    v_pk_add_f32 v[24:25], v[24:25], s[46:47]
    v_pk_add_f32 v[26:27], v[26:27], s[46:47]
    v_pk_add_f32 v[28:29], v[28:29], s[46:47]
    v_pk_add_f32 v[30:31], v[30:31], s[46:47]
    v_rcp_f32 v24, v24
    v_rcp_f32 v25, v25
    v_rcp_f32 v26, v26
    v_rcp_f32 v27, v27
    v_rcp_f32 v28, v28
    v_rcp_f32 v29, v29
    s_cmp_eq_u32 s37, 0
    s_cbranch_scc1 k_nf2
    v_cmp_eq_u32 vcc, 0, v5
    s_and_b32 s37, vcc_lo, 39321
    s_cbranch_scc1 k_np2
    buffer_load_dwordx4 a[64:67], v2, s[28:31], s16 offen offset:0 sc1
    buffer_load_dwordx4 a[68:71], v2, s[28:31], s16 offen offset:1024 sc1
    buffer_load_dwordx4 a[72:75], v2, s[28:31], s16 offen offset:2048 sc1
    buffer_load_dwordx4 a[76:79], v2, s[28:31], s16 offen offset:3072 sc1
    buffer_load_dwordx4 a[80:83], v2, s[28:31], s17 offen offset:0 sc1
    buffer_load_dwordx4 a[84:87], v2, s[28:31], s17 offen offset:1024 sc1
    buffer_load_dwordx4 a[88:91], v2, s[28:31], s17 offen offset:2048 sc1
    buffer_load_dwordx4 a[92:95], v2, s[28:31], s17 offen offset:3072 sc1
    buffer_load_dwordx4 a[96:99], v2, s[28:31], s18 offen offset:0 sc1
    buffer_load_dwordx4 a[100:103], v2, s[28:31], s18 offen offset:1024 sc1
    buffer_load_dwordx4 a[104:107], v2, s[28:31], s18 offen offset:2048 sc1
    buffer_load_dwordx4 a[108:111], v2, s[28:31], s18 offen offset:3072 sc1
    buffer_load_dwordx4 a[112:115], v2, s[28:31], s19 offen offset:0 sc1
    buffer_load_dwordx4 a[116:119], v2, s[28:31], s19 offen offset:1024 sc1
    buffer_load_dwordx4 a[120:123], v2, s[28:31], s19 offen offset:2048 sc1
    buffer_load_dwordx4 a[124:127], v2, s[28:31], s19 offen offset:3072 sc1
    s_branch k_nf2
k_np2:
    buffer_load_dword v5, v6, s[28:31], s83 offen sc1
k_nf2:
    v_rcp_f32 v30, v30
    v_rcp_f32 v31, v31
    v_pk_mul_f32 v[24:25], v[24:25], v[164:165]
    v_pk_mul_f32 v[26:27], v[26:27], v[166:167]
    v_pk_mul_f32 v[28:29], v[28:29], v[196:197]
    v_pk_mul_f32 v[30:31], v[30:31], v[198:199]
    v_pk_mul_f32 v[24:25], v[24:25], v[180:181]
    v_pk_mul_f32 v[26:27], v[26:27], v[182:183]
    v_pk_mul_f32 v[28:29], v[28:29], v[212:213]
    v_pk_mul_f32 v[30:31], v[30:31], v[214:215]
    v_cvt_pk_bf16_f32 v164, v24, v25
    v_cvt_pk_bf16_f32 v165, v26, v27
    v_cvt_pk_bf16_f32 v166, v28, v29
    v_cvt_pk_bf16_f32 v167, v30, v31
    s_nop 1
    v_permlane16_swap_b32 v164, v166
    v_permlane16_swap_b32 v165, v167
    ds_read_b64_tr_b16 v[96:97], v244 offset:32768
    ds_read_b64_tr_b16 v[98:99], v244 offset:34816
    ds_read_b64_tr_b16 v[100:101], v245 offset:32768
    ds_read_b64_tr_b16 v[102:103], v245 offset:34816
    ds_read_b64_tr_b16 v[104:105], v246 offset:32768
    ds_read_b64_tr_b16 v[106:107], v246 offset:34816
    ds_read_b64_tr_b16 v[108:109], v247 offset:32768
    ds_read_b64_tr_b16 v[110:111], v247 offset:34816
    ds_read_b64_tr_b16 v[112:113], v244 offset:36864
    ds_read_b64_tr_b16 v[114:115], v244 offset:38912
    ds_read_b64_tr_b16 v[116:117], v245 offset:36864
    ds_read_b64_tr_b16 v[118:119], v245 offset:38912
    ds_read_b64_tr_b16 v[120:121], v246 offset:36864
    ds_read_b64_tr_b16 v[122:123], v246 offset:38912
    ds_read_b64_tr_b16 v[124:125], v247 offset:36864
    ds_read_b64_tr_b16 v[126:127], v247 offset:38912
    v_pk_mul_f32 v[16:17], v[168:169], s[44:45]
    v_pk_mul_f32 v[18:19], v[170:171], s[44:45]
    v_pk_mul_f32 v[20:21], v[200:201], s[44:45]
    v_pk_mul_f32 v[22:23], v[202:203], s[44:45]
    s_cmp_eq_u32 s37, 0
    s_cbranch_scc1 k_nf3
    v_cmp_eq_u32 vcc, 0, v5
    s_and_b32 s37, vcc_lo, 39321
    s_cbranch_scc1 k_np3
    buffer_load_dwordx4 a[64:67], v2, s[28:31], s16 offen offset:0 sc1
    buffer_load_dwordx4 a[68:71], v2, s[28:31], s16 offen offset:1024 sc1
    buffer_load_dwordx4 a[72:75], v2, s[28:31], s16 offen offset:2048 sc1
    buffer_load_dwordx4 a[76:79], v2, s[28:31], s16 offen offset:3072 sc1
    buffer_load_dwordx4 a[80:83], v2, s[28:31], s17 offen offset:0 sc1
    buffer_load_dwordx4 a[84:87], v2, s[28:31], s17 offen offset:1024 sc1
    buffer_load_dwordx4 a[88:91], v2, s[28:31], s17 offen offset:2048 sc1
    buffer_load_dwordx4 a[92:95], v2, s[28:31], s17 offen offset:3072 sc1
    buffer_load_dwordx4 a[96:99], v2, s[28:31], s18 offen offset:0 sc1
    buffer_load_dwordx4 a[100:103], v2, s[28:31], s18 offen offset:1024 sc1
    buffer_load_dwordx4 a[104:107], v2, s[28:31], s18 offen offset:2048 sc1
    buffer_load_dwordx4 a[108:111], v2, s[28:31], s18 offen offset:3072 sc1
    buffer_load_dwordx4 a[112:115], v2, s[28:31], s19 offen offset:0 sc1
    buffer_load_dwordx4 a[116:119], v2, s[28:31], s19 offen offset:1024 sc1
    buffer_load_dwordx4 a[120:123], v2, s[28:31], s19 offen offset:2048 sc1
    buffer_load_dwordx4 a[124:127], v2, s[28:31], s19 offen offset:3072 sc1
    s_branch k_nf3
k_np3:
    buffer_load_dword v5, v6, s[28:31], s83 offen sc1
k_nf3:
    v_exp_f32 v16, v16
    v_exp_f32 v17, v17
    v_exp_f32 v18, v18
    v_exp_f32 v19, v19
    v_exp_f32 v20, v20
    v_exp_f32 v21, v21
    v_exp_f32 v22, v22
    v_exp_f32 v23, v23
    v_pk_add_f32 v[16:17], v[16:17], s[46:47]
    v_pk_add_f32 v[18:19], v[18:19], s[46:47]
    v_pk_add_f32 v[20:21], v[20:21], s[46:47]
    v_pk_add_f32 v[22:23], v[22:23], s[46:47]
    v_rcp_f32 v16, v16
    v_rcp_f32 v17, v17
    v_rcp_f32 v18, v18
    v_rcp_f32 v19, v19
    v_rcp_f32 v20, v20
    v_rcp_f32 v21, v21
    v_rcp_f32 v22, v22
    v_rcp_f32 v23, v23
    v_pk_mul_f32 v[16:17], v[16:17], v[168:169]
    v_pk_mul_f32 v[18:19], v[18:19], v[170:171]
    v_pk_mul_f32 v[20:21], v[20:21], v[200:201]
    v_pk_mul_f32 v[22:23], v[22:23], v[202:203]
    v_pk_mul_f32 v[16:17], v[16:17], v[184:185]
    v_pk_mul_f32 v[18:19], v[18:19], v[186:187]
    v_pk_mul_f32 v[20:21], v[20:21], v[216:217]
    v_pk_mul_f32 v[22:23], v[22:23], v[218:219]
    v_cvt_pk_bf16_f32 v168, v16, v17
    v_cvt_pk_bf16_f32 v169, v18, v19
    v_cvt_pk_bf16_f32 v170, v20, v21
    v_cvt_pk_bf16_f32 v171, v22, v23
    s_nop 1
    v_permlane16_swap_b32 v168, v170
    v_permlane16_swap_b32 v169, v171
    v_pk_mul_f32 v[24:25], v[172:173], s[44:45]
    v_pk_mul_f32 v[26:27], v[174:175], s[44:45]
    s_cmp_eq_u32 s37, 0
    s_cbranch_scc1 k_nf4
    v_cmp_eq_u32 vcc, 0, v5
    s_and_b32 s37, vcc_lo, 39321
    s_cbranch_scc1 k_np4
    buffer_load_dwordx4 a[64:67], v2, s[28:31], s16 offen offset:0 sc1
    buffer_load_dwordx4 a[68:71], v2, s[28:31], s16 offen offset:1024 sc1
    buffer_load_dwordx4 a[72:75], v2, s[28:31], s16 offen offset:2048 sc1
    buffer_load_dwordx4 a[76:79], v2, s[28:31], s16 offen offset:3072 sc1
    buffer_load_dwordx4 a[80:83], v2, s[28:31], s17 offen offset:0 sc1
    buffer_load_dwordx4 a[84:87], v2, s[28:31], s17 offen offset:1024 sc1
    buffer_load_dwordx4 a[88:91], v2, s[28:31], s17 offen offset:2048 sc1
    buffer_load_dwordx4 a[92:95], v2, s[28:31], s17 offen offset:3072 sc1
    buffer_load_dwordx4 a[96:99], v2, s[28:31], s18 offen offset:0 sc1
    buffer_load_dwordx4 a[100:103], v2, s[28:31], s18 offen offset:1024 sc1
    buffer_load_dwordx4 a[104:107], v2, s[28:31], s18 offen offset:2048 sc1
    buffer_load_dwordx4 a[108:111], v2, s[28:31], s18 offen offset:3072 sc1
    buffer_load_dwordx4 a[112:115], v2, s[28:31], s19 offen offset:0 sc1
    buffer_load_dwordx4 a[116:119], v2, s[28:31], s19 offen offset:1024 sc1
    buffer_load_dwordx4 a[120:123], v2, s[28:31], s19 offen offset:2048 sc1
    buffer_load_dwordx4 a[124:127], v2, s[28:31], s19 offen offset:3072 sc1
    s_branch k_nf4
k_np4:
    buffer_load_dword v5, v6, s[28:31], s83 offen sc1
k_nf4:
    v_pk_mul_f32 v[28:29], v[204:205], s[44:45]
    v_pk_mul_f32 v[30:31], v[206:207], s[44:45]
    v_exp_f32 v24, v24
    v_exp_f32 v25, v25
    v_exp_f32 v26, v26
    v_exp_f32 v27, v27
    v_exp_f32 v28, v28
    v_exp_f32 v29, v29
    v_exp_f32 v30, v30
    v_exp_f32 v31, v31
    v_pk_add_f32 v[24:25], v[24:25], s[46:47]
    v_pk_add_f32 v[26:27], v[26:27], s[46:47]
    v_pk_add_f32 v[28:29], v[28:29], s[46:47]
    v_pk_add_f32 v[30:31], v[30:31], s[46:47]
    v_rcp_f32 v24, v24
    v_rcp_f32 v25, v25
    v_rcp_f32 v26, v26
    v_rcp_f32 v27, v27
    v_rcp_f32 v28, v28
    v_rcp_f32 v29, v29
    v_rcp_f32 v30, v30
    v_rcp_f32 v31, v31
    v_pk_mul_f32 v[24:25], v[24:25], v[172:173]
    v_pk_mul_f32 v[26:27], v[26:27], v[174:175]
    v_pk_mul_f32 v[28:29], v[28:29], v[204:205]
    v_pk_mul_f32 v[30:31], v[30:31], v[206:207]
    v_pk_mul_f32 v[24:25], v[24:25], v[188:189]
    v_pk_mul_f32 v[26:27], v[26:27], v[190:191]
    v_pk_mul_f32 v[28:29], v[28:29], v[220:221]
    v_pk_mul_f32 v[30:31], v[30:31], v[222:223]
    v_cvt_pk_bf16_f32 v172, v24, v25
    v_cvt_pk_bf16_f32 v173, v26, v27
    v_cvt_pk_bf16_f32 v174, v28, v29
    v_cvt_pk_bf16_f32 v175, v30, v31
    s_nop 1
    v_permlane16_swap_b32 v172, v174
    v_permlane16_swap_b32 v173, v175
    s_cmp_eq_u32 s37, 0
    s_cbranch_scc1 k_h_ok
    v_cmp_eq_u32 vcc, 0, v5
    s_and_b32 s37, vcc_lo, 39321
    s_cbranch_scc0 k_h_go
    s_mov_b32 s3, 0x20000
k_hpoll:
    buffer_load_dword v5, v6, s[28:31], s83 offen sc1
    s_waitcnt vmcnt(0)
    v_cmp_eq_u32 vcc, 0, v5
    s_and_b32 s43, vcc_lo, 39321
    s_cbranch_scc0 k_h_go
    s_sub_u32 s3, s3, 1
    s_cbranch_scc0 k_hpoll
k_h_go:
    buffer_load_dwordx4 a[64:67], v2, s[28:31], s16 offen offset:0 sc1
    buffer_load_dwordx4 a[68:71], v2, s[28:31], s16 offen offset:1024 sc1
    buffer_load_dwordx4 a[72:75], v2, s[28:31], s16 offen offset:2048 sc1
    buffer_load_dwordx4 a[76:79], v2, s[28:31], s16 offen offset:3072 sc1
    buffer_load_dwordx4 a[80:83], v2, s[28:31], s17 offen offset:0 sc1
    buffer_load_dwordx4 a[84:87], v2, s[28:31], s17 offen offset:1024 sc1
    buffer_load_dwordx4 a[88:91], v2, s[28:31], s17 offen offset:2048 sc1
    buffer_load_dwordx4 a[92:95], v2, s[28:31], s17 offen offset:3072 sc1
    buffer_load_dwordx4 a[96:99], v2, s[28:31], s18 offen offset:0 sc1
    buffer_load_dwordx4 a[100:103], v2, s[28:31], s18 offen offset:1024 sc1
    buffer_load_dwordx4 a[104:107], v2, s[28:31], s18 offen offset:2048 sc1
    buffer_load_dwordx4 a[108:111], v2, s[28:31], s18 offen offset:3072 sc1
    buffer_load_dwordx4 a[112:115], v2, s[28:31], s19 offen offset:0 sc1
    buffer_load_dwordx4 a[116:119], v2, s[28:31], s19 offen offset:1024 sc1
    buffer_load_dwordx4 a[120:123], v2, s[28:31], s19 offen offset:2048 sc1
    buffer_load_dwordx4 a[124:127], v2, s[28:31], s19 offen offset:3072 sc1
k_h_ok:
.p2align 3
    s_waitcnt vmcnt(12) lgkmcnt(0)
    v_mfma_f32_16x16x32_bf16 v[64:67], v[96:99], a[64:67], 0
    ds_read_b64_tr_b16 v[128:129], v244 offset:40960
    ds_read_b64_tr_b16 v[130:131], v244 offset:43008
    v_mfma_f32_16x16x32_bf16 v[68:71], v[96:99], a[68:71], 0
    ds_read_b64_tr_b16 v[132:133], v245 offset:40960
    v_mfma_f32_16x16x32_bf16 v[76:79], v[100:103], a[68:71], 0
    ds_read_b64_tr_b16 v[134:135], v245 offset:43008
    v_mfma_f32_16x16x32_bf16 v[72:75], v[100:103], a[64:67], 0
    ds_read_b64_tr_b16 v[136:137], v246 offset:40960
    buffer_load_dwordx4 a[128:131], v2, s[28:31], s20 offen offset:0 sc1
    v_mfma_f32_16x16x32_bf16 v[80:83], v[104:107], a[64:67], 0
    ds_read_b64_tr_b16 v[138:139], v246 offset:43008
    v_mfma_f32_16x16x32_bf16 v[84:87], v[104:107], a[68:71], 0
    ds_read_b64_tr_b16 v[140:141], v247 offset:40960
    buffer_load_dwordx4 a[132:135], v2, s[28:31], s20 offen offset:1024 sc1
    v_mfma_f32_16x16x32_bf16 v[92:95], v[108:111], a[68:71], 0
    ds_read_b64_tr_b16 v[142:143], v247 offset:43008
    v_mfma_f32_16x16x32_bf16 v[88:91], v[108:111], a[64:67], 0
    buffer_load_dwordx4 a[136:139], v2, s[28:31], s20 offen offset:2048 sc1
    v_mfma_f32_16x16x32_bf16 v[64:67], v[112:115], a[72:75], v[64:67]
    ds_read_b64_tr_b16 v[144:145], v244 offset:45056
    v_mfma_f32_16x16x32_bf16 v[68:71], v[112:115], a[76:79], v[68:71]
    ds_read_b64_tr_b16 v[146:147], v244 offset:47104
    v_mfma_f32_16x16x32_bf16 v[76:79], v[116:119], a[76:79], v[76:79]
    ds_read_b64_tr_b16 v[148:149], v245 offset:45056
    buffer_load_dwordx4 a[140:143], v2, s[28:31], s20 offen offset:3072 sc1
    v_mfma_f32_16x16x32_bf16 v[72:75], v[116:119], a[72:75], v[72:75]
    ds_read_b64_tr_b16 v[150:151], v245 offset:47104
    v_mfma_f32_16x16x32_bf16 v[80:83], v[120:123], a[72:75], v[80:83]
    ds_read_b64_tr_b16 v[152:153], v246 offset:45056
    buffer_store_dwordx4 v[224:227], v7, s[28:31], s56 offen sc0 sc1
    v_mfma_f32_16x16x32_bf16 v[84:87], v[120:123], a[76:79], v[84:87]
    ds_read_b64_tr_b16 v[154:155], v246 offset:47104
    v_mfma_f32_16x16x32_bf16 v[92:95], v[124:127], a[76:79], v[92:95]
    ds_read_b64_tr_b16 v[156:157], v247 offset:45056
    buffer_store_dwordx4 v[232:235], v7, s[28:31], s57 offen sc0 sc1
    v_mfma_f32_16x16x32_bf16 v[88:91], v[124:127], a[72:75], v[88:91]
    ds_read_b64_tr_b16 v[158:159], v247 offset:47104
    s_waitcnt vmcnt(18) lgkmcnt(8)
    v_mfma_f32_16x16x32_bf16 v[32:35], v[128:131], a[64:67], 0
    ds_read_b64_tr_b16 v[96:97], v244 offset:49152
    ds_read_b64_tr_b16 v[98:99], v244 offset:51200
    v_mfma_f32_16x16x32_bf16 v[36:39], v[128:131], a[68:71], 0
    ds_read_b64_tr_b16 v[100:101], v245 offset:49152
    buffer_load_dwordx4 a[144:147], v2, s[28:31], s21 offen offset:0 sc1
    v_mfma_f32_16x16x32_bf16 v[44:47], v[132:135], a[68:71], 0
    ds_read_b64_tr_b16 v[102:103], v245 offset:51200
    v_mfma_f32_16x16x32_bf16 v[40:43], v[132:135], a[64:67], 0
    ds_read_b64_tr_b16 v[104:105], v246 offset:49152
    buffer_load_dwordx4 a[148:151], v2, s[28:31], s21 offen offset:1024 sc1
    v_mfma_f32_16x16x32_bf16 v[48:51], v[136:139], a[64:67], 0
    ds_read_b64_tr_b16 v[106:107], v246 offset:51200
    v_mfma_f32_16x16x32_bf16 v[52:55], v[136:139], a[68:71], 0
    ds_read_b64_tr_b16 v[108:109], v247 offset:49152
    buffer_load_dwordx4 a[152:155], v2, s[28:31], s21 offen offset:2048 sc1
    v_mfma_f32_16x16x32_bf16 v[60:63], v[140:143], a[68:71], 0
    ds_read_b64_tr_b16 v[110:111], v247 offset:51200
    v_mfma_f32_16x16x32_bf16 v[56:59], v[140:143], a[64:67], 0
    s_waitcnt lgkmcnt(8)
    buffer_load_dwordx4 a[156:159], v2, s[28:31], s21 offen offset:3072 sc1
    v_mfma_f32_16x16x32_bf16 v[32:35], v[144:147], a[72:75], v[32:35]
    ds_read_b64_tr_b16 v[112:113], v244 offset:53248
    v_mfma_f32_16x16x32_bf16 v[36:39], v[144:147], a[76:79], v[36:39]
    ds_read_b64_tr_b16 v[114:115], v244 offset:55296
    v_mfma_f32_16x16x32_bf16 v[44:47], v[148:151], a[76:79], v[44:47]
    ds_read_b64_tr_b16 v[116:117], v245 offset:53248
    buffer_load_dwordx4 a[160:163], v2, s[28:31], s22 offen offset:0 sc1
    v_mfma_f32_16x16x32_bf16 v[40:43], v[148:151], a[72:75], v[40:43]
    ds_read_b64_tr_b16 v[118:119], v245 offset:55296
    v_mfma_f32_16x16x32_bf16 v[48:51], v[152:155], a[72:75], v[48:51]
    ds_read_b64_tr_b16 v[120:121], v246 offset:53248
    buffer_store_dwordx4 v[160:163], v10, s[28:31], s40 offen offset:0 sc0 sc1
    v_mfma_f32_16x16x32_bf16 v[52:55], v[152:155], a[76:79], v[52:55]
    ds_read_b64_tr_b16 v[122:123], v246 offset:55296
    v_mfma_f32_16x16x32_bf16 v[60:63], v[156:159], a[76:79], v[60:63]
    ds_read_b64_tr_b16 v[124:125], v247 offset:53248
    buffer_store_dwordx4 v[164:167], v10, s[28:31], s40 offen offset:1024 sc0 sc1
    v_mfma_f32_16x16x32_bf16 v[56:59], v[156:159], a[72:75], v[56:59]
    ds_read_b64_tr_b16 v[126:127], v247 offset:55296
    s_waitcnt vmcnt(21) lgkmcnt(8)
    v_mfma_f32_16x16x32_bf16 v[64:67], v[96:99], a[80:83], v[64:67]
    ds_read_b64_tr_b16 v[128:129], v244 offset:57344
    ds_read_b64_tr_b16 v[130:131], v244 offset:59392
    v_mfma_f32_16x16x32_bf16 v[68:71], v[96:99], a[84:87], v[68:71]
    ds_read_b64_tr_b16 v[132:133], v245 offset:57344
    v_mfma_f32_16x16x32_bf16 v[76:79], v[100:103], a[84:87], v[76:79]
    ds_read_b64_tr_b16 v[134:135], v245 offset:59392
    v_mfma_f32_16x16x32_bf16 v[72:75], v[100:103], a[80:83], v[72:75]
    ds_read_b64_tr_b16 v[136:137], v246 offset:57344
    buffer_load_dwordx4 a[164:167], v2, s[28:31], s22 offen offset:1024 sc1
    v_mfma_f32_16x16x32_bf16 v[80:83], v[104:107], a[80:83], v[80:83]
    ds_read_b64_tr_b16 v[138:139], v246 offset:59392
    v_mfma_f32_16x16x32_bf16 v[84:87], v[104:107], a[84:87], v[84:87]
    ds_read_b64_tr_b16 v[140:141], v247 offset:57344
    buffer_load_dwordx4 a[168:171], v2, s[28:31], s22 offen offset:2048 sc1
    v_mfma_f32_16x16x32_bf16 v[92:95], v[108:111], a[84:87], v[92:95]
    ds_read_b64_tr_b16 v[142:143], v247 offset:59392
    v_mfma_f32_16x16x32_bf16 v[88:91], v[108:111], a[80:83], v[88:91]
    s_waitcnt lgkmcnt(8)
    buffer_load_dwordx4 a[172:175], v2, s[28:31], s22 offen offset:3072 sc1
    v_mfma_f32_16x16x32_bf16 v[64:67], v[112:115], a[88:91], v[64:67]
    ds_read_b64_tr_b16 v[144:145], v244 offset:61440
    v_mfma_f32_16x16x32_bf16 v[68:71], v[112:115], a[92:95], v[68:71]
    ds_read_b64_tr_b16 v[146:147], v244 offset:63488
    v_mfma_f32_16x16x32_bf16 v[76:79], v[116:119], a[92:95], v[76:79]
    ds_read_b64_tr_b16 v[148:149], v245 offset:61440
    buffer_load_dwordx4 a[176:179], v2, s[28:31], s23 offen offset:0 sc1
    v_mfma_f32_16x16x32_bf16 v[72:75], v[116:119], a[88:91], v[72:75]
    ds_read_b64_tr_b16 v[150:151], v245 offset:63488
    v_mfma_f32_16x16x32_bf16 v[80:83], v[120:123], a[88:91], v[80:83]
    ds_read_b64_tr_b16 v[152:153], v246 offset:61440
    buffer_store_dwordx4 v[168:171], v10, s[28:31], s41 offen offset:0 sc0 sc1
    v_mfma_f32_16x16x32_bf16 v[84:87], v[120:123], a[92:95], v[84:87]
    ds_read_b64_tr_b16 v[154:155], v246 offset:63488
    v_mfma_f32_16x16x32_bf16 v[92:95], v[124:127], a[92:95], v[92:95]
    ds_read_b64_tr_b16 v[156:157], v247 offset:61440
    buffer_store_dwordx4 v[172:175], v10, s[28:31], s41 offen offset:1024 sc0 sc1
    v_mfma_f32_16x16x32_bf16 v[88:91], v[124:127], a[88:91], v[88:91]
    ds_read_b64_tr_b16 v[158:159], v247 offset:63488
    s_waitcnt vmcnt(27) lgkmcnt(8)
    v_mfma_f32_16x16x32_bf16 v[32:35], v[128:131], a[80:83], v[32:35]
    ds_read_b64_tr_b16 v[96:97], v248 offset:0
    ds_read_b64_tr_b16 v[98:99], v248 offset:2048
    v_mfma_f32_16x16x32_bf16 v[36:39], v[128:131], a[84:87], v[36:39]
    ds_read_b64_tr_b16 v[100:101], v249 offset:0
    v_mfma_f32_16x16x32_bf16 v[44:47], v[132:135], a[84:87], v[44:47]
    ds_read_b64_tr_b16 v[102:103], v249 offset:2048
    v_mfma_f32_16x16x32_bf16 v[40:43], v[132:135], a[80:83], v[40:43]
    ds_read_b64_tr_b16 v[104:105], v250 offset:0
    v_mfma_f32_16x16x32_bf16 v[48:51], v[136:139], a[80:83], v[48:51]
    ds_read_b64_tr_b16 v[106:107], v250 offset:2048
    v_mfma_f32_16x16x32_bf16 v[52:55], v[136:139], a[84:87], v[52:55]
    ds_read_b64_tr_b16 v[108:109], v251 offset:0
    buffer_load_dwordx4 a[180:183], v2, s[28:31], s23 offen offset:1024 sc1
    v_mfma_f32_16x16x32_bf16 v[60:63], v[140:143], a[84:87], v[60:63]
    ds_read_b64_tr_b16 v[110:111], v251 offset:2048
    v_mfma_f32_16x16x32_bf16 v[56:59], v[140:143], a[80:83], v[56:59]
    s_waitcnt lgkmcnt(8)
    buffer_load_dwordx4 a[184:187], v2, s[28:31], s23 offen offset:2048 sc1
    v_mfma_f32_16x16x32_bf16 v[32:35], v[144:147], a[88:91], v[32:35]
    ds_read_b64_tr_b16 v[112:113], v248 offset:4096
    v_mfma_f32_16x16x32_bf16 v[36:39], v[144:147], a[92:95], v[36:39]
    ds_read_b64_tr_b16 v[114:115], v248 offset:6144
    v_mfma_f32_16x16x32_bf16 v[44:47], v[148:151], a[92:95], v[44:47]
    ds_read_b64_tr_b16 v[116:117], v249 offset:4096
    v_mfma_f32_16x16x32_bf16 v[40:43], v[148:151], a[88:91], v[40:43]
    ds_read_b64_tr_b16 v[118:119], v249 offset:6144
    v_mfma_f32_16x16x32_bf16 v[48:51], v[152:155], a[88:91], v[48:51]
    ds_read_b64_tr_b16 v[120:121], v250 offset:4096
    v_mfma_f32_16x16x32_bf16 v[52:55], v[152:155], a[92:95], v[52:55]
    ds_read_b64_tr_b16 v[122:123], v250 offset:6144
    v_mfma_f32_16x16x32_bf16 v[60:63], v[156:159], a[92:95], v[60:63]
    ds_read_b64_tr_b16 v[124:125], v251 offset:4096
    buffer_load_dwordx4 a[188:191], v2, s[28:31], s23 offen offset:3072 sc1
    v_mfma_f32_16x16x32_bf16 v[56:59], v[156:159], a[88:91], v[56:59]
    ds_read_b64_tr_b16 v[126:127], v251 offset:6144
    s_waitcnt vmcnt(26) lgkmcnt(8)
    s_barrier
    v_mfma_f32_16x16x32_bf16 v[64:67], v[96:99], a[96:99], v[64:67]
    ds_read_b64_tr_b16 v[128:129], v248 offset:8192
    ds_read_b64_tr_b16 v[130:131], v248 offset:10240
    v_mfma_f32_16x16x32_bf16 v[68:71], v[96:99], a[100:103], v[68:71]
    ds_read_b64_tr_b16 v[132:133], v249 offset:8192
    s_add_u32 s6, s6, s59
    v_mfma_f32_16x16x32_bf16 v[76:79], v[100:103], a[100:103], v[76:79]
    ds_read_b64_tr_b16 v[134:135], v249 offset:10240
    v_mfma_f32_16x16x32_bf16 v[72:75], v[100:103], a[96:99], v[72:75]
    ds_read_b64_tr_b16 v[136:137], v250 offset:8192
    s_add_u32 m0, s63, 98304
    v_mfma_f32_16x16x32_bf16 v[80:83], v[104:107], a[96:99], v[80:83]
    ds_read_b64_tr_b16 v[138:139], v250 offset:10240
    buffer_load_dwordx4 v14, s[52:55], s6 offen lds
    v_mfma_f32_16x16x32_bf16 v[84:87], v[104:107], a[100:103], v[84:87]
    ds_read_b64_tr_b16 v[140:141], v251 offset:8192
    buffer_load_dwordx4 v0, s[52:55], s6 offen offset:1024 lds
    v_mfma_f32_16x16x32_bf16 v[92:95], v[108:111], a[100:103], v[92:95]
    ds_read_b64_tr_b16 v[142:143], v251 offset:10240
    s_add_u32 m0, s63, 106496
    v_mfma_f32_16x16x32_bf16 v[88:91], v[108:111], a[96:99], v[88:91]
    s_waitcnt lgkmcnt(8)
    buffer_load_dwordx4 v12, s[52:55], s6 offen lds
    v_mfma_f32_16x16x32_bf16 v[64:67], v[112:115], a[104:107], v[64:67]
    ds_read_b64_tr_b16 v[144:145], v248 offset:12288
    buffer_load_dwordx4 v13, s[52:55], s6 offen offset:1024 lds
    v_mfma_f32_16x16x32_bf16 v[68:71], v[112:115], a[108:111], v[68:71]
    ds_read_b64_tr_b16 v[146:147], v248 offset:14336
    v_mfma_f32_16x16x32_bf16 v[76:79], v[116:119], a[108:111], v[76:79]
    ds_read_b64_tr_b16 v[148:149], v249 offset:12288
    s_add_u32 s7, s7, s62
    v_mfma_f32_16x16x32_bf16 v[72:75], v[116:119], a[104:107], v[72:75]
    ds_read_b64_tr_b16 v[150:151], v249 offset:14336
    v_mfma_f32_16x16x32_bf16 v[80:83], v[120:123], a[104:107], v[80:83]
    ds_read_b64_tr_b16 v[152:153], v250 offset:12288
    s_add_u32 m0, s63, 114688
    v_mfma_f32_16x16x32_bf16 v[84:87], v[120:123], a[108:111], v[84:87]
    ds_read_b64_tr_b16 v[154:155], v250 offset:14336
    buffer_load_dwordx4 v14, s[52:55], s7 offen lds
    v_mfma_f32_16x16x32_bf16 v[92:95], v[124:127], a[108:111], v[92:95]
    ds_read_b64_tr_b16 v[156:157], v251 offset:12288
    buffer_load_dwordx4 v0, s[52:55], s7 offen offset:1024 lds
    v_mfma_f32_16x16x32_bf16 v[88:91], v[124:127], a[104:107], v[88:91]
    ds_read_b64_tr_b16 v[158:159], v251 offset:14336
    s_waitcnt vmcnt(32) lgkmcnt(8)
    v_mfma_f32_16x16x32_bf16 v[32:35], v[128:131], a[96:99], v[32:35]
    ds_read_b64_tr_b16 v[96:97], v248 offset:16384
    ds_read_b64_tr_b16 v[98:99], v248 offset:18432
    v_mfma_f32_16x16x32_bf16 v[36:39], v[128:131], a[100:103], v[36:39]
    ds_read_b64_tr_b16 v[100:101], v249 offset:16384
    v_mfma_f32_16x16x32_bf16 v[44:47], v[132:135], a[100:103], v[44:47]
    ds_read_b64_tr_b16 v[102:103], v249 offset:18432
    v_mfma_f32_16x16x32_bf16 v[40:43], v[132:135], a[96:99], v[40:43]
    ds_read_b64_tr_b16 v[104:105], v250 offset:16384
    v_mfma_f32_16x16x32_bf16 v[48:51], v[136:139], a[96:99], v[48:51]
    ds_read_b64_tr_b16 v[106:107], v250 offset:18432
    v_mfma_f32_16x16x32_bf16 v[52:55], v[136:139], a[100:103], v[52:55]
    ds_read_b64_tr_b16 v[108:109], v251 offset:16384
    s_add_u32 m0, s63, 122880
    v_mfma_f32_16x16x32_bf16 v[60:63], v[140:143], a[100:103], v[60:63]
    ds_read_b64_tr_b16 v[110:111], v251 offset:18432
    v_mfma_f32_16x16x32_bf16 v[56:59], v[140:143], a[96:99], v[56:59]
    s_waitcnt lgkmcnt(8)
    buffer_load_dwordx4 v12, s[52:55], s7 offen lds
    v_mfma_f32_16x16x32_bf16 v[32:35], v[144:147], a[104:107], v[32:35]
    ds_read_b64_tr_b16 v[112:113], v248 offset:20480
    v_mfma_f32_16x16x32_bf16 v[36:39], v[144:147], a[108:111], v[36:39]
    ds_read_b64_tr_b16 v[114:115], v248 offset:22528
    v_mfma_f32_16x16x32_bf16 v[44:47], v[148:151], a[108:111], v[44:47]
    ds_read_b64_tr_b16 v[116:117], v249 offset:20480
    v_mfma_f32_16x16x32_bf16 v[40:43], v[148:151], a[104:107], v[40:43]
    ds_read_b64_tr_b16 v[118:119], v249 offset:22528
    v_mfma_f32_16x16x32_bf16 v[48:51], v[152:155], a[104:107], v[48:51]
    ds_read_b64_tr_b16 v[120:121], v250 offset:20480
    buffer_load_dwordx4 v13, s[52:55], s7 offen offset:1024 lds
    v_mfma_f32_16x16x32_bf16 v[52:55], v[152:155], a[108:111], v[52:55]
    ds_read_b64_tr_b16 v[122:123], v250 offset:22528
    v_mfma_f32_16x16x32_bf16 v[60:63], v[156:159], a[108:111], v[60:63]
    ds_read_b64_tr_b16 v[124:125], v251 offset:20480
    buffer_load_dword v5, v6, s[28:31], s83 offen sc1
    v_mfma_f32_16x16x32_bf16 v[56:59], v[156:159], a[104:107], v[56:59]
    ds_read_b64_tr_b16 v[126:127], v251 offset:22528
    s_waitcnt vmcnt(31) lgkmcnt(8)
    s_barrier
    v_mfma_f32_16x16x32_bf16 v[64:67], v[96:99], a[112:115], v[64:67]
    ds_read_b64_tr_b16 v[128:129], v248 offset:24576
    ds_read_b64_tr_b16 v[130:131], v248 offset:26624
    v_mfma_f32_16x16x32_bf16 v[68:71], v[96:99], a[116:119], v[68:71]
    ds_read_b64_tr_b16 v[132:133], v249 offset:24576
    s_add_u32 s8, s8, s59
    v_mfma_f32_16x16x32_bf16 v[76:79], v[100:103], a[116:119], v[76:79]
    ds_read_b64_tr_b16 v[134:135], v249 offset:26624
    v_mfma_f32_16x16x32_bf16 v[72:75], v[100:103], a[112:115], v[72:75]
    ds_read_b64_tr_b16 v[136:137], v250 offset:24576
    s_add_u32 m0, s63, 131072
    v_mfma_f32_16x16x32_bf16 v[80:83], v[104:107], a[112:115], v[80:83]
    ds_read_b64_tr_b16 v[138:139], v250 offset:26624
    v_mfma_f32_16x16x32_bf16 v[84:87], v[104:107], a[116:119], v[84:87]
    ds_read_b64_tr_b16 v[140:141], v251 offset:24576
    buffer_load_dwordx4 v14, s[52:55], s8 offen lds
    v_mfma_f32_16x16x32_bf16 v[92:95], v[108:111], a[116:119], v[92:95]
    ds_read_b64_tr_b16 v[142:143], v251 offset:26624
    v_mfma_f32_16x16x32_bf16 v[88:91], v[108:111], a[112:115], v[88:91]
    s_waitcnt lgkmcnt(8)
    buffer_load_dwordx4 v0, s[52:55], s8 offen offset:1024 lds
    v_mfma_f32_16x16x32_bf16 v[64:67], v[112:115], a[120:123], v[64:67]
    ds_read_b64_tr_b16 v[144:145], v248 offset:28672
    v_mfma_f32_16x16x32_bf16 v[68:71], v[112:115], a[124:127], v[68:71]
    ds_read_b64_tr_b16 v[146:147], v248 offset:30720
    v_mfma_f32_16x16x32_bf16 v[76:79], v[116:119], a[124:127], v[76:79]
    ds_read_b64_tr_b16 v[148:149], v249 offset:28672
    s_add_u32 m0, s63, 139264
    v_mfma_f32_16x16x32_bf16 v[72:75], v[116:119], a[120:123], v[72:75]
    ds_read_b64_tr_b16 v[150:151], v249 offset:30720
    v_mfma_f32_16x16x32_bf16 v[80:83], v[120:123], a[120:123], v[80:83]
    ds_read_b64_tr_b16 v[152:153], v250 offset:28672
    buffer_load_dwordx4 v12, s[52:55], s8 offen lds
    v_mfma_f32_16x16x32_bf16 v[84:87], v[120:123], a[124:127], v[84:87]
    ds_read_b64_tr_b16 v[154:155], v250 offset:30720
    v_mfma_f32_16x16x32_bf16 v[92:95], v[124:127], a[124:127], v[92:95]
    ds_read_b64_tr_b16 v[156:157], v251 offset:28672
    buffer_load_dwordx4 v13, s[52:55], s8 offen offset:1024 lds
    v_mfma_f32_16x16x32_bf16 v[88:91], v[124:127], a[120:123], v[88:91]
    ds_read_b64_tr_b16 v[158:159], v251 offset:30720
    s_waitcnt vmcnt(35) lgkmcnt(8)
    v_mfma_f32_16x16x32_bf16 v[32:35], v[128:131], a[112:115], v[32:35]
    ds_read_b64_tr_b16 v[96:97], v244 offset:0
    ds_read_b64_tr_b16 v[98:99], v244 offset:2048
    v_mfma_f32_16x16x32_bf16 v[36:39], v[128:131], a[116:119], v[36:39]
    ds_read_b64_tr_b16 v[100:101], v245 offset:0
    v_mfma_f32_16x16x32_bf16 v[44:47], v[132:135], a[116:119], v[44:47]
    ds_read_b64_tr_b16 v[102:103], v245 offset:2048
    v_mfma_f32_16x16x32_bf16 v[40:43], v[132:135], a[112:115], v[40:43]
    ds_read_b64_tr_b16 v[104:105], v246 offset:0
    v_mfma_f32_16x16x32_bf16 v[48:51], v[136:139], a[112:115], v[48:51]
    ds_read_b64_tr_b16 v[106:107], v246 offset:2048
    v_mfma_f32_16x16x32_bf16 v[52:55], v[136:139], a[116:119], v[52:55]
    ds_read_b64_tr_b16 v[108:109], v247 offset:0
    v_mfma_f32_16x16x32_bf16 v[60:63], v[140:143], a[116:119], v[60:63]
    ds_read_b64_tr_b16 v[110:111], v247 offset:2048
    v_mfma_f32_16x16x32_bf16 v[56:59], v[140:143], a[112:115], v[56:59]
    s_waitcnt lgkmcnt(8)
    v_mfma_f32_16x16x32_bf16 v[32:35], v[144:147], a[120:123], v[32:35]
    ds_read_b64_tr_b16 v[112:113], v244 offset:4096
    v_mfma_f32_16x16x32_bf16 v[36:39], v[144:147], a[124:127], v[36:39]
    ds_read_b64_tr_b16 v[114:115], v244 offset:6144
    v_mfma_f32_16x16x32_bf16 v[44:47], v[148:151], a[124:127], v[44:47]
    ds_read_b64_tr_b16 v[116:117], v245 offset:4096
    v_mfma_f32_16x16x32_bf16 v[40:43], v[148:151], a[120:123], v[40:43]
    ds_read_b64_tr_b16 v[118:119], v245 offset:6144
    v_mfma_f32_16x16x32_bf16 v[48:51], v[152:155], a[120:123], v[48:51]
    ds_read_b64_tr_b16 v[120:121], v246 offset:4096
    v_mfma_f32_16x16x32_bf16 v[52:55], v[152:155], a[124:127], v[52:55]
    ds_read_b64_tr_b16 v[122:123], v246 offset:6144
    v_mfma_f32_16x16x32_bf16 v[60:63], v[156:159], a[124:127], v[60:63]
    ds_read_b64_tr_b16 v[124:125], v247 offset:4096
    v_mfma_f32_16x16x32_bf16 v[56:59], v[156:159], a[120:123], v[56:59]
    ds_read_b64_tr_b16 v[126:127], v247 offset:6144
    s_waitcnt vmcnt(4) lgkmcnt(8)
    v_cmp_gt_u32 vcc, 1, v5
    s_cbranch_vccz k_c_ok8
    s_mov_b32 s3, 0x20000
k_cpoll8:
    s_sub_u32 s3, s3, 1
    s_cbranch_scc1 k_c_ok8
    buffer_load_dword v5, v6, s[28:31], s83 offen sc1
    s_waitcnt vmcnt(0)
    v_cmp_gt_u32 vcc, 1, v5
    s_cbranch_vccnz k_cpoll8
k_c_ok8:
    s_barrier
    v_mfma_f32_16x16x32_bf16 v[64:67], v[96:99], a[128:131], v[64:67]
    ds_read_b64_tr_b16 v[128:129], v244 offset:8192
    ds_read_b64_tr_b16 v[130:131], v244 offset:10240
    v_mfma_f32_16x16x32_bf16 v[68:71], v[96:99], a[132:135], v[68:71]
    ds_read_b64_tr_b16 v[132:133], v245 offset:8192
    s_add_u32 s16, s16, s36
    v_mfma_f32_16x16x32_bf16 v[76:79], v[100:103], a[132:135], v[76:79]
    ds_read_b64_tr_b16 v[134:135], v245 offset:10240
    v_mfma_f32_16x16x32_bf16 v[72:75], v[100:103], a[128:131], v[72:75]
    ds_read_b64_tr_b16 v[136:137], v246 offset:8192
    buffer_load_dwordx4 a[192:195], v2, s[28:31], s16 offen offset:0 sc1
    v_mfma_f32_16x16x32_bf16 v[80:83], v[104:107], a[128:131], v[80:83]
    ds_read_b64_tr_b16 v[138:139], v246 offset:10240
    v_mfma_f32_16x16x32_bf16 v[84:87], v[104:107], a[132:135], v[84:87]
    ds_read_b64_tr_b16 v[140:141], v247 offset:8192
    buffer_load_dwordx4 a[196:199], v2, s[28:31], s16 offen offset:1024 sc1
    v_mfma_f32_16x16x32_bf16 v[92:95], v[108:111], a[132:135], v[92:95]
    ds_read_b64_tr_b16 v[142:143], v247 offset:10240
    v_mfma_f32_16x16x32_bf16 v[88:91], v[108:111], a[128:131], v[88:91]
    s_waitcnt lgkmcnt(8)
    buffer_load_dwordx4 a[200:203], v2, s[28:31], s16 offen offset:2048 sc1
    v_mfma_f32_16x16x32_bf16 v[64:67], v[112:115], a[136:139], v[64:67]
    ds_read_b64_tr_b16 v[144:145], v244 offset:12288
    buffer_load_dwordx4 a[204:207], v2, s[28:31], s16 offen offset:3072 sc1
    v_mfma_f32_16x16x32_bf16 v[68:71], v[112:115], a[140:143], v[68:71]
    ds_read_b64_tr_b16 v[146:147], v244 offset:14336
    v_mfma_f32_16x16x32_bf16 v[76:79], v[116:119], a[140:143], v[76:79]
    ds_read_b64_tr_b16 v[148:149], v245 offset:12288
    s_add_u32 s17, s17, s58
    v_mfma_f32_16x16x32_bf16 v[72:75], v[116:119], a[136:139], v[72:75]
    ds_read_b64_tr_b16 v[150:151], v245 offset:14336
    v_mfma_f32_16x16x32_bf16 v[80:83], v[120:123], a[136:139], v[80:83]
    ds_read_b64_tr_b16 v[152:153], v246 offset:12288
    buffer_load_dwordx4 a[208:211], v2, s[28:31], s17 offen offset:0 sc1
    v_mfma_f32_16x16x32_bf16 v[84:87], v[120:123], a[140:143], v[84:87]
    ds_read_b64_tr_b16 v[154:155], v246 offset:14336
    v_mfma_f32_16x16x32_bf16 v[92:95], v[124:127], a[140:143], v[92:95]
    ds_read_b64_tr_b16 v[156:157], v247 offset:12288
    buffer_load_dwordx4 a[212:215], v2, s[28:31], s17 offen offset:1024 sc1
    v_mfma_f32_16x16x32_bf16 v[88:91], v[124:127], a[136:139], v[88:91]
    ds_read_b64_tr_b16 v[158:159], v247 offset:14336
    s_waitcnt vmcnt(22) lgkmcnt(8)
    s_mov_b64 exec, 1
    buffer_store_dword v8, v3, s[28:31], s82 offen sc1
    s_mov_b64 exec, -1
    v_mfma_f32_16x16x32_bf16 v[32:35], v[128:131], a[128:131], v[32:35]
    ds_read_b64_tr_b16 v[96:97], v244 offset:16384
    ds_read_b64_tr_b16 v[98:99], v244 offset:18432
    v_mfma_f32_16x16x32_bf16 v[36:39], v[128:131], a[132:135], v[36:39]
    ds_read_b64_tr_b16 v[100:101], v245 offset:16384
    v_mfma_f32_16x16x32_bf16 v[44:47], v[132:135], a[132:135], v[44:47]
    ds_read_b64_tr_b16 v[102:103], v245 offset:18432
    v_mfma_f32_16x16x32_bf16 v[40:43], v[132:135], a[128:131], v[40:43]
    ds_read_b64_tr_b16 v[104:105], v246 offset:16384
    buffer_load_dwordx4 a[216:219], v2, s[28:31], s17 offen offset:2048 sc1
    v_mfma_f32_16x16x32_bf16 v[48:51], v[136:139], a[128:131], v[48:51]
    ds_read_b64_tr_b16 v[106:107], v246 offset:18432
    v_mfma_f32_16x16x32_bf16 v[52:55], v[136:139], a[132:135], v[52:55]
    ds_read_b64_tr_b16 v[108:109], v247 offset:16384
    buffer_load_dwordx4 a[220:223], v2, s[28:31], s17 offen offset:3072 sc1
    v_mfma_f32_16x16x32_bf16 v[60:63], v[140:143], a[132:135], v[60:63]
    ds_read_b64_tr_b16 v[110:111], v247 offset:18432
    v_mfma_f32_16x16x32_bf16 v[56:59], v[140:143], a[128:131], v[56:59]
    s_waitcnt lgkmcnt(8)
    s_add_u32 s18, s18, s36
    v_mfma_f32_16x16x32_bf16 v[32:35], v[144:147], a[136:139], v[32:35]
    ds_read_b64_tr_b16 v[112:113], v244 offset:20480
    v_mfma_f32_16x16x32_bf16 v[36:39], v[144:147], a[140:143], v[36:39]
    ds_read_b64_tr_b16 v[114:115], v244 offset:22528
    v_mfma_f32_16x16x32_bf16 v[44:47], v[148:151], a[140:143], v[44:47]
    ds_read_b64_tr_b16 v[116:117], v245 offset:20480
    buffer_load_dwordx4 a[224:227], v2, s[28:31], s18 offen offset:0 sc1
    v_mfma_f32_16x16x32_bf16 v[40:43], v[148:151], a[136:139], v[40:43]
    ds_read_b64_tr_b16 v[118:119], v245 offset:22528
    v_mfma_f32_16x16x32_bf16 v[48:51], v[152:155], a[136:139], v[48:51]
    ds_read_b64_tr_b16 v[120:121], v246 offset:20480
    buffer_load_dwordx4 a[228:231], v2, s[28:31], s18 offen offset:1024 sc1
    v_mfma_f32_16x16x32_bf16 v[52:55], v[152:155], a[140:143], v[52:55]
    ds_read_b64_tr_b16 v[122:123], v246 offset:22528
    v_mfma_f32_16x16x32_bf16 v[60:63], v[156:159], a[140:143], v[60:63]
    ds_read_b64_tr_b16 v[124:125], v247 offset:20480
    buffer_load_dwordx4 a[232:235], v2, s[28:31], s18 offen offset:2048 sc1
    v_mfma_f32_16x16x32_bf16 v[56:59], v[156:159], a[136:139], v[56:59]
    ds_read_b64_tr_b16 v[126:127], v247 offset:22528
    s_waitcnt vmcnt(37) lgkmcnt(8)
    s_barrier
    v_mfma_f32_16x16x32_bf16 v[64:67], v[96:99], a[144:147], v[64:67]
    ds_read_b64_tr_b16 v[128:129], v244 offset:24576
    ds_read_b64_tr_b16 v[130:131], v244 offset:26624
    v_mfma_f32_16x16x32_bf16 v[68:71], v[96:99], a[148:151], v[68:71]
    ds_read_b64_tr_b16 v[132:133], v245 offset:24576
    v_mfma_f32_16x16x32_bf16 v[76:79], v[100:103], a[148:151], v[76:79]
    ds_read_b64_tr_b16 v[134:135], v245 offset:26624
    v_mfma_f32_16x16x32_bf16 v[72:75], v[100:103], a[144:147], v[72:75]
    ds_read_b64_tr_b16 v[136:137], v246 offset:24576
    buffer_load_dwordx4 a[236:239], v2, s[28:31], s18 offen offset:3072 sc1
    v_mfma_f32_16x16x32_bf16 v[80:83], v[104:107], a[144:147], v[80:83]
    ds_read_b64_tr_b16 v[138:139], v246 offset:26624
    v_mfma_f32_16x16x32_bf16 v[84:87], v[104:107], a[148:151], v[84:87]
    ds_read_b64_tr_b16 v[140:141], v247 offset:24576
    s_add_u32 s19, s19, s58
    v_mfma_f32_16x16x32_bf16 v[92:95], v[108:111], a[148:151], v[92:95]
    ds_read_b64_tr_b16 v[142:143], v247 offset:26624
    v_mfma_f32_16x16x32_bf16 v[88:91], v[108:111], a[144:147], v[88:91]
    s_waitcnt lgkmcnt(8)
    buffer_load_dwordx4 a[240:243], v2, s[28:31], s19 offen offset:0 sc1
    v_mfma_f32_16x16x32_bf16 v[64:67], v[112:115], a[152:155], v[64:67]
    ds_read_b64_tr_b16 v[144:145], v244 offset:28672
    v_mfma_f32_16x16x32_bf16 v[68:71], v[112:115], a[156:159], v[68:71]
    ds_read_b64_tr_b16 v[146:147], v244 offset:30720
    v_mfma_f32_16x16x32_bf16 v[76:79], v[116:119], a[156:159], v[76:79]
    ds_read_b64_tr_b16 v[148:149], v245 offset:28672
    v_mfma_f32_16x16x32_bf16 v[72:75], v[116:119], a[152:155], v[72:75]
    ds_read_b64_tr_b16 v[150:151], v245 offset:30720
    v_mfma_f32_16x16x32_bf16 v[80:83], v[120:123], a[152:155], v[80:83]
    ds_read_b64_tr_b16 v[152:153], v246 offset:28672
    buffer_load_dwordx4 a[244:247], v2, s[28:31], s19 offen offset:1024 sc1
    v_mfma_f32_16x16x32_bf16 v[84:87], v[120:123], a[156:159], v[84:87]
    ds_read_b64_tr_b16 v[154:155], v246 offset:30720
    v_mfma_f32_16x16x32_bf16 v[92:95], v[124:127], a[156:159], v[92:95]
    ds_read_b64_tr_b16 v[156:157], v247 offset:28672
    buffer_load_dwordx4 a[248:251], v2, s[28:31], s19 offen offset:2048 sc1
    v_mfma_f32_16x16x32_bf16 v[88:91], v[124:127], a[152:155], v[88:91]
    ds_read_b64_tr_b16 v[158:159], v247 offset:30720
    s_waitcnt vmcnt(41) lgkmcnt(8)
    v_mfma_f32_16x16x32_bf16 v[32:35], v[128:131], a[144:147], v[32:35]
    ds_read_b64_tr_b16 v[96:97], v240 offset:0
    ds_read_b64_tr_b16 v[98:99], v240 offset:2048
    v_mfma_f32_16x16x32_bf16 v[36:39], v[128:131], a[148:151], v[36:39]
    ds_read_b64_tr_b16 v[100:101], v241 offset:0
    v_mfma_f32_16x16x32_bf16 v[44:47], v[132:135], a[148:151], v[44:47]
    ds_read_b64_tr_b16 v[102:103], v241 offset:2048
    v_mfma_f32_16x16x32_bf16 v[40:43], v[132:135], a[144:147], v[40:43]
    ds_read_b64_tr_b16 v[104:105], v242 offset:0
    buffer_load_dwordx4 a[252:255], v2, s[28:31], s19 offen offset:3072 sc1
    v_mfma_f32_16x16x32_bf16 v[48:51], v[136:139], a[144:147], v[48:51]
    ds_read_b64_tr_b16 v[106:107], v242 offset:2048
    v_mfma_f32_16x16x32_bf16 v[52:55], v[136:139], a[148:151], v[52:55]
    ds_read_b64_tr_b16 v[108:109], v243 offset:0
    s_add_u32 s20, s20, s36
    v_mfma_f32_16x16x32_bf16 v[60:63], v[140:143], a[148:151], v[60:63]
    ds_read_b64_tr_b16 v[110:111], v243 offset:2048
    v_mfma_f32_16x16x32_bf16 v[56:59], v[140:143], a[144:147], v[56:59]
    s_waitcnt lgkmcnt(8)
    buffer_load_dwordx4 a[0:3], v2, s[28:31], s20 offen offset:0 sc1
    v_mfma_f32_16x16x32_bf16 v[32:35], v[144:147], a[152:155], v[32:35]
    ds_read_b64_tr_b16 v[112:113], v240 offset:4096
    v_mfma_f32_16x16x32_bf16 v[36:39], v[144:147], a[156:159], v[36:39]
    ds_read_b64_tr_b16 v[114:115], v240 offset:6144
    v_mfma_f32_16x16x32_bf16 v[44:47], v[148:151], a[156:159], v[44:47]
    ds_read_b64_tr_b16 v[116:117], v241 offset:4096
    buffer_load_dwordx4 a[4:7], v2, s[28:31], s20 offen offset:1024 sc1
    v_mfma_f32_16x16x32_bf16 v[40:43], v[148:151], a[152:155], v[40:43]
    ds_read_b64_tr_b16 v[118:119], v241 offset:6144
    v_mfma_f32_16x16x32_bf16 v[48:51], v[152:155], a[152:155], v[48:51]
    ds_read_b64_tr_b16 v[120:121], v242 offset:4096
    buffer_load_dwordx4 a[8:11], v2, s[28:31], s20 offen offset:2048 sc1
    v_mfma_f32_16x16x32_bf16 v[52:55], v[152:155], a[156:159], v[52:55]
    ds_read_b64_tr_b16 v[122:123], v242 offset:6144
    v_mfma_f32_16x16x32_bf16 v[60:63], v[156:159], a[156:159], v[60:63]
    ds_read_b64_tr_b16 v[124:125], v243 offset:4096
    buffer_load_dwordx4 a[12:15], v2, s[28:31], s20 offen offset:3072 sc1
    v_mfma_f32_16x16x32_bf16 v[56:59], v[156:159], a[152:155], v[56:59]
    ds_read_b64_tr_b16 v[126:127], v243 offset:6144
    s_waitcnt vmcnt(40) lgkmcnt(8)
    s_barrier
    v_mfma_f32_16x16x32_bf16 v[64:67], v[96:99], a[160:163], v[64:67]
    ds_read_b64_tr_b16 v[128:129], v240 offset:8192
    ds_read_b64_tr_b16 v[130:131], v240 offset:10240
    v_mfma_f32_16x16x32_bf16 v[68:71], v[96:99], a[164:167], v[68:71]
    ds_read_b64_tr_b16 v[132:133], v241 offset:8192
    s_add_u32 s9, s9, s62
    v_mfma_f32_16x16x32_bf16 v[76:79], v[100:103], a[164:167], v[76:79]
    ds_read_b64_tr_b16 v[134:135], v241 offset:10240
    v_mfma_f32_16x16x32_bf16 v[72:75], v[100:103], a[160:163], v[72:75]
    ds_read_b64_tr_b16 v[136:137], v242 offset:8192
    s_add_u32 m0, s63, 147456
    v_mfma_f32_16x16x32_bf16 v[80:83], v[104:107], a[160:163], v[80:83]
    ds_read_b64_tr_b16 v[138:139], v242 offset:10240
    v_mfma_f32_16x16x32_bf16 v[84:87], v[104:107], a[164:167], v[84:87]
    ds_read_b64_tr_b16 v[140:141], v243 offset:8192
    buffer_load_dwordx4 v14, s[52:55], s9 offen lds
    v_mfma_f32_16x16x32_bf16 v[92:95], v[108:111], a[164:167], v[92:95]
    ds_read_b64_tr_b16 v[142:143], v243 offset:10240
    v_mfma_f32_16x16x32_bf16 v[88:91], v[108:111], a[160:163], v[88:91]
    s_waitcnt lgkmcnt(8)
    buffer_load_dwordx4 v0, s[52:55], s9 offen offset:1024 lds
    v_mfma_f32_16x16x32_bf16 v[64:67], v[112:115], a[168:171], v[64:67]
    ds_read_b64_tr_b16 v[144:145], v240 offset:12288
    v_mfma_f32_16x16x32_bf16 v[68:71], v[112:115], a[172:175], v[68:71]
    ds_read_b64_tr_b16 v[146:147], v240 offset:14336
    v_mfma_f32_16x16x32_bf16 v[76:79], v[116:119], a[172:175], v[76:79]
    ds_read_b64_tr_b16 v[148:149], v241 offset:12288
    s_add_u32 m0, s63, 155648
    v_mfma_f32_16x16x32_bf16 v[72:75], v[116:119], a[168:171], v[72:75]
    ds_read_b64_tr_b16 v[150:151], v241 offset:14336
    v_mfma_f32_16x16x32_bf16 v[80:83], v[120:123], a[168:171], v[80:83]
    ds_read_b64_tr_b16 v[152:153], v242 offset:12288
    buffer_load_dwordx4 v12, s[52:55], s9 offen lds
    v_mfma_f32_16x16x32_bf16 v[84:87], v[120:123], a[172:175], v[84:87]
    ds_read_b64_tr_b16 v[154:155], v242 offset:14336
    v_mfma_f32_16x16x32_bf16 v[92:95], v[124:127], a[172:175], v[92:95]
    ds_read_b64_tr_b16 v[156:157], v243 offset:12288
    buffer_load_dwordx4 v13, s[52:55], s9 offen offset:1024 lds
    v_mfma_f32_16x16x32_bf16 v[88:91], v[124:127], a[168:171], v[88:91]
    ds_read_b64_tr_b16 v[158:159], v243 offset:14336
    s_waitcnt vmcnt(44) lgkmcnt(8)
    v_mfma_f32_16x16x32_bf16 v[32:35], v[128:131], a[160:163], v[32:35]
    ds_read_b64_tr_b16 v[96:97], v240 offset:16384
    ds_read_b64_tr_b16 v[98:99], v240 offset:18432
    v_mfma_f32_16x16x32_bf16 v[36:39], v[128:131], a[164:167], v[36:39]
    ds_read_b64_tr_b16 v[100:101], v241 offset:16384
    s_add_u32 s21, s21, s58
    v_mfma_f32_16x16x32_bf16 v[44:47], v[132:135], a[164:167], v[44:47]
    ds_read_b64_tr_b16 v[102:103], v241 offset:18432
    v_mfma_f32_16x16x32_bf16 v[40:43], v[132:135], a[160:163], v[40:43]
    ds_read_b64_tr_b16 v[104:105], v242 offset:16384
    buffer_load_dwordx4 a[16:19], v2, s[28:31], s21 offen offset:0 sc1
    v_mfma_f32_16x16x32_bf16 v[48:51], v[136:139], a[160:163], v[48:51]
    ds_read_b64_tr_b16 v[106:107], v242 offset:18432
    v_mfma_f32_16x16x32_bf16 v[52:55], v[136:139], a[164:167], v[52:55]
    ds_read_b64_tr_b16 v[108:109], v243 offset:16384
    buffer_load_dwordx4 a[20:23], v2, s[28:31], s21 offen offset:1024 sc1
    v_mfma_f32_16x16x32_bf16 v[60:63], v[140:143], a[164:167], v[60:63]
    ds_read_b64_tr_b16 v[110:111], v243 offset:18432
    v_mfma_f32_16x16x32_bf16 v[56:59], v[140:143], a[160:163], v[56:59]
    s_waitcnt lgkmcnt(8)
    buffer_load_dwordx4 a[24:27], v2, s[28:31], s21 offen offset:2048 sc1
    v_mfma_f32_16x16x32_bf16 v[32:35], v[144:147], a[168:171], v[32:35]
    ds_read_b64_tr_b16 v[112:113], v240 offset:20480
    buffer_load_dwordx4 a[28:31], v2, s[28:31], s21 offen offset:3072 sc1
    v_mfma_f32_16x16x32_bf16 v[36:39], v[144:147], a[172:175], v[36:39]
    ds_read_b64_tr_b16 v[114:115], v240 offset:22528
    v_mfma_f32_16x16x32_bf16 v[44:47], v[148:151], a[172:175], v[44:47]
    ds_read_b64_tr_b16 v[116:117], v241 offset:20480
    s_add_u32 s10, s10, s59
    v_mfma_f32_16x16x32_bf16 v[40:43], v[148:151], a[168:171], v[40:43]
    ds_read_b64_tr_b16 v[118:119], v241 offset:22528
    v_mfma_f32_16x16x32_bf16 v[48:51], v[152:155], a[168:171], v[48:51]
    ds_read_b64_tr_b16 v[120:121], v242 offset:20480
    s_add_u32 m0, s63, 65536
    v_mfma_f32_16x16x32_bf16 v[52:55], v[152:155], a[172:175], v[52:55]
    ds_read_b64_tr_b16 v[122:123], v242 offset:22528
    v_mfma_f32_16x16x32_bf16 v[60:63], v[156:159], a[172:175], v[60:63]
    ds_read_b64_tr_b16 v[124:125], v243 offset:20480
    buffer_load_dwordx4 v14, s[52:55], s10 offen lds
    v_mfma_f32_16x16x32_bf16 v[56:59], v[156:159], a[168:171], v[56:59]
    ds_read_b64_tr_b16 v[126:127], v243 offset:22528
    s_waitcnt vmcnt(43) lgkmcnt(8)
    s_barrier
    v_mfma_f32_16x16x32_bf16 v[64:67], v[96:99], a[176:179], v[64:67]
    ds_read_b64_tr_b16 v[128:129], v240 offset:24576
    ds_read_b64_tr_b16 v[130:131], v240 offset:26624
    v_mfma_f32_16x16x32_bf16 v[68:71], v[96:99], a[180:183], v[68:71]
    ds_read_b64_tr_b16 v[132:133], v241 offset:24576
    buffer_load_dwordx4 v0, s[52:55], s10 offen offset:1024 lds
    v_mfma_f32_16x16x32_bf16 v[76:79], v[100:103], a[180:183], v[76:79]
    ds_read_b64_tr_b16 v[134:135], v241 offset:26624
    v_mfma_f32_16x16x32_bf16 v[72:75], v[100:103], a[176:179], v[72:75]
    ds_read_b64_tr_b16 v[136:137], v242 offset:24576
    s_add_u32 s11, s11, s62
    v_mfma_f32_16x16x32_bf16 v[80:83], v[104:107], a[176:179], v[80:83]
    ds_read_b64_tr_b16 v[138:139], v242 offset:26624
    v_mfma_f32_16x16x32_bf16 v[84:87], v[104:107], a[180:183], v[84:87]
    ds_read_b64_tr_b16 v[140:141], v243 offset:24576
    s_add_u32 m0, s63, 73728
    v_mfma_f32_16x16x32_bf16 v[92:95], v[108:111], a[180:183], v[92:95]
    ds_read_b64_tr_b16 v[142:143], v243 offset:26624
    v_mfma_f32_16x16x32_bf16 v[88:91], v[108:111], a[176:179], v[88:91]
    s_waitcnt lgkmcnt(8)
    buffer_load_dwordx4 v14, s[52:55], s11 offen lds
    v_mfma_f32_16x16x32_bf16 v[64:67], v[112:115], a[184:187], v[64:67]
    ds_read_b64_tr_b16 v[144:145], v240 offset:28672
    buffer_load_dwordx4 v0, s[52:55], s11 offen offset:1024 lds
    v_mfma_f32_16x16x32_bf16 v[68:71], v[112:115], a[188:191], v[68:71]
    ds_read_b64_tr_b16 v[146:147], v240 offset:30720
    v_mfma_f32_16x16x32_bf16 v[76:79], v[116:119], a[188:191], v[76:79]
    ds_read_b64_tr_b16 v[148:149], v241 offset:28672
    s_add_u32 s22, s22, s36
    v_mfma_f32_16x16x32_bf16 v[72:75], v[116:119], a[184:187], v[72:75]
    ds_read_b64_tr_b16 v[150:151], v241 offset:30720
    v_mfma_f32_16x16x32_bf16 v[80:83], v[120:123], a[184:187], v[80:83]
    ds_read_b64_tr_b16 v[152:153], v242 offset:28672
    buffer_load_dwordx4 a[32:35], v2, s[28:31], s22 offen offset:0 sc1
    v_mfma_f32_16x16x32_bf16 v[84:87], v[120:123], a[188:191], v[84:87]
    ds_read_b64_tr_b16 v[154:155], v242 offset:30720
    v_mfma_f32_16x16x32_bf16 v[92:95], v[124:127], a[188:191], v[92:95]
    ds_read_b64_tr_b16 v[156:157], v243 offset:28672
    buffer_load_dwordx4 a[36:39], v2, s[28:31], s22 offen offset:1024 sc1
    v_mfma_f32_16x16x32_bf16 v[88:91], v[124:127], a[184:187], v[88:91]
    ds_read_b64_tr_b16 v[158:159], v243 offset:30720
    s_waitcnt vmcnt(48) lgkmcnt(8)
    v_mfma_f32_16x16x32_bf16 v[32:35], v[128:131], a[176:179], v[32:35]
    ds_read_b64_tr_b16 v[96:97], v240 offset:32768
    ds_read_b64_tr_b16 v[98:99], v240 offset:34816
    v_mfma_f32_16x16x32_bf16 v[36:39], v[128:131], a[180:183], v[36:39]
    ds_read_b64_tr_b16 v[100:101], v241 offset:32768
    v_mfma_f32_16x16x32_bf16 v[44:47], v[132:135], a[180:183], v[44:47]
    ds_read_b64_tr_b16 v[102:103], v241 offset:34816
    v_mfma_f32_16x16x32_bf16 v[40:43], v[132:135], a[176:179], v[40:43]
    ds_read_b64_tr_b16 v[104:105], v242 offset:32768
    buffer_load_dwordx4 a[40:43], v2, s[28:31], s22 offen offset:2048 sc1
    v_mfma_f32_16x16x32_bf16 v[48:51], v[136:139], a[176:179], v[48:51]
    ds_read_b64_tr_b16 v[106:107], v242 offset:34816
    v_mfma_f32_16x16x32_bf16 v[52:55], v[136:139], a[180:183], v[52:55]
    ds_read_b64_tr_b16 v[108:109], v243 offset:32768
    buffer_load_dwordx4 a[44:47], v2, s[28:31], s22 offen offset:3072 sc1
    v_mfma_f32_16x16x32_bf16 v[60:63], v[140:143], a[180:183], v[60:63]
    ds_read_b64_tr_b16 v[110:111], v243 offset:34816
    v_mfma_f32_16x16x32_bf16 v[56:59], v[140:143], a[176:179], v[56:59]
    s_waitcnt lgkmcnt(8)
    s_add_u32 m0, s63, 81920
    v_mfma_f32_16x16x32_bf16 v[32:35], v[144:147], a[184:187], v[32:35]
    ds_read_b64_tr_b16 v[112:113], v240 offset:36864
    v_mfma_f32_16x16x32_bf16 v[36:39], v[144:147], a[188:191], v[36:39]
    ds_read_b64_tr_b16 v[114:115], v240 offset:38912
    v_mfma_f32_16x16x32_bf16 v[44:47], v[148:151], a[188:191], v[44:47]
    ds_read_b64_tr_b16 v[116:117], v241 offset:36864
    buffer_load_dwordx4 v14, s[52:55], s60 offen lds
    v_mfma_f32_16x16x32_bf16 v[40:43], v[148:151], a[184:187], v[40:43]
    ds_read_b64_tr_b16 v[118:119], v241 offset:38912
    v_mfma_f32_16x16x32_bf16 v[48:51], v[152:155], a[184:187], v[48:51]
    ds_read_b64_tr_b16 v[120:121], v242 offset:36864
    buffer_load_dwordx4 v0, s[52:55], s60 offen offset:1024 lds
    v_mfma_f32_16x16x32_bf16 v[52:55], v[152:155], a[188:191], v[52:55]
    ds_read_b64_tr_b16 v[122:123], v242 offset:38912
    v_mfma_f32_16x16x32_bf16 v[60:63], v[156:159], a[188:191], v[60:63]
    ds_read_b64_tr_b16 v[124:125], v243 offset:36864
    buffer_load_dword v5, v6, s[28:31], s83 offen sc1
    v_mfma_f32_16x16x32_bf16 v[56:59], v[156:159], a[184:187], v[56:59]
    ds_read_b64_tr_b16 v[126:127], v243 offset:38912
    s_waitcnt vmcnt(36) lgkmcnt(8)
    s_barrier
    v_mfma_f32_16x16x32_bf16 v[64:67], v[96:99], a[192:195], v[64:67]
    ds_read_b64_tr_b16 v[128:129], v240 offset:40960
    ds_read_b64_tr_b16 v[130:131], v240 offset:43008
    v_mfma_f32_16x16x32_bf16 v[68:71], v[96:99], a[196:199], v[68:71]
    ds_read_b64_tr_b16 v[132:133], v241 offset:40960
    s_add_u32 s23, s23, s58
    v_mfma_f32_16x16x32_bf16 v[76:79], v[100:103], a[196:199], v[76:79]
    ds_read_b64_tr_b16 v[134:135], v241 offset:43008
    v_mfma_f32_16x16x32_bf16 v[72:75], v[100:103], a[192:195], v[72:75]
    ds_read_b64_tr_b16 v[136:137], v242 offset:40960
    buffer_load_dwordx4 a[48:51], v2, s[28:31], s23 offen offset:0 sc1
    v_mfma_f32_16x16x32_bf16 v[80:83], v[104:107], a[192:195], v[80:83]
    ds_read_b64_tr_b16 v[138:139], v242 offset:43008
    v_mfma_f32_16x16x32_bf16 v[84:87], v[104:107], a[196:199], v[84:87]
    ds_read_b64_tr_b16 v[140:141], v243 offset:40960
    buffer_load_dwordx4 a[52:55], v2, s[28:31], s23 offen offset:1024 sc1
    v_mfma_f32_16x16x32_bf16 v[92:95], v[108:111], a[196:199], v[92:95]
    ds_read_b64_tr_b16 v[142:143], v243 offset:43008
    v_mfma_f32_16x16x32_bf16 v[88:91], v[108:111], a[192:195], v[88:91]
    s_waitcnt lgkmcnt(8)
    buffer_load_dwordx4 a[56:59], v2, s[28:31], s23 offen offset:2048 sc1
    v_mfma_f32_16x16x32_bf16 v[64:67], v[112:115], a[200:203], v[64:67]
    ds_read_b64_tr_b16 v[144:145], v240 offset:45056
    v_mfma_f32_16x16x32_bf16 v[68:71], v[112:115], a[204:207], v[68:71]
    ds_read_b64_tr_b16 v[146:147], v240 offset:47104
    v_mfma_f32_16x16x32_bf16 v[76:79], v[116:119], a[204:207], v[76:79]
    ds_read_b64_tr_b16 v[148:149], v241 offset:45056
    buffer_load_dwordx4 a[60:63], v2, s[28:31], s23 offen offset:3072 sc1
    v_mfma_f32_16x16x32_bf16 v[72:75], v[116:119], a[200:203], v[72:75]
    ds_read_b64_tr_b16 v[150:151], v241 offset:47104
    v_mfma_f32_16x16x32_bf16 v[80:83], v[120:123], a[200:203], v[80:83]
    ds_read_b64_tr_b16 v[152:153], v242 offset:45056
    s_add_u32 m0, s63, 90112
    v_mfma_f32_16x16x32_bf16 v[84:87], v[120:123], a[204:207], v[84:87]
    ds_read_b64_tr_b16 v[154:155], v242 offset:47104
    v_mfma_f32_16x16x32_bf16 v[92:95], v[124:127], a[204:207], v[92:95]
    ds_read_b64_tr_b16 v[156:157], v243 offset:45056
    buffer_load_dwordx4 v14, s[52:55], s61 offen lds
    v_mfma_f32_16x16x32_bf16 v[88:91], v[124:127], a[200:203], v[88:91]
    ds_read_b64_tr_b16 v[158:159], v243 offset:47104
    s_waitcnt vmcnt(41) lgkmcnt(8)
    v_mfma_f32_16x16x32_bf16 v[32:35], v[128:131], a[192:195], v[32:35]
    ds_read_b64_tr_b16 v[96:97], v240 offset:49152
    ds_read_b64_tr_b16 v[98:99], v240 offset:51200
    v_mfma_f32_16x16x32_bf16 v[36:39], v[128:131], a[196:199], v[36:39]
    ds_read_b64_tr_b16 v[100:101], v241 offset:49152
    v_mfma_f32_16x16x32_bf16 v[44:47], v[132:135], a[196:199], v[44:47]
    ds_read_b64_tr_b16 v[102:103], v241 offset:51200
    v_mfma_f32_16x16x32_bf16 v[40:43], v[132:135], a[192:195], v[40:43]
    ds_read_b64_tr_b16 v[104:105], v242 offset:49152
    buffer_load_dwordx4 v0, s[52:55], s61 offen offset:1024 lds
    v_mfma_f32_16x16x32_bf16 v[48:51], v[136:139], a[192:195], v[48:51]
    ds_read_b64_tr_b16 v[106:107], v242 offset:51200
    v_mfma_f32_16x16x32_bf16 v[52:55], v[136:139], a[196:199], v[52:55]
    ds_read_b64_tr_b16 v[108:109], v243 offset:49152
    s_add_u32 m0, s63, 0
    v_mfma_f32_16x16x32_bf16 v[60:63], v[140:143], a[196:199], v[60:63]
    ds_read_b64_tr_b16 v[110:111], v243 offset:51200
    v_mfma_f32_16x16x32_bf16 v[56:59], v[140:143], a[192:195], v[56:59]
    s_waitcnt lgkmcnt(8)
    buffer_load_dwordx4 v14, s[52:55], s38 offen lds
    v_mfma_f32_16x16x32_bf16 v[32:35], v[144:147], a[200:203], v[32:35]
    ds_read_b64_tr_b16 v[112:113], v240 offset:53248
    v_mfma_f32_16x16x32_bf16 v[36:39], v[144:147], a[204:207], v[36:39]
    ds_read_b64_tr_b16 v[114:115], v240 offset:55296
    v_mfma_f32_16x16x32_bf16 v[44:47], v[148:151], a[204:207], v[44:47]
    ds_read_b64_tr_b16 v[116:117], v241 offset:53248
    buffer_load_dwordx4 v0, s[52:55], s38 offen offset:1024 lds
    v_mfma_f32_16x16x32_bf16 v[40:43], v[148:151], a[200:203], v[40:43]
    ds_read_b64_tr_b16 v[118:119], v241 offset:55296
    v_mfma_f32_16x16x32_bf16 v[48:51], v[152:155], a[200:203], v[48:51]
    ds_read_b64_tr_b16 v[120:121], v242 offset:53248
    s_add_u32 m0, s63, 8192
    v_mfma_f32_16x16x32_bf16 v[52:55], v[152:155], a[204:207], v[52:55]
    ds_read_b64_tr_b16 v[122:123], v242 offset:55296
    v_mfma_f32_16x16x32_bf16 v[60:63], v[156:159], a[204:207], v[60:63]
    ds_read_b64_tr_b16 v[124:125], v243 offset:53248
    buffer_load_dwordx4 v14, s[52:55], s39 offen lds
    v_mfma_f32_16x16x32_bf16 v[56:59], v[156:159], a[200:203], v[56:59]
    ds_read_b64_tr_b16 v[126:127], v243 offset:55296
    s_waitcnt vmcnt(9) lgkmcnt(8)
    v_cmp_gt_u32 vcc, 2, v5
    s_cbranch_vccz k_c_ok18
    s_mov_b32 s3, 0x20000
k_cpoll18:
    s_sub_u32 s3, s3, 1
    s_cbranch_scc1 k_c_ok18
    buffer_load_dword v5, v6, s[28:31], s83 offen sc1
    s_waitcnt vmcnt(0)
    v_cmp_gt_u32 vcc, 2, v5
    s_cbranch_vccnz k_cpoll18
k_c_ok18:
    s_barrier
    v_mfma_f32_16x16x32_bf16 v[64:67], v[96:99], a[208:211], v[64:67]
    ds_read_b64_tr_b16 v[128:129], v240 offset:57344
    ds_read_b64_tr_b16 v[130:131], v240 offset:59392
    v_mfma_f32_16x16x32_bf16 v[68:71], v[96:99], a[212:215], v[68:71]
    ds_read_b64_tr_b16 v[132:133], v241 offset:57344
    v_mfma_f32_16x16x32_bf16 v[76:79], v[100:103], a[212:215], v[76:79]
    ds_read_b64_tr_b16 v[134:135], v241 offset:59392
    v_mfma_f32_16x16x32_bf16 v[72:75], v[100:103], a[208:211], v[72:75]
    ds_read_b64_tr_b16 v[136:137], v242 offset:57344
    buffer_load_dwordx4 a[64:67], v2, s[28:31], s24 offen offset:0 sc1
    v_mfma_f32_16x16x32_bf16 v[80:83], v[104:107], a[208:211], v[80:83]
    ds_read_b64_tr_b16 v[138:139], v242 offset:59392
    v_mfma_f32_16x16x32_bf16 v[84:87], v[104:107], a[212:215], v[84:87]
    ds_read_b64_tr_b16 v[140:141], v243 offset:57344
    buffer_load_dwordx4 a[68:71], v2, s[28:31], s24 offen offset:1024 sc1
    v_mfma_f32_16x16x32_bf16 v[92:95], v[108:111], a[212:215], v[92:95]
    ds_read_b64_tr_b16 v[142:143], v243 offset:59392
    v_mfma_f32_16x16x32_bf16 v[88:91], v[108:111], a[208:211], v[88:91]
    s_waitcnt lgkmcnt(8)
    buffer_load_dwordx4 a[72:75], v2, s[28:31], s24 offen offset:2048 sc1
    v_mfma_f32_16x16x32_bf16 v[64:67], v[112:115], a[216:219], v[64:67]
    ds_read_b64_tr_b16 v[144:145], v240 offset:61440
    v_mfma_f32_16x16x32_bf16 v[68:71], v[112:115], a[220:223], v[68:71]
    ds_read_b64_tr_b16 v[146:147], v240 offset:63488
    v_mfma_f32_16x16x32_bf16 v[76:79], v[116:119], a[220:223], v[76:79]
    ds_read_b64_tr_b16 v[148:149], v241 offset:61440
    v_mfma_f32_16x16x32_bf16 v[72:75], v[116:119], a[216:219], v[72:75]
    ds_read_b64_tr_b16 v[150:151], v241 offset:63488
    v_mfma_f32_16x16x32_bf16 v[80:83], v[120:123], a[216:219], v[80:83]
    ds_read_b64_tr_b16 v[152:153], v242 offset:61440
    buffer_load_dwordx4 a[76:79], v2, s[28:31], s24 offen offset:3072 sc1
    v_mfma_f32_16x16x32_bf16 v[84:87], v[120:123], a[220:223], v[84:87]
    ds_read_b64_tr_b16 v[154:155], v242 offset:63488
    v_mfma_f32_16x16x32_bf16 v[92:95], v[124:127], a[220:223], v[92:95]
    ds_read_b64_tr_b16 v[156:157], v243 offset:61440
    buffer_load_dwordx4 a[80:83], v2, s[28:31], s25 offen offset:0 sc1
    v_mfma_f32_16x16x32_bf16 v[88:91], v[124:127], a[216:219], v[88:91]
    ds_read_b64_tr_b16 v[158:159], v243 offset:63488
    s_waitcnt vmcnt(45) lgkmcnt(8)
    v_mfma_f32_16x16x32_bf16 v[32:35], v[128:131], a[208:211], v[32:35]
    ds_read_b64_tr_b16 v[96:97], v244 offset:32768
    ds_read_b64_tr_b16 v[98:99], v244 offset:34816
    v_mfma_f32_16x16x32_bf16 v[36:39], v[128:131], a[212:215], v[36:39]
    ds_read_b64_tr_b16 v[100:101], v245 offset:32768
    v_mfma_f32_16x16x32_bf16 v[44:47], v[132:135], a[212:215], v[44:47]
    ds_read_b64_tr_b16 v[102:103], v245 offset:34816
    v_mfma_f32_16x16x32_bf16 v[40:43], v[132:135], a[208:211], v[40:43]
    ds_read_b64_tr_b16 v[104:105], v246 offset:32768
    buffer_load_dwordx4 a[84:87], v2, s[28:31], s25 offen offset:1024 sc1
    v_mfma_f32_16x16x32_bf16 v[48:51], v[136:139], a[208:211], v[48:51]
    ds_read_b64_tr_b16 v[106:107], v246 offset:34816
    v_mfma_f32_16x16x32_bf16 v[52:55], v[136:139], a[212:215], v[52:55]
    ds_read_b64_tr_b16 v[108:109], v247 offset:32768
    buffer_load_dwordx4 a[88:91], v2, s[28:31], s25 offen offset:2048 sc1
    v_mfma_f32_16x16x32_bf16 v[60:63], v[140:143], a[212:215], v[60:63]
    ds_read_b64_tr_b16 v[110:111], v247 offset:34816
    v_mfma_f32_16x16x32_bf16 v[56:59], v[140:143], a[208:211], v[56:59]
    s_waitcnt lgkmcnt(8)
    buffer_load_dwordx4 a[92:95], v2, s[28:31], s25 offen offset:3072 sc1
    v_mfma_f32_16x16x32_bf16 v[32:35], v[144:147], a[216:219], v[32:35]
    ds_read_b64_tr_b16 v[112:113], v244 offset:36864
    v_mfma_f32_16x16x32_bf16 v[36:39], v[144:147], a[220:223], v[36:39]
    ds_read_b64_tr_b16 v[114:115], v244 offset:38912
    v_mfma_f32_16x16x32_bf16 v[44:47], v[148:151], a[220:223], v[44:47]
    ds_read_b64_tr_b16 v[116:117], v245 offset:36864
    v_mfma_f32_16x16x32_bf16 v[40:43], v[148:151], a[216:219], v[40:43]
    ds_read_b64_tr_b16 v[118:119], v245 offset:38912
    v_mfma_f32_16x16x32_bf16 v[48:51], v[152:155], a[216:219], v[48:51]
    ds_read_b64_tr_b16 v[120:121], v246 offset:36864
    buffer_load_dwordx4 v0, s[52:55], s39 offen offset:1024 lds
    v_mfma_f32_16x16x32_bf16 v[52:55], v[152:155], a[220:223], v[52:55]
    ds_read_b64_tr_b16 v[122:123], v246 offset:38912
    v_mfma_f32_16x16x32_bf16 v[60:63], v[156:159], a[220:223], v[60:63]
    ds_read_b64_tr_b16 v[124:125], v247 offset:36864
    buffer_load_dwordx4 a[96:99], v2, s[28:31], s26 offen offset:0 sc1
    v_mfma_f32_16x16x32_bf16 v[56:59], v[156:159], a[216:219], v[56:59]
    ds_read_b64_tr_b16 v[126:127], v247 offset:38912
    s_waitcnt vmcnt(46) lgkmcnt(8)
    s_barrier
    v_mfma_f32_16x16x32_bf16 v[64:67], v[96:99], a[224:227], v[64:67]
    ds_read_b64_tr_b16 v[128:129], v244 offset:40960
    ds_read_b64_tr_b16 v[130:131], v244 offset:43008
    v_mfma_f32_16x16x32_bf16 v[68:71], v[96:99], a[228:231], v[68:71]
    ds_read_b64_tr_b16 v[132:133], v245 offset:40960
    v_mfma_f32_16x16x32_bf16 v[76:79], v[100:103], a[228:231], v[76:79]
    ds_read_b64_tr_b16 v[134:135], v245 offset:43008
    v_mfma_f32_16x16x32_bf16 v[72:75], v[100:103], a[224:227], v[72:75]
    ds_read_b64_tr_b16 v[136:137], v246 offset:40960
    buffer_load_dwordx4 a[100:103], v2, s[28:31], s26 offen offset:1024 sc1
    v_mfma_f32_16x16x32_bf16 v[80:83], v[104:107], a[224:227], v[80:83]
    ds_read_b64_tr_b16 v[138:139], v246 offset:43008
    v_mfma_f32_16x16x32_bf16 v[84:87], v[104:107], a[228:231], v[84:87]
    ds_read_b64_tr_b16 v[140:141], v247 offset:40960
    buffer_load_dwordx4 a[104:107], v2, s[28:31], s26 offen offset:2048 sc1
    v_mfma_f32_16x16x32_bf16 v[92:95], v[108:111], a[228:231], v[92:95]
    ds_read_b64_tr_b16 v[142:143], v247 offset:43008
    v_mfma_f32_16x16x32_bf16 v[88:91], v[108:111], a[224:227], v[88:91]
    s_waitcnt lgkmcnt(8)
    buffer_load_dwordx4 a[108:111], v2, s[28:31], s26 offen offset:3072 sc1
    v_mfma_f32_16x16x32_bf16 v[64:67], v[112:115], a[232:235], v[64:67]
    ds_read_b64_tr_b16 v[144:145], v244 offset:45056
    v_mfma_f32_16x16x32_bf16 v[68:71], v[112:115], a[236:239], v[68:71]
    ds_read_b64_tr_b16 v[146:147], v244 offset:47104
    v_mfma_f32_16x16x32_bf16 v[76:79], v[116:119], a[236:239], v[76:79]
    ds_read_b64_tr_b16 v[148:149], v245 offset:45056
    v_mfma_f32_16x16x32_bf16 v[72:75], v[116:119], a[232:235], v[72:75]
    ds_read_b64_tr_b16 v[150:151], v245 offset:47104
    v_mfma_f32_16x16x32_bf16 v[80:83], v[120:123], a[232:235], v[80:83]
    ds_read_b64_tr_b16 v[152:153], v246 offset:45056
    s_add_u32 m0, s63, 16384
    v_mfma_f32_16x16x32_bf16 v[84:87], v[120:123], a[236:239], v[84:87]
    ds_read_b64_tr_b16 v[154:155], v246 offset:47104
    v_mfma_f32_16x16x32_bf16 v[92:95], v[124:127], a[236:239], v[92:95]
    ds_read_b64_tr_b16 v[156:157], v247 offset:45056
    buffer_load_dwordx4 v14, s[52:55], s80 offen lds
    v_mfma_f32_16x16x32_bf16 v[88:91], v[124:127], a[232:235], v[88:91]
    ds_read_b64_tr_b16 v[158:159], v247 offset:47104
    s_waitcnt vmcnt(50) lgkmcnt(8)
    v_mfma_f32_16x16x32_bf16 v[32:35], v[128:131], a[224:227], v[32:35]
    ds_read_b64_tr_b16 v[96:97], v244 offset:49152
    ds_read_b64_tr_b16 v[98:99], v244 offset:51200
    v_mfma_f32_16x16x32_bf16 v[36:39], v[128:131], a[228:231], v[36:39]
    ds_read_b64_tr_b16 v[100:101], v245 offset:49152
    v_mfma_f32_16x16x32_bf16 v[44:47], v[132:135], a[228:231], v[44:47]
    ds_read_b64_tr_b16 v[102:103], v245 offset:51200
    v_mfma_f32_16x16x32_bf16 v[40:43], v[132:135], a[224:227], v[40:43]
    ds_read_b64_tr_b16 v[104:105], v246 offset:49152
    buffer_load_dwordx4 v0, s[52:55], s80 offen offset:1024 lds
    v_mfma_f32_16x16x32_bf16 v[48:51], v[136:139], a[224:227], v[48:51]
    ds_read_b64_tr_b16 v[106:107], v246 offset:51200
    v_mfma_f32_16x16x32_bf16 v[52:55], v[136:139], a[228:231], v[52:55]
    ds_read_b64_tr_b16 v[108:109], v247 offset:49152
    buffer_load_dwordx4 a[112:115], v2, s[28:31], s27 offen offset:0 sc1
    v_mfma_f32_16x16x32_bf16 v[60:63], v[140:143], a[228:231], v[60:63]
    ds_read_b64_tr_b16 v[110:111], v247 offset:51200
    v_mfma_f32_16x16x32_bf16 v[56:59], v[140:143], a[224:227], v[56:59]
    s_waitcnt lgkmcnt(8)
    buffer_load_dwordx4 a[116:119], v2, s[28:31], s27 offen offset:1024 sc1
    v_mfma_f32_16x16x32_bf16 v[32:35], v[144:147], a[232:235], v[32:35]
    ds_read_b64_tr_b16 v[112:113], v244 offset:53248
    v_mfma_f32_16x16x32_bf16 v[36:39], v[144:147], a[236:239], v[36:39]
    ds_read_b64_tr_b16 v[114:115], v244 offset:55296
    v_mfma_f32_16x16x32_bf16 v[44:47], v[148:151], a[236:239], v[44:47]
    ds_read_b64_tr_b16 v[116:117], v245 offset:53248
    v_mfma_f32_16x16x32_bf16 v[40:43], v[148:151], a[232:235], v[40:43]
    ds_read_b64_tr_b16 v[118:119], v245 offset:55296
    v_mfma_f32_16x16x32_bf16 v[48:51], v[152:155], a[232:235], v[48:51]
    ds_read_b64_tr_b16 v[120:121], v246 offset:53248
    buffer_load_dwordx4 a[120:123], v2, s[28:31], s27 offen offset:2048 sc1
    v_mfma_f32_16x16x32_bf16 v[52:55], v[152:155], a[236:239], v[52:55]
    ds_read_b64_tr_b16 v[122:123], v246 offset:55296
    v_mfma_f32_16x16x32_bf16 v[60:63], v[156:159], a[236:239], v[60:63]
    ds_read_b64_tr_b16 v[124:125], v247 offset:53248
    buffer_load_dwordx4 a[124:127], v2, s[28:31], s27 offen offset:3072 sc1
    v_mfma_f32_16x16x32_bf16 v[56:59], v[156:159], a[232:235], v[56:59]
    ds_read_b64_tr_b16 v[126:127], v247 offset:55296
    s_waitcnt vmcnt(51) lgkmcnt(8)
    s_barrier
    v_mfma_f32_16x16x32_bf16 v[64:67], v[96:99], a[240:243], v[64:67]
    ds_read_b64_tr_b16 v[128:129], v244 offset:57344
    ds_read_b64_tr_b16 v[130:131], v244 offset:59392
    v_mfma_f32_16x16x32_bf16 v[68:71], v[96:99], a[244:247], v[68:71]
    ds_read_b64_tr_b16 v[132:133], v245 offset:57344
    v_mfma_f32_16x16x32_bf16 v[76:79], v[100:103], a[244:247], v[76:79]
    ds_read_b64_tr_b16 v[134:135], v245 offset:59392
    v_mfma_f32_16x16x32_bf16 v[72:75], v[100:103], a[240:243], v[72:75]
    ds_read_b64_tr_b16 v[136:137], v246 offset:57344
    s_add_u32 m0, s63, 24576
    v_mfma_f32_16x16x32_bf16 v[80:83], v[104:107], a[240:243], v[80:83]
    ds_read_b64_tr_b16 v[138:139], v246 offset:59392
    v_mfma_f32_16x16x32_bf16 v[84:87], v[104:107], a[244:247], v[84:87]
    ds_read_b64_tr_b16 v[140:141], v247 offset:57344
    buffer_load_dwordx4 v14, s[52:55], s81 offen lds
    v_mfma_f32_16x16x32_bf16 v[92:95], v[108:111], a[244:247], v[92:95]
    ds_read_b64_tr_b16 v[142:143], v247 offset:59392
    v_mfma_f32_16x16x32_bf16 v[88:91], v[108:111], a[240:243], v[88:91]
    s_waitcnt lgkmcnt(8)
    buffer_load_dwordx4 v0, s[52:55], s81 offen offset:1024 lds
    v_mfma_f32_16x16x32_bf16 v[64:67], v[112:115], a[248:251], v[64:67]
    ds_read_b64_tr_b16 v[144:145], v244 offset:61440
    v_mfma_f32_16x16x32_bf16 v[68:71], v[112:115], a[252:255], v[68:71]
    ds_read_b64_tr_b16 v[146:147], v244 offset:63488
    v_mfma_f32_16x16x32_bf16 v[76:79], v[116:119], a[252:255], v[76:79]
    ds_read_b64_tr_b16 v[148:149], v245 offset:61440
    v_mfma_f32_16x16x32_bf16 v[72:75], v[116:119], a[248:251], v[72:75]
    ds_read_b64_tr_b16 v[150:151], v245 offset:63488
    v_mfma_f32_16x16x32_bf16 v[80:83], v[120:123], a[248:251], v[80:83]
    ds_read_b64_tr_b16 v[152:153], v246 offset:61440
    buffer_load_dwordx4 a[128:131], v2, s[28:31], s35 offen offset:0 sc1
    v_mfma_f32_16x16x32_bf16 v[84:87], v[120:123], a[252:255], v[84:87]
    ds_read_b64_tr_b16 v[154:155], v246 offset:63488
    v_mfma_f32_16x16x32_bf16 v[92:95], v[124:127], a[252:255], v[92:95]
    ds_read_b64_tr_b16 v[156:157], v247 offset:61440
    buffer_load_dwordx4 a[132:135], v2, s[28:31], s35 offen offset:1024 sc1
    v_mfma_f32_16x16x32_bf16 v[88:91], v[124:127], a[248:251], v[88:91]
    ds_read_b64_tr_b16 v[158:159], v247 offset:63488
    s_waitcnt vmcnt(55) lgkmcnt(8)
    v_mfma_f32_16x16x32_bf16 v[32:35], v[128:131], a[240:243], v[32:35]
    ds_read_b64_tr_b16 v[96:97], v248 offset:0
    ds_read_b64_tr_b16 v[98:99], v248 offset:2048
    v_mfma_f32_16x16x32_bf16 v[36:39], v[128:131], a[244:247], v[36:39]
    ds_read_b64_tr_b16 v[100:101], v249 offset:0
    buffer_load_dwordx4 a[136:139], v2, s[28:31], s35 offen offset:2048 sc1
    v_mfma_f32_16x16x32_bf16 v[44:47], v[132:135], a[244:247], v[44:47]
    ds_read_b64_tr_b16 v[102:103], v249 offset:2048
    v_mfma_f32_16x16x32_bf16 v[40:43], v[132:135], a[240:243], v[40:43]
    ds_read_b64_tr_b16 v[104:105], v250 offset:0
    buffer_load_dwordx4 a[140:143], v2, s[28:31], s35 offen offset:3072 sc1
    v_mfma_f32_16x16x32_bf16 v[48:51], v[136:139], a[240:243], v[48:51]
    ds_read_b64_tr_b16 v[106:107], v250 offset:2048
    v_mfma_f32_16x16x32_bf16 v[52:55], v[136:139], a[244:247], v[52:55]
    ds_read_b64_tr_b16 v[108:109], v251 offset:0
    v_add_u32 v14, 1835008, v14
    v_mfma_f32_16x16x32_bf16 v[60:63], v[140:143], a[244:247], v[60:63]
    ds_read_b64_tr_b16 v[110:111], v251 offset:2048
    v_mfma_f32_16x16x32_bf16 v[56:59], v[140:143], a[240:243], v[56:59]
    s_waitcnt lgkmcnt(8)
    v_add_u32 v0, 1835008, v0
    v_mfma_f32_16x16x32_bf16 v[32:35], v[144:147], a[248:251], v[32:35]
    ds_read_b64_tr_b16 v[112:113], v248 offset:4096
    s_add_u32 m0, s63, 32768
    v_mfma_f32_16x16x32_bf16 v[36:39], v[144:147], a[252:255], v[36:39]
    ds_read_b64_tr_b16 v[114:115], v248 offset:6144
    v_mfma_f32_16x16x32_bf16 v[44:47], v[148:151], a[252:255], v[44:47]
    ds_read_b64_tr_b16 v[116:117], v249 offset:4096
    buffer_load_dwordx4 v14, s[52:55], s60 offen lds
    v_mfma_f32_16x16x32_bf16 v[40:43], v[148:151], a[248:251], v[40:43]
    ds_read_b64_tr_b16 v[118:119], v249 offset:6144
    v_mfma_f32_16x16x32_bf16 v[48:51], v[152:155], a[248:251], v[48:51]
    ds_read_b64_tr_b16 v[120:121], v250 offset:4096
    buffer_load_dwordx4 v0, s[52:55], s60 offen offset:1024 lds
    v_mfma_f32_16x16x32_bf16 v[52:55], v[152:155], a[252:255], v[52:55]
    ds_read_b64_tr_b16 v[122:123], v250 offset:6144
    v_mfma_f32_16x16x32_bf16 v[60:63], v[156:159], a[252:255], v[60:63]
    ds_read_b64_tr_b16 v[124:125], v251 offset:4096
    buffer_load_dwordx4 a[144:147], v2, s[28:31], s33 offen offset:0 sc1
    v_mfma_f32_16x16x32_bf16 v[56:59], v[156:159], a[248:251], v[56:59]
    ds_read_b64_tr_b16 v[126:127], v251 offset:6144
    s_waitcnt vmcnt(54) lgkmcnt(8)
    s_barrier
    v_mfma_f32_16x16x32_bf16 v[64:67], v[96:99], a[0:3], v[64:67]
    ds_read_b64_tr_b16 v[128:129], v248 offset:8192
    ds_read_b64_tr_b16 v[130:131], v248 offset:10240
    v_mfma_f32_16x16x32_bf16 v[68:71], v[96:99], a[4:7], v[68:71]
    ds_read_b64_tr_b16 v[132:133], v249 offset:8192
    v_mfma_f32_16x16x32_bf16 v[76:79], v[100:103], a[4:7], v[76:79]
    ds_read_b64_tr_b16 v[134:135], v249 offset:10240
    v_mfma_f32_16x16x32_bf16 v[72:75], v[100:103], a[0:3], v[72:75]
    ds_read_b64_tr_b16 v[136:137], v250 offset:8192
    buffer_load_dwordx4 a[148:151], v2, s[28:31], s33 offen offset:1024 sc1
    v_mfma_f32_16x16x32_bf16 v[80:83], v[104:107], a[0:3], v[80:83]
    ds_read_b64_tr_b16 v[138:139], v250 offset:10240
    v_mfma_f32_16x16x32_bf16 v[84:87], v[104:107], a[4:7], v[84:87]
    ds_read_b64_tr_b16 v[140:141], v251 offset:8192
    buffer_load_dwordx4 a[152:155], v2, s[28:31], s33 offen offset:2048 sc1
    v_mfma_f32_16x16x32_bf16 v[92:95], v[108:111], a[4:7], v[92:95]
    ds_read_b64_tr_b16 v[142:143], v251 offset:10240
    v_mfma_f32_16x16x32_bf16 v[88:91], v[108:111], a[0:3], v[88:91]
    s_waitcnt lgkmcnt(8)
    buffer_load_dwordx4 a[156:159], v2, s[28:31], s33 offen offset:3072 sc1
    v_mfma_f32_16x16x32_bf16 v[64:67], v[112:115], a[8:11], v[64:67]
    ds_read_b64_tr_b16 v[144:145], v248 offset:12288
    v_mfma_f32_16x16x32_bf16 v[68:71], v[112:115], a[12:15], v[68:71]
    ds_read_b64_tr_b16 v[146:147], v248 offset:14336
    v_mfma_f32_16x16x32_bf16 v[76:79], v[116:119], a[12:15], v[76:79]
    ds_read_b64_tr_b16 v[148:149], v249 offset:12288
    s_add_u32 m0, s63, 40960
    v_mfma_f32_16x16x32_bf16 v[72:75], v[116:119], a[8:11], v[72:75]
    ds_read_b64_tr_b16 v[150:151], v249 offset:14336
    v_mfma_f32_16x16x32_bf16 v[80:83], v[120:123], a[8:11], v[80:83]
    ds_read_b64_tr_b16 v[152:153], v250 offset:12288
    buffer_load_dwordx4 v14, s[52:55], s61 offen lds
    v_mfma_f32_16x16x32_bf16 v[84:87], v[120:123], a[12:15], v[84:87]
    ds_read_b64_tr_b16 v[154:155], v250 offset:14336
    v_mfma_f32_16x16x32_bf16 v[92:95], v[124:127], a[12:15], v[92:95]
    ds_read_b64_tr_b16 v[156:157], v251 offset:12288
    buffer_load_dwordx4 v0, s[52:55], s61 offen offset:1024 lds
    v_mfma_f32_16x16x32_bf16 v[88:91], v[124:127], a[8:11], v[88:91]
    ds_read_b64_tr_b16 v[158:159], v251 offset:14336
    s_waitcnt vmcnt(61) lgkmcnt(8)
    v_mfma_f32_16x16x32_bf16 v[32:35], v[128:131], a[0:3], v[32:35]
    ds_read_b64_tr_b16 v[96:97], v248 offset:16384
    ds_read_b64_tr_b16 v[98:99], v248 offset:18432
    v_mfma_f32_16x16x32_bf16 v[36:39], v[128:131], a[4:7], v[36:39]
    ds_read_b64_tr_b16 v[100:101], v249 offset:16384
    v_mfma_f32_16x16x32_bf16 v[44:47], v[132:135], a[4:7], v[44:47]
    ds_read_b64_tr_b16 v[102:103], v249 offset:18432
    v_mfma_f32_16x16x32_bf16 v[40:43], v[132:135], a[0:3], v[40:43]
    ds_read_b64_tr_b16 v[104:105], v250 offset:16384
    v_add_u32 v2, 57344, v2
    v_mfma_f32_16x16x32_bf16 v[48:51], v[136:139], a[0:3], v[48:51]
    ds_read_b64_tr_b16 v[106:107], v250 offset:18432
    v_mfma_f32_16x16x32_bf16 v[52:55], v[136:139], a[4:7], v[52:55]
    ds_read_b64_tr_b16 v[108:109], v251 offset:16384
    buffer_load_dwordx4 a[160:163], v2, s[28:31], s24 offen offset:0 sc1
    v_mfma_f32_16x16x32_bf16 v[60:63], v[140:143], a[4:7], v[60:63]
    ds_read_b64_tr_b16 v[110:111], v251 offset:18432
    v_mfma_f32_16x16x32_bf16 v[56:59], v[140:143], a[0:3], v[56:59]
    s_waitcnt lgkmcnt(8)
    buffer_load_dwordx4 a[164:167], v2, s[28:31], s24 offen offset:1024 sc1
    v_mfma_f32_16x16x32_bf16 v[32:35], v[144:147], a[8:11], v[32:35]
    ds_read_b64_tr_b16 v[112:113], v248 offset:20480
    v_mfma_f32_16x16x32_bf16 v[36:39], v[144:147], a[12:15], v[36:39]
    ds_read_b64_tr_b16 v[114:115], v248 offset:22528
    v_mfma_f32_16x16x32_bf16 v[44:47], v[148:151], a[12:15], v[44:47]
    ds_read_b64_tr_b16 v[116:117], v249 offset:20480
    v_mfma_f32_16x16x32_bf16 v[40:43], v[148:151], a[8:11], v[40:43]
    ds_read_b64_tr_b16 v[118:119], v249 offset:22528
    v_mfma_f32_16x16x32_bf16 v[48:51], v[152:155], a[8:11], v[48:51]
    ds_read_b64_tr_b16 v[120:121], v250 offset:20480
    buffer_load_dwordx4 a[168:171], v2, s[28:31], s24 offen offset:2048 sc1
    v_mfma_f32_16x16x32_bf16 v[52:55], v[152:155], a[12:15], v[52:55]
    ds_read_b64_tr_b16 v[122:123], v250 offset:22528
    v_mfma_f32_16x16x32_bf16 v[60:63], v[156:159], a[12:15], v[60:63]
    ds_read_b64_tr_b16 v[124:125], v251 offset:20480
    buffer_load_dwordx4 a[172:175], v2, s[28:31], s24 offen offset:3072 sc1
    v_mfma_f32_16x16x32_bf16 v[56:59], v[156:159], a[8:11], v[56:59]
    ds_read_b64_tr_b16 v[126:127], v251 offset:22528
    s_waitcnt vmcnt(55) lgkmcnt(8)
    s_barrier
    v_mfma_f32_16x16x32_bf16 v[64:67], v[96:99], a[16:19], v[64:67]
    ds_read_b64_tr_b16 v[128:129], v248 offset:24576
    ds_read_b64_tr_b16 v[130:131], v248 offset:26624
    v_mfma_f32_16x16x32_bf16 v[68:71], v[96:99], a[20:23], v[68:71]
    ds_read_b64_tr_b16 v[132:133], v249 offset:24576
    v_mfma_f32_16x16x32_bf16 v[76:79], v[100:103], a[20:23], v[76:79]
    ds_read_b64_tr_b16 v[134:135], v249 offset:26624
    v_mfma_f32_16x16x32_bf16 v[72:75], v[100:103], a[16:19], v[72:75]
    ds_read_b64_tr_b16 v[136:137], v250 offset:24576
    s_add_u32 m0, s63, 49152
    v_mfma_f32_16x16x32_bf16 v[80:83], v[104:107], a[16:19], v[80:83]
    ds_read_b64_tr_b16 v[138:139], v250 offset:26624
    v_mfma_f32_16x16x32_bf16 v[84:87], v[104:107], a[20:23], v[84:87]
    ds_read_b64_tr_b16 v[140:141], v251 offset:24576
    buffer_load_dwordx4 v14, s[52:55], s38 offen lds
    v_mfma_f32_16x16x32_bf16 v[92:95], v[108:111], a[20:23], v[92:95]
    ds_read_b64_tr_b16 v[142:143], v251 offset:26624
    v_mfma_f32_16x16x32_bf16 v[88:91], v[108:111], a[16:19], v[88:91]
    s_waitcnt lgkmcnt(8)
    buffer_load_dwordx4 v0, s[52:55], s38 offen offset:1024 lds
    v_mfma_f32_16x16x32_bf16 v[64:67], v[112:115], a[24:27], v[64:67]
    ds_read_b64_tr_b16 v[144:145], v248 offset:28672
    v_mfma_f32_16x16x32_bf16 v[68:71], v[112:115], a[28:31], v[68:71]
    ds_read_b64_tr_b16 v[146:147], v248 offset:30720
    v_mfma_f32_16x16x32_bf16 v[76:79], v[116:119], a[28:31], v[76:79]
    ds_read_b64_tr_b16 v[148:149], v249 offset:28672
    buffer_load_dwordx4 a[176:179], v2, s[28:31], s25 offen offset:0 sc1
    v_mfma_f32_16x16x32_bf16 v[72:75], v[116:119], a[24:27], v[72:75]
    ds_read_b64_tr_b16 v[150:151], v249 offset:30720
    v_mfma_f32_16x16x32_bf16 v[80:83], v[120:123], a[24:27], v[80:83]
    ds_read_b64_tr_b16 v[152:153], v250 offset:28672
    buffer_load_dwordx4 a[180:183], v2, s[28:31], s25 offen offset:1024 sc1
    v_mfma_f32_16x16x32_bf16 v[84:87], v[120:123], a[28:31], v[84:87]
    ds_read_b64_tr_b16 v[154:155], v250 offset:30720
    v_mfma_f32_16x16x32_bf16 v[92:95], v[124:127], a[28:31], v[92:95]
    ds_read_b64_tr_b16 v[156:157], v251 offset:28672
    buffer_load_dwordx4 a[184:187], v2, s[28:31], s25 offen offset:2048 sc1
    v_mfma_f32_16x16x32_bf16 v[88:91], v[124:127], a[24:27], v[88:91]
    ds_read_b64_tr_b16 v[158:159], v251 offset:30720
    s_waitcnt vmcnt(62) lgkmcnt(8)
    v_mfma_f32_16x16x32_bf16 v[32:35], v[128:131], a[16:19], v[32:35]
    ds_read_b64_tr_b16 v[96:97], v244 offset:0
    ds_read_b64_tr_b16 v[98:99], v244 offset:2048
    v_mfma_f32_16x16x32_bf16 v[36:39], v[128:131], a[20:23], v[36:39]
    ds_read_b64_tr_b16 v[100:101], v245 offset:0
    v_mfma_f32_16x16x32_bf16 v[44:47], v[132:135], a[20:23], v[44:47]
    ds_read_b64_tr_b16 v[102:103], v245 offset:2048
    v_mfma_f32_16x16x32_bf16 v[40:43], v[132:135], a[16:19], v[40:43]
    ds_read_b64_tr_b16 v[104:105], v246 offset:0
    buffer_load_dwordx4 a[188:191], v2, s[28:31], s25 offen offset:3072 sc1
    v_mfma_f32_16x16x32_bf16 v[48:51], v[136:139], a[16:19], v[48:51]
    ds_read_b64_tr_b16 v[106:107], v246 offset:2048
    v_mfma_f32_16x16x32_bf16 v[52:55], v[136:139], a[20:23], v[52:55]
    ds_read_b64_tr_b16 v[108:109], v247 offset:0
    s_add_u32 m0, s63, 57344
    v_mfma_f32_16x16x32_bf16 v[60:63], v[140:143], a[20:23], v[60:63]
    ds_read_b64_tr_b16 v[110:111], v247 offset:2048
    v_mfma_f32_16x16x32_bf16 v[56:59], v[140:143], a[16:19], v[56:59]
    s_waitcnt lgkmcnt(8)
    buffer_load_dwordx4 v14, s[52:55], s39 offen lds
    v_mfma_f32_16x16x32_bf16 v[32:35], v[144:147], a[24:27], v[32:35]
    ds_read_b64_tr_b16 v[112:113], v244 offset:4096
    v_mfma_f32_16x16x32_bf16 v[36:39], v[144:147], a[28:31], v[36:39]
    ds_read_b64_tr_b16 v[114:115], v244 offset:6144
    v_mfma_f32_16x16x32_bf16 v[44:47], v[148:151], a[28:31], v[44:47]
    ds_read_b64_tr_b16 v[116:117], v245 offset:4096
    v_mfma_f32_16x16x32_bf16 v[40:43], v[148:151], a[24:27], v[40:43]
    ds_read_b64_tr_b16 v[118:119], v245 offset:6144
    v_mfma_f32_16x16x32_bf16 v[48:51], v[152:155], a[24:27], v[48:51]
    ds_read_b64_tr_b16 v[120:121], v246 offset:4096
    buffer_load_dwordx4 v0, s[52:55], s39 offen offset:1024 lds
    v_mfma_f32_16x16x32_bf16 v[52:55], v[152:155], a[28:31], v[52:55]
    ds_read_b64_tr_b16 v[122:123], v246 offset:6144
    v_mfma_f32_16x16x32_bf16 v[60:63], v[156:159], a[28:31], v[60:63]
    ds_read_b64_tr_b16 v[124:125], v247 offset:4096
    buffer_load_dwordx4 a[192:195], v2, s[28:31], s26 offen offset:0 sc1
    v_mfma_f32_16x16x32_bf16 v[56:59], v[156:159], a[24:27], v[56:59]
    ds_read_b64_tr_b16 v[126:127], v247 offset:6144
    s_waitcnt vmcnt(56) lgkmcnt(8)
    s_barrier
    v_mfma_f32_16x16x32_bf16 v[64:67], v[96:99], a[32:35], v[64:67]
    ds_read_b64_tr_b16 v[128:129], v244 offset:8192
    ds_read_b64_tr_b16 v[130:131], v244 offset:10240
    v_mfma_f32_16x16x32_bf16 v[68:71], v[96:99], a[36:39], v[68:71]
    ds_read_b64_tr_b16 v[132:133], v245 offset:8192
    v_mfma_f32_16x16x32_bf16 v[76:79], v[100:103], a[36:39], v[76:79]
    ds_read_b64_tr_b16 v[134:135], v245 offset:10240
    v_mfma_f32_16x16x32_bf16 v[72:75], v[100:103], a[32:35], v[72:75]
    ds_read_b64_tr_b16 v[136:137], v246 offset:8192
    buffer_load_dwordx4 a[196:199], v2, s[28:31], s26 offen offset:1024 sc1
    v_mfma_f32_16x16x32_bf16 v[80:83], v[104:107], a[32:35], v[80:83]
    ds_read_b64_tr_b16 v[138:139], v246 offset:10240
    v_mfma_f32_16x16x32_bf16 v[84:87], v[104:107], a[36:39], v[84:87]
    ds_read_b64_tr_b16 v[140:141], v247 offset:8192
    buffer_load_dwordx4 a[200:203], v2, s[28:31], s26 offen offset:2048 sc1
    v_mfma_f32_16x16x32_bf16 v[92:95], v[108:111], a[36:39], v[92:95]
    ds_read_b64_tr_b16 v[142:143], v247 offset:10240
    v_mfma_f32_16x16x32_bf16 v[88:91], v[108:111], a[32:35], v[88:91]
    s_waitcnt lgkmcnt(8)
    buffer_load_dwordx4 a[204:207], v2, s[28:31], s26 offen offset:3072 sc1
    v_mfma_f32_16x16x32_bf16 v[64:67], v[112:115], a[40:43], v[64:67]
    ds_read_b64_tr_b16 v[144:145], v244 offset:12288
    v_mfma_f32_16x16x32_bf16 v[68:71], v[112:115], a[44:47], v[68:71]
    ds_read_b64_tr_b16 v[146:147], v244 offset:14336
    v_mfma_f32_16x16x32_bf16 v[76:79], v[116:119], a[44:47], v[76:79]
    ds_read_b64_tr_b16 v[148:149], v245 offset:12288
    s_add_u32 m0, s63, 98304
    v_mfma_f32_16x16x32_bf16 v[72:75], v[116:119], a[40:43], v[72:75]
    ds_read_b64_tr_b16 v[150:151], v245 offset:14336
    v_mfma_f32_16x16x32_bf16 v[80:83], v[120:123], a[40:43], v[80:83]
    ds_read_b64_tr_b16 v[152:153], v246 offset:12288
    buffer_load_dwordx4 v14, s[52:55], s80 offen lds
    v_mfma_f32_16x16x32_bf16 v[84:87], v[120:123], a[44:47], v[84:87]
    ds_read_b64_tr_b16 v[154:155], v246 offset:14336
    v_mfma_f32_16x16x32_bf16 v[92:95], v[124:127], a[44:47], v[92:95]
    ds_read_b64_tr_b16 v[156:157], v247 offset:12288
    buffer_load_dwordx4 v0, s[52:55], s80 offen offset:1024 lds
    v_mfma_f32_16x16x32_bf16 v[88:91], v[124:127], a[40:43], v[88:91]
    ds_read_b64_tr_b16 v[158:159], v247 offset:14336
    s_waitcnt vmcnt(56) lgkmcnt(8)
    v_mfma_f32_16x16x32_bf16 v[64:67], v[128:131], a[48:51], v[64:67]
    ds_read_b64_tr_b16 v[96:97], v244 offset:16384
    ds_read_b64_tr_b16 v[98:99], v244 offset:18432
    v_mfma_f32_16x16x32_bf16 v[68:71], v[128:131], a[52:55], v[68:71]
    ds_read_b64_tr_b16 v[100:101], v245 offset:16384
    v_mfma_f32_16x16x32_bf16 v[76:79], v[132:135], a[52:55], v[76:79]
    ds_read_b64_tr_b16 v[102:103], v245 offset:18432
    v_mfma_f32_16x16x32_bf16 v[72:75], v[132:135], a[48:51], v[72:75]
    ds_read_b64_tr_b16 v[104:105], v246 offset:16384
    buffer_load_dwordx4 a[208:211], v2, s[28:31], s27 offen offset:0 sc1
    v_mfma_f32_16x16x32_bf16 v[80:83], v[136:139], a[48:51], v[80:83]
    ds_read_b64_tr_b16 v[106:107], v246 offset:18432
    v_mfma_f32_16x16x32_bf16 v[84:87], v[136:139], a[52:55], v[84:87]
    ds_read_b64_tr_b16 v[108:109], v247 offset:16384
    buffer_load_dwordx4 a[212:215], v2, s[28:31], s27 offen offset:1024 sc1
    v_mfma_f32_16x16x32_bf16 v[92:95], v[140:143], a[52:55], v[92:95]
    ds_read_b64_tr_b16 v[110:111], v247 offset:18432
    v_mfma_f32_16x16x32_bf16 v[88:91], v[140:143], a[48:51], v[88:91]
    s_waitcnt lgkmcnt(8)
    buffer_load_dwordx4 a[216:219], v2, s[28:31], s27 offen offset:2048 sc1
    v_mfma_f32_16x16x32_bf16 v[64:67], v[144:147], a[56:59], v[64:67]
    ds_read_b64_tr_b16 v[112:113], v244 offset:20480
    v_mfma_f32_16x16x32_bf16 v[68:71], v[144:147], a[60:63], v[68:71]
    ds_read_b64_tr_b16 v[114:115], v244 offset:22528
    v_mfma_f32_16x16x32_bf16 v[76:79], v[148:151], a[60:63], v[76:79]
    ds_read_b64_tr_b16 v[116:117], v245 offset:20480
    buffer_load_dwordx4 a[220:223], v2, s[28:31], s27 offen offset:3072 sc1
    v_mfma_f32_16x16x32_bf16 v[72:75], v[148:151], a[56:59], v[72:75]
    ds_read_b64_tr_b16 v[118:119], v245 offset:22528
    v_mfma_f32_16x16x32_bf16 v[80:83], v[152:155], a[56:59], v[80:83]
    ds_read_b64_tr_b16 v[120:121], v246 offset:20480
    s_add_u32 m0, s63, 106496
    v_mfma_f32_16x16x32_bf16 v[84:87], v[152:155], a[60:63], v[84:87]
    ds_read_b64_tr_b16 v[122:123], v246 offset:22528
    v_mfma_f32_16x16x32_bf16 v[92:95], v[156:159], a[60:63], v[92:95]
    ds_read_b64_tr_b16 v[124:125], v247 offset:20480
    buffer_load_dwordx4 v14, s[52:55], s81 offen lds
    v_mfma_f32_16x16x32_bf16 v[88:91], v[156:159], a[56:59], v[88:91]
    ds_read_b64_tr_b16 v[126:127], v247 offset:22528
    s_waitcnt vmcnt(52) lgkmcnt(8)
    s_barrier
    v_mfma_f32_16x16x32_bf16 v[64:67], v[96:99], a[64:67], v[64:67]
    ds_read_b64_tr_b16 v[128:129], v244 offset:24576
    ds_read_b64_tr_b16 v[130:131], v244 offset:26624
    v_mfma_f32_16x16x32_bf16 v[68:71], v[96:99], a[68:71], v[68:71]
    ds_read_b64_tr_b16 v[132:133], v245 offset:24576
    v_mfma_f32_16x16x32_bf16 v[76:79], v[100:103], a[68:71], v[76:79]
    ds_read_b64_tr_b16 v[134:135], v245 offset:26624
    v_mfma_f32_16x16x32_bf16 v[72:75], v[100:103], a[64:67], v[72:75]
    ds_read_b64_tr_b16 v[136:137], v246 offset:24576
    v_mfma_f32_16x16x32_bf16 v[80:83], v[104:107], a[64:67], v[80:83]
    ds_read_b64_tr_b16 v[138:139], v246 offset:26624
    v_mfma_f32_16x16x32_bf16 v[84:87], v[104:107], a[68:71], v[84:87]
    ds_read_b64_tr_b16 v[140:141], v247 offset:24576
    buffer_load_dwordx4 v0, s[52:55], s81 offen offset:1024 lds
    v_mfma_f32_16x16x32_bf16 v[92:95], v[108:111], a[68:71], v[92:95]
    ds_read_b64_tr_b16 v[142:143], v247 offset:26624
    v_mfma_f32_16x16x32_bf16 v[88:91], v[108:111], a[64:67], v[88:91]
    s_waitcnt lgkmcnt(8)
    buffer_load_dwordx4 a[224:227], v2, s[28:31], s35 offen offset:0 sc1
    v_mfma_f32_16x16x32_bf16 v[64:67], v[112:115], a[72:75], v[64:67]
    ds_read_b64_tr_b16 v[144:145], v244 offset:28672
    v_mfma_f32_16x16x32_bf16 v[68:71], v[112:115], a[76:79], v[68:71]
    ds_read_b64_tr_b16 v[146:147], v244 offset:30720
    v_mfma_f32_16x16x32_bf16 v[76:79], v[116:119], a[76:79], v[76:79]
    ds_read_b64_tr_b16 v[148:149], v245 offset:28672
    v_mfma_f32_16x16x32_bf16 v[72:75], v[116:119], a[72:75], v[72:75]
    ds_read_b64_tr_b16 v[150:151], v245 offset:30720
    v_mfma_f32_16x16x32_bf16 v[80:83], v[120:123], a[72:75], v[80:83]
    ds_read_b64_tr_b16 v[152:153], v246 offset:28672
    buffer_load_dwordx4 a[228:231], v2, s[28:31], s35 offen offset:1024 sc1
    v_mfma_f32_16x16x32_bf16 v[84:87], v[120:123], a[76:79], v[84:87]
    ds_read_b64_tr_b16 v[154:155], v246 offset:30720
    v_mfma_f32_16x16x32_bf16 v[92:95], v[124:127], a[76:79], v[92:95]
    ds_read_b64_tr_b16 v[156:157], v247 offset:28672
    buffer_load_dwordx4 a[232:235], v2, s[28:31], s35 offen offset:2048 sc1
    v_mfma_f32_16x16x32_bf16 v[88:91], v[124:127], a[72:75], v[88:91]
    ds_read_b64_tr_b16 v[158:159], v247 offset:30720
    s_waitcnt vmcnt(52) lgkmcnt(8)
    v_mfma_f32_16x16x32_bf16 v[64:67], v[128:131], a[80:83], v[64:67]
    ds_read_b64_tr_b16 v[96:97], v240 offset:0
    ds_read_b64_tr_b16 v[98:99], v240 offset:2048
    v_mfma_f32_16x16x32_bf16 v[68:71], v[128:131], a[84:87], v[68:71]
    ds_read_b64_tr_b16 v[100:101], v241 offset:0
    v_mfma_f32_16x16x32_bf16 v[76:79], v[132:135], a[84:87], v[76:79]
    ds_read_b64_tr_b16 v[102:103], v241 offset:2048
    v_mfma_f32_16x16x32_bf16 v[72:75], v[132:135], a[80:83], v[72:75]
    ds_read_b64_tr_b16 v[104:105], v242 offset:0
    buffer_load_dwordx4 a[236:239], v2, s[28:31], s35 offen offset:3072 sc1
    v_mfma_f32_16x16x32_bf16 v[80:83], v[136:139], a[80:83], v[80:83]
    ds_read_b64_tr_b16 v[106:107], v242 offset:2048
    v_mfma_f32_16x16x32_bf16 v[84:87], v[136:139], a[84:87], v[84:87]
    ds_read_b64_tr_b16 v[108:109], v243 offset:0
    s_add_u32 m0, s63, 114688
    v_mfma_f32_16x16x32_bf16 v[92:95], v[140:143], a[84:87], v[92:95]
    ds_read_b64_tr_b16 v[110:111], v243 offset:2048
    v_mfma_f32_16x16x32_bf16 v[88:91], v[140:143], a[80:83], v[88:91]
    s_waitcnt lgkmcnt(8)
    buffer_load_dwordx4 v12, s[52:55], s10 offen lds
    v_mfma_f32_16x16x32_bf16 v[64:67], v[144:147], a[88:91], v[64:67]
    ds_read_b64_tr_b16 v[112:113], v240 offset:4096
    v_mfma_f32_16x16x32_bf16 v[68:71], v[144:147], a[92:95], v[68:71]
    ds_read_b64_tr_b16 v[114:115], v240 offset:6144
    v_mfma_f32_16x16x32_bf16 v[76:79], v[148:151], a[92:95], v[76:79]
    ds_read_b64_tr_b16 v[116:117], v241 offset:4096
    buffer_load_dwordx4 v13, s[52:55], s10 offen offset:1024 lds
    v_mfma_f32_16x16x32_bf16 v[72:75], v[148:151], a[88:91], v[72:75]
    ds_read_b64_tr_b16 v[118:119], v241 offset:6144
    v_mfma_f32_16x16x32_bf16 v[80:83], v[152:155], a[88:91], v[80:83]
    ds_read_b64_tr_b16 v[120:121], v242 offset:4096
    buffer_load_dwordx4 a[240:243], v2, s[28:31], s33 offen offset:0 sc1
    v_mfma_f32_16x16x32_bf16 v[84:87], v[152:155], a[92:95], v[84:87]
    ds_read_b64_tr_b16 v[122:123], v242 offset:6144
    v_mfma_f32_16x16x32_bf16 v[92:95], v[156:159], a[92:95], v[92:95]
    ds_read_b64_tr_b16 v[124:125], v243 offset:4096
    buffer_load_dwordx4 a[244:247], v2, s[28:31], s33 offen offset:1024 sc1
    v_mfma_f32_16x16x32_bf16 v[88:91], v[156:159], a[88:91], v[88:91]
    ds_read_b64_tr_b16 v[126:127], v243 offset:6144
    s_waitcnt vmcnt(50) lgkmcnt(8)
    s_barrier
    v_mfma_f32_16x16x32_bf16 v[64:67], v[96:99], a[96:99], v[64:67]
    ds_read_b64_tr_b16 v[128:129], v240 offset:8192
    ds_read_b64_tr_b16 v[130:131], v240 offset:10240
    v_mfma_f32_16x16x32_bf16 v[68:71], v[96:99], a[100:103], v[68:71]
    ds_read_b64_tr_b16 v[132:133], v241 offset:8192
    v_mfma_f32_16x16x32_bf16 v[76:79], v[100:103], a[100:103], v[76:79]
    ds_read_b64_tr_b16 v[134:135], v241 offset:10240
    v_mfma_f32_16x16x32_bf16 v[72:75], v[100:103], a[96:99], v[72:75]
    ds_read_b64_tr_b16 v[136:137], v242 offset:8192
    buffer_load_dwordx4 a[248:251], v2, s[28:31], s33 offen offset:2048 sc1
    v_mfma_f32_16x16x32_bf16 v[80:83], v[104:107], a[96:99], v[80:83]
    ds_read_b64_tr_b16 v[138:139], v242 offset:10240
    v_mfma_f32_16x16x32_bf16 v[84:87], v[104:107], a[100:103], v[84:87]
    ds_read_b64_tr_b16 v[140:141], v243 offset:8192
    buffer_load_dwordx4 a[252:255], v2, s[28:31], s33 offen offset:3072 sc1
    v_mfma_f32_16x16x32_bf16 v[92:95], v[108:111], a[100:103], v[92:95]
    ds_read_b64_tr_b16 v[142:143], v243 offset:10240
    v_mfma_f32_16x16x32_bf16 v[88:91], v[108:111], a[96:99], v[88:91]
    s_waitcnt lgkmcnt(8)
    s_add_u32 m0, s63, 122880
    v_mfma_f32_16x16x32_bf16 v[64:67], v[112:115], a[104:107], v[64:67]
    ds_read_b64_tr_b16 v[144:145], v240 offset:12288
    v_mfma_f32_16x16x32_bf16 v[68:71], v[112:115], a[108:111], v[68:71]
    ds_read_b64_tr_b16 v[146:147], v240 offset:14336
    v_mfma_f32_16x16x32_bf16 v[76:79], v[116:119], a[108:111], v[76:79]
    ds_read_b64_tr_b16 v[148:149], v241 offset:12288
    v_mfma_f32_16x16x32_bf16 v[72:75], v[116:119], a[104:107], v[72:75]
    ds_read_b64_tr_b16 v[150:151], v241 offset:14336
    v_mfma_f32_16x16x32_bf16 v[80:83], v[120:123], a[104:107], v[80:83]
    ds_read_b64_tr_b16 v[152:153], v242 offset:12288
    buffer_load_dwordx4 v12, s[52:55], s11 offen lds
    v_mfma_f32_16x16x32_bf16 v[84:87], v[120:123], a[108:111], v[84:87]
    ds_read_b64_tr_b16 v[154:155], v242 offset:14336
    v_mfma_f32_16x16x32_bf16 v[92:95], v[124:127], a[108:111], v[92:95]
    ds_read_b64_tr_b16 v[156:157], v243 offset:12288
    buffer_load_dwordx4 v13, s[52:55], s11 offen offset:1024 lds
    v_mfma_f32_16x16x32_bf16 v[88:91], v[124:127], a[104:107], v[88:91]
    ds_read_b64_tr_b16 v[158:159], v243 offset:14336
    s_waitcnt vmcnt(50) lgkmcnt(8)
    v_mfma_f32_16x16x32_bf16 v[64:67], v[128:131], a[112:115], v[64:67]
    ds_read_b64_tr_b16 v[96:97], v240 offset:16384
    ds_read_b64_tr_b16 v[98:99], v240 offset:18432
    v_mfma_f32_16x16x32_bf16 v[68:71], v[128:131], a[116:119], v[68:71]
    ds_read_b64_tr_b16 v[100:101], v241 offset:16384
    s_add_u32 m0, s63, 131072
    v_mfma_f32_16x16x32_bf16 v[76:79], v[132:135], a[116:119], v[76:79]
    ds_read_b64_tr_b16 v[102:103], v241 offset:18432
    v_mfma_f32_16x16x32_bf16 v[72:75], v[132:135], a[112:115], v[72:75]
    ds_read_b64_tr_b16 v[104:105], v242 offset:16384
    buffer_load_dwordx4 v12, s[52:55], s60 offen lds
    v_mfma_f32_16x16x32_bf16 v[80:83], v[136:139], a[112:115], v[80:83]
    ds_read_b64_tr_b16 v[106:107], v242 offset:18432
    v_mfma_f32_16x16x32_bf16 v[84:87], v[136:139], a[116:119], v[84:87]
    ds_read_b64_tr_b16 v[108:109], v243 offset:16384
    buffer_load_dwordx4 v13, s[52:55], s60 offen offset:1024 lds
    v_mfma_f32_16x16x32_bf16 v[92:95], v[140:143], a[116:119], v[92:95]
    ds_read_b64_tr_b16 v[110:111], v243 offset:18432
    v_mfma_f32_16x16x32_bf16 v[88:91], v[140:143], a[112:115], v[88:91]
    s_waitcnt lgkmcnt(8)
    s_add_u32 m0, s63, 139264
    v_mfma_f32_16x16x32_bf16 v[64:67], v[144:147], a[120:123], v[64:67]
    ds_read_b64_tr_b16 v[112:113], v240 offset:20480
    buffer_load_dwordx4 v12, s[52:55], s61 offen lds
    v_mfma_f32_16x16x32_bf16 v[68:71], v[144:147], a[124:127], v[68:71]
    ds_read_b64_tr_b16 v[114:115], v240 offset:22528
    v_mfma_f32_16x16x32_bf16 v[76:79], v[148:151], a[124:127], v[76:79]
    ds_read_b64_tr_b16 v[116:117], v241 offset:20480
    buffer_load_dwordx4 v13, s[52:55], s61 offen offset:1024 lds
    v_mfma_f32_16x16x32_bf16 v[72:75], v[148:151], a[120:123], v[72:75]
    ds_read_b64_tr_b16 v[118:119], v241 offset:22528
    v_mfma_f32_16x16x32_bf16 v[80:83], v[152:155], a[120:123], v[80:83]
    ds_read_b64_tr_b16 v[120:121], v242 offset:20480
    s_add_u32 m0, s63, 147456
    v_mfma_f32_16x16x32_bf16 v[84:87], v[152:155], a[124:127], v[84:87]
    ds_read_b64_tr_b16 v[122:123], v242 offset:22528
    v_mfma_f32_16x16x32_bf16 v[92:95], v[156:159], a[124:127], v[92:95]
    ds_read_b64_tr_b16 v[124:125], v243 offset:20480
    buffer_load_dwordx4 v12, s[52:55], s38 offen lds
    v_mfma_f32_16x16x32_bf16 v[88:91], v[156:159], a[120:123], v[88:91]
    ds_read_b64_tr_b16 v[126:127], v243 offset:22528
    s_waitcnt vmcnt(47) lgkmcnt(8)
    s_barrier
    v_mfma_f32_16x16x32_bf16 v[64:67], v[96:99], a[128:131], v[64:67]
    ds_read_b64_tr_b16 v[128:129], v240 offset:24576
    ds_read_b64_tr_b16 v[130:131], v240 offset:26624
    v_mfma_f32_16x16x32_bf16 v[68:71], v[96:99], a[132:135], v[68:71]
    ds_read_b64_tr_b16 v[132:133], v241 offset:24576
    buffer_load_dwordx4 v13, s[52:55], s38 offen offset:1024 lds
    v_mfma_f32_16x16x32_bf16 v[76:79], v[100:103], a[132:135], v[76:79]
    ds_read_b64_tr_b16 v[134:135], v241 offset:26624
    v_mfma_f32_16x16x32_bf16 v[72:75], v[100:103], a[128:131], v[72:75]
    ds_read_b64_tr_b16 v[136:137], v242 offset:24576
    s_add_u32 m0, s63, 155648
    v_mfma_f32_16x16x32_bf16 v[80:83], v[104:107], a[128:131], v[80:83]
    ds_read_b64_tr_b16 v[138:139], v242 offset:26624
    v_mfma_f32_16x16x32_bf16 v[84:87], v[104:107], a[132:135], v[84:87]
    ds_read_b64_tr_b16 v[140:141], v243 offset:24576
    buffer_load_dwordx4 v12, s[52:55], s39 offen lds
    v_mfma_f32_16x16x32_bf16 v[92:95], v[108:111], a[132:135], v[92:95]
    ds_read_b64_tr_b16 v[142:143], v243 offset:26624
    v_mfma_f32_16x16x32_bf16 v[88:91], v[108:111], a[128:131], v[88:91]
    s_waitcnt lgkmcnt(8)
    buffer_load_dwordx4 v13, s[52:55], s39 offen offset:1024 lds
    v_mfma_f32_16x16x32_bf16 v[64:67], v[112:115], a[136:139], v[64:67]
    ds_read_b64_tr_b16 v[144:145], v240 offset:28672
    v_mfma_f32_16x16x32_bf16 v[68:71], v[112:115], a[140:143], v[68:71]
    ds_read_b64_tr_b16 v[146:147], v240 offset:30720
    v_mfma_f32_16x16x32_bf16 v[76:79], v[116:119], a[140:143], v[76:79]
    ds_read_b64_tr_b16 v[148:149], v241 offset:28672
    s_add_u32 m0, s63, 65536
    v_mfma_f32_16x16x32_bf16 v[72:75], v[116:119], a[136:139], v[72:75]
    ds_read_b64_tr_b16 v[150:151], v241 offset:30720
    v_mfma_f32_16x16x32_bf16 v[80:83], v[120:123], a[136:139], v[80:83]
    ds_read_b64_tr_b16 v[152:153], v242 offset:28672
    buffer_load_dwordx4 v12, s[52:55], s80 offen lds
    v_mfma_f32_16x16x32_bf16 v[84:87], v[120:123], a[140:143], v[84:87]
    ds_read_b64_tr_b16 v[154:155], v242 offset:30720
    v_mfma_f32_16x16x32_bf16 v[92:95], v[124:127], a[140:143], v[92:95]
    ds_read_b64_tr_b16 v[156:157], v243 offset:28672
    buffer_load_dwordx4 v13, s[52:55], s80 offen offset:1024 lds
    v_mfma_f32_16x16x32_bf16 v[88:91], v[124:127], a[136:139], v[88:91]
    ds_read_b64_tr_b16 v[158:159], v243 offset:30720
    s_waitcnt vmcnt(48) lgkmcnt(8)
    v_mfma_f32_16x16x32_bf16 v[64:67], v[128:131], a[144:147], v[64:67]
    ds_read_b64_tr_b16 v[96:97], v240 offset:32768
    ds_read_b64_tr_b16 v[98:99], v240 offset:34816
    v_mfma_f32_16x16x32_bf16 v[68:71], v[128:131], a[148:151], v[68:71]
    ds_read_b64_tr_b16 v[100:101], v241 offset:32768
    s_add_u32 m0, s63, 73728
    v_mfma_f32_16x16x32_bf16 v[76:79], v[132:135], a[148:151], v[76:79]
    ds_read_b64_tr_b16 v[102:103], v241 offset:34816
    v_mfma_f32_16x16x32_bf16 v[72:75], v[132:135], a[144:147], v[72:75]
    ds_read_b64_tr_b16 v[104:105], v242 offset:32768
    buffer_load_dwordx4 v12, s[52:55], s81 offen lds
    v_mfma_f32_16x16x32_bf16 v[80:83], v[136:139], a[144:147], v[80:83]
    ds_read_b64_tr_b16 v[106:107], v242 offset:34816
    v_mfma_f32_16x16x32_bf16 v[84:87], v[136:139], a[148:151], v[84:87]
    ds_read_b64_tr_b16 v[108:109], v243 offset:32768
    buffer_load_dwordx4 v13, s[52:55], s81 offen offset:1024 lds
    v_mfma_f32_16x16x32_bf16 v[92:95], v[140:143], a[148:151], v[92:95]
    ds_read_b64_tr_b16 v[110:111], v243 offset:34816
    v_mfma_f32_16x16x32_bf16 v[88:91], v[140:143], a[144:147], v[88:91]
    s_waitcnt lgkmcnt(8)
    v_add_u32 v12, 1835008, v12
    v_mfma_f32_16x16x32_bf16 v[64:67], v[144:147], a[152:155], v[64:67]
    ds_read_b64_tr_b16 v[112:113], v240 offset:36864
    v_add_u32 v13, 1835008, v13
    v_mfma_f32_16x16x32_bf16 v[68:71], v[144:147], a[156:159], v[68:71]
    ds_read_b64_tr_b16 v[114:115], v240 offset:38912
    v_mfma_f32_16x16x32_bf16 v[76:79], v[148:151], a[156:159], v[76:79]
    ds_read_b64_tr_b16 v[116:117], v241 offset:36864
    s_add_u32 m0, s63, 81920
    v_mfma_f32_16x16x32_bf16 v[72:75], v[148:151], a[152:155], v[72:75]
    ds_read_b64_tr_b16 v[118:119], v241 offset:38912
    v_mfma_f32_16x16x32_bf16 v[80:83], v[152:155], a[152:155], v[80:83]
    ds_read_b64_tr_b16 v[120:121], v242 offset:36864
    buffer_load_dwordx4 v12, s[52:55], s60 offen lds
    v_mfma_f32_16x16x32_bf16 v[84:87], v[152:155], a[156:159], v[84:87]
    ds_read_b64_tr_b16 v[122:123], v242 offset:38912
    v_mfma_f32_16x16x32_bf16 v[92:95], v[156:159], a[156:159], v[92:95]
    ds_read_b64_tr_b16 v[124:125], v243 offset:36864
    buffer_load_dwordx4 v13, s[52:55], s60 offen offset:1024 lds
    v_mfma_f32_16x16x32_bf16 v[88:91], v[156:159], a[152:155], v[88:91]
    ds_read_b64_tr_b16 v[126:127], v243 offset:38912
    s_waitcnt vmcnt(44) lgkmcnt(8)
    s_barrier
    v_mfma_f32_16x16x32_bf16 v[64:67], v[96:99], a[160:163], v[64:67]
    ds_read_b64_tr_b16 v[128:129], v240 offset:40960
    ds_read_b64_tr_b16 v[130:131], v240 offset:43008
    v_mfma_f32_16x16x32_bf16 v[68:71], v[96:99], a[164:167], v[68:71]
    ds_read_b64_tr_b16 v[132:133], v241 offset:40960
    s_add_u32 m0, s63, 90112
    v_mfma_f32_16x16x32_bf16 v[76:79], v[100:103], a[164:167], v[76:79]
    ds_read_b64_tr_b16 v[134:135], v241 offset:43008
    v_mfma_f32_16x16x32_bf16 v[72:75], v[100:103], a[160:163], v[72:75]
    ds_read_b64_tr_b16 v[136:137], v242 offset:40960
    buffer_load_dwordx4 v12, s[52:55], s61 offen lds
    v_mfma_f32_16x16x32_bf16 v[80:83], v[104:107], a[160:163], v[80:83]
    ds_read_b64_tr_b16 v[138:139], v242 offset:43008
    v_mfma_f32_16x16x32_bf16 v[84:87], v[104:107], a[164:167], v[84:87]
    ds_read_b64_tr_b16 v[140:141], v243 offset:40960
    buffer_load_dwordx4 v13, s[52:55], s61 offen offset:1024 lds
    v_mfma_f32_16x16x32_bf16 v[92:95], v[108:111], a[164:167], v[92:95]
    ds_read_b64_tr_b16 v[142:143], v243 offset:43008
    v_mfma_f32_16x16x32_bf16 v[88:91], v[108:111], a[160:163], v[88:91]
    s_waitcnt lgkmcnt(8)
    s_add_u32 m0, s63, 0
    v_mfma_f32_16x16x32_bf16 v[64:67], v[112:115], a[168:171], v[64:67]
    ds_read_b64_tr_b16 v[144:145], v240 offset:45056
    buffer_load_dwordx4 v12, s[52:55], s38 offen lds
    v_mfma_f32_16x16x32_bf16 v[68:71], v[112:115], a[172:175], v[68:71]
    ds_read_b64_tr_b16 v[146:147], v240 offset:47104
    v_mfma_f32_16x16x32_bf16 v[76:79], v[116:119], a[172:175], v[76:79]
    ds_read_b64_tr_b16 v[148:149], v241 offset:45056
    buffer_load_dwordx4 v13, s[52:55], s38 offen offset:1024 lds
    v_mfma_f32_16x16x32_bf16 v[72:75], v[116:119], a[168:171], v[72:75]
    ds_read_b64_tr_b16 v[150:151], v241 offset:47104
    v_mfma_f32_16x16x32_bf16 v[80:83], v[120:123], a[168:171], v[80:83]
    ds_read_b64_tr_b16 v[152:153], v242 offset:45056
    s_add_u32 m0, s63, 8192
    v_mfma_f32_16x16x32_bf16 v[84:87], v[120:123], a[172:175], v[84:87]
    ds_read_b64_tr_b16 v[154:155], v242 offset:47104
    v_mfma_f32_16x16x32_bf16 v[92:95], v[124:127], a[172:175], v[92:95]
    ds_read_b64_tr_b16 v[156:157], v243 offset:45056
    buffer_load_dwordx4 v12, s[52:55], s39 offen lds
    v_mfma_f32_16x16x32_bf16 v[88:91], v[124:127], a[168:171], v[88:91]
    ds_read_b64_tr_b16 v[158:159], v243 offset:47104
    s_waitcnt vmcnt(45) lgkmcnt(8)
    v_mfma_f32_16x16x32_bf16 v[64:67], v[128:131], a[176:179], v[64:67]
    ds_read_b64_tr_b16 v[96:97], v240 offset:49152
    ds_read_b64_tr_b16 v[98:99], v240 offset:51200
    v_mfma_f32_16x16x32_bf16 v[68:71], v[128:131], a[180:183], v[68:71]
    ds_read_b64_tr_b16 v[100:101], v241 offset:49152
    v_mfma_f32_16x16x32_bf16 v[76:79], v[132:135], a[180:183], v[76:79]
    ds_read_b64_tr_b16 v[102:103], v241 offset:51200
    v_mfma_f32_16x16x32_bf16 v[72:75], v[132:135], a[176:179], v[72:75]
    ds_read_b64_tr_b16 v[104:105], v242 offset:49152
    buffer_load_dwordx4 v13, s[52:55], s39 offen offset:1024 lds
    v_mfma_f32_16x16x32_bf16 v[80:83], v[136:139], a[176:179], v[80:83]
    ds_read_b64_tr_b16 v[106:107], v242 offset:51200
    v_mfma_f32_16x16x32_bf16 v[84:87], v[136:139], a[180:183], v[84:87]
    ds_read_b64_tr_b16 v[108:109], v243 offset:49152
    s_add_u32 m0, s63, 16384
    v_mfma_f32_16x16x32_bf16 v[92:95], v[140:143], a[180:183], v[92:95]
    ds_read_b64_tr_b16 v[110:111], v243 offset:51200
    v_mfma_f32_16x16x32_bf16 v[88:91], v[140:143], a[176:179], v[88:91]
    s_waitcnt lgkmcnt(8)
    buffer_load_dwordx4 v12, s[52:55], s80 offen lds
    v_mfma_f32_16x16x32_bf16 v[64:67], v[144:147], a[184:187], v[64:67]
    ds_read_b64_tr_b16 v[112:113], v240 offset:53248
    v_mfma_f32_16x16x32_bf16 v[68:71], v[144:147], a[188:191], v[68:71]
    ds_read_b64_tr_b16 v[114:115], v240 offset:55296
    v_mfma_f32_16x16x32_bf16 v[76:79], v[148:151], a[188:191], v[76:79]
    ds_read_b64_tr_b16 v[116:117], v241 offset:53248
    buffer_load_dwordx4 v13, s[52:55], s80 offen offset:1024 lds
    v_mfma_f32_16x16x32_bf16 v[72:75], v[148:151], a[184:187], v[72:75]
    ds_read_b64_tr_b16 v[118:119], v241 offset:55296
    v_mfma_f32_16x16x32_bf16 v[80:83], v[152:155], a[184:187], v[80:83]
    ds_read_b64_tr_b16 v[120:121], v242 offset:53248
    s_add_u32 m0, s63, 24576
    v_mfma_f32_16x16x32_bf16 v[84:87], v[152:155], a[188:191], v[84:87]
    ds_read_b64_tr_b16 v[122:123], v242 offset:55296
    v_mfma_f32_16x16x32_bf16 v[92:95], v[156:159], a[188:191], v[92:95]
    ds_read_b64_tr_b16 v[124:125], v243 offset:53248
    buffer_load_dwordx4 v12, s[52:55], s81 offen lds
    v_mfma_f32_16x16x32_bf16 v[88:91], v[156:159], a[184:187], v[88:91]
    ds_read_b64_tr_b16 v[126:127], v243 offset:55296
    s_waitcnt vmcnt(41) lgkmcnt(8)
    s_barrier
    v_mfma_f32_16x16x32_bf16 v[64:67], v[96:99], a[192:195], v[64:67]
    ds_read_b64_tr_b16 v[128:129], v240 offset:57344
    ds_read_b64_tr_b16 v[130:131], v240 offset:59392
    v_mfma_f32_16x16x32_bf16 v[68:71], v[96:99], a[196:199], v[68:71]
    ds_read_b64_tr_b16 v[132:133], v241 offset:57344
    v_mfma_f32_16x16x32_bf16 v[76:79], v[100:103], a[196:199], v[76:79]
    ds_read_b64_tr_b16 v[134:135], v241 offset:59392
    v_mfma_f32_16x16x32_bf16 v[72:75], v[100:103], a[192:195], v[72:75]
    ds_read_b64_tr_b16 v[136:137], v242 offset:57344
    v_mfma_f32_16x16x32_bf16 v[80:83], v[104:107], a[192:195], v[80:83]
    ds_read_b64_tr_b16 v[138:139], v242 offset:59392
    v_mfma_f32_16x16x32_bf16 v[84:87], v[104:107], a[196:199], v[84:87]
    ds_read_b64_tr_b16 v[140:141], v243 offset:57344
    v_mfma_f32_16x16x32_bf16 v[92:95], v[108:111], a[196:199], v[92:95]
    ds_read_b64_tr_b16 v[142:143], v243 offset:59392
    v_mfma_f32_16x16x32_bf16 v[88:91], v[108:111], a[192:195], v[88:91]
    s_waitcnt lgkmcnt(8)
    buffer_load_dwordx4 v13, s[52:55], s81 offen offset:1024 lds
    v_mfma_f32_16x16x32_bf16 v[64:67], v[112:115], a[200:203], v[64:67]
    ds_read_b64_tr_b16 v[144:145], v240 offset:61440
    v_mfma_f32_16x16x32_bf16 v[68:71], v[112:115], a[204:207], v[68:71]
    ds_read_b64_tr_b16 v[146:147], v240 offset:63488
    v_mfma_f32_16x16x32_bf16 v[76:79], v[116:119], a[204:207], v[76:79]
    ds_read_b64_tr_b16 v[148:149], v241 offset:61440
    v_mfma_f32_16x16x32_bf16 v[72:75], v[116:119], a[200:203], v[72:75]
    ds_read_b64_tr_b16 v[150:151], v241 offset:63488
    v_mfma_f32_16x16x32_bf16 v[80:83], v[120:123], a[200:203], v[80:83]
    ds_read_b64_tr_b16 v[152:153], v242 offset:61440
    v_mfma_f32_16x16x32_bf16 v[84:87], v[120:123], a[204:207], v[84:87]
    ds_read_b64_tr_b16 v[154:155], v242 offset:63488
    v_mfma_f32_16x16x32_bf16 v[92:95], v[124:127], a[204:207], v[92:95]
    ds_read_b64_tr_b16 v[156:157], v243 offset:61440
    v_mfma_f32_16x16x32_bf16 v[88:91], v[124:127], a[200:203], v[88:91]
    ds_read_b64_tr_b16 v[158:159], v243 offset:63488
    s_waitcnt vmcnt(38) lgkmcnt(8)
    v_mfma_f32_16x16x32_bf16 v[64:67], v[128:131], a[208:211], v[64:67]
    ds_read_b64_tr_b16 v[96:97], v244 offset:32768
    ds_read_b64_tr_b16 v[98:99], v244 offset:34816
    v_mfma_f32_16x16x32_bf16 v[68:71], v[128:131], a[212:215], v[68:71]
    ds_read_b64_tr_b16 v[100:101], v245 offset:32768
    v_mfma_f32_16x16x32_bf16 v[76:79], v[132:135], a[212:215], v[76:79]
    ds_read_b64_tr_b16 v[102:103], v245 offset:34816
    v_mfma_f32_16x16x32_bf16 v[72:75], v[132:135], a[208:211], v[72:75]
    ds_read_b64_tr_b16 v[104:105], v246 offset:32768
    v_mfma_f32_16x16x32_bf16 v[80:83], v[136:139], a[208:211], v[80:83]
    ds_read_b64_tr_b16 v[106:107], v246 offset:34816
    v_mfma_f32_16x16x32_bf16 v[84:87], v[136:139], a[212:215], v[84:87]
    ds_read_b64_tr_b16 v[108:109], v247 offset:32768
    v_mfma_f32_16x16x32_bf16 v[92:95], v[140:143], a[212:215], v[92:95]
    ds_read_b64_tr_b16 v[110:111], v247 offset:34816
    v_mfma_f32_16x16x32_bf16 v[88:91], v[140:143], a[208:211], v[88:91]
    s_waitcnt lgkmcnt(8)
    v_mfma_f32_16x16x32_bf16 v[64:67], v[144:147], a[216:219], v[64:67]
    ds_read_b64_tr_b16 v[112:113], v244 offset:36864
    v_mfma_f32_16x16x32_bf16 v[68:71], v[144:147], a[220:223], v[68:71]
    ds_read_b64_tr_b16 v[114:115], v244 offset:38912
    v_mfma_f32_16x16x32_bf16 v[76:79], v[148:151], a[220:223], v[76:79]
    ds_read_b64_tr_b16 v[116:117], v245 offset:36864
    v_mfma_f32_16x16x32_bf16 v[72:75], v[148:151], a[216:219], v[72:75]
    ds_read_b64_tr_b16 v[118:119], v245 offset:38912
    v_mfma_f32_16x16x32_bf16 v[80:83], v[152:155], a[216:219], v[80:83]
    ds_read_b64_tr_b16 v[120:121], v246 offset:36864
    v_mfma_f32_16x16x32_bf16 v[84:87], v[152:155], a[220:223], v[84:87]
    ds_read_b64_tr_b16 v[122:123], v246 offset:38912
    v_mfma_f32_16x16x32_bf16 v[92:95], v[156:159], a[220:223], v[92:95]
    ds_read_b64_tr_b16 v[124:125], v247 offset:36864
    v_mfma_f32_16x16x32_bf16 v[88:91], v[156:159], a[216:219], v[88:91]
    ds_read_b64_tr_b16 v[126:127], v247 offset:38912
    s_waitcnt vmcnt(30) lgkmcnt(8)
    s_barrier
    v_mfma_f32_16x16x32_bf16 v[64:67], v[96:99], a[224:227], v[64:67]
    ds_read_b64_tr_b16 v[128:129], v244 offset:40960
    ds_read_b64_tr_b16 v[130:131], v244 offset:43008
    v_mfma_f32_16x16x32_bf16 v[68:71], v[96:99], a[228:231], v[68:71]
    ds_read_b64_tr_b16 v[132:133], v245 offset:40960
    v_mfma_f32_16x16x32_bf16 v[76:79], v[100:103], a[228:231], v[76:79]
    ds_read_b64_tr_b16 v[134:135], v245 offset:43008
    v_mfma_f32_16x16x32_bf16 v[72:75], v[100:103], a[224:227], v[72:75]
    ds_read_b64_tr_b16 v[136:137], v246 offset:40960
    v_mfma_f32_16x16x32_bf16 v[80:83], v[104:107], a[224:227], v[80:83]
    ds_read_b64_tr_b16 v[138:139], v246 offset:43008
    v_mfma_f32_16x16x32_bf16 v[84:87], v[104:107], a[228:231], v[84:87]
    ds_read_b64_tr_b16 v[140:141], v247 offset:40960
    v_mfma_f32_16x16x32_bf16 v[92:95], v[108:111], a[228:231], v[92:95]
    ds_read_b64_tr_b16 v[142:143], v247 offset:43008
    v_mfma_f32_16x16x32_bf16 v[88:91], v[108:111], a[224:227], v[88:91]
    s_waitcnt lgkmcnt(8)
    v_mfma_f32_16x16x32_bf16 v[64:67], v[112:115], a[232:235], v[64:67]
    ds_read_b64_tr_b16 v[144:145], v244 offset:45056
    v_mfma_f32_16x16x32_bf16 v[68:71], v[112:115], a[236:239], v[68:71]
    ds_read_b64_tr_b16 v[146:147], v244 offset:47104
    v_mfma_f32_16x16x32_bf16 v[76:79], v[116:119], a[236:239], v[76:79]
    ds_read_b64_tr_b16 v[148:149], v245 offset:45056
    v_mfma_f32_16x16x32_bf16 v[72:75], v[116:119], a[232:235], v[72:75]
    ds_read_b64_tr_b16 v[150:151], v245 offset:47104
    v_mfma_f32_16x16x32_bf16 v[80:83], v[120:123], a[232:235], v[80:83]
    ds_read_b64_tr_b16 v[152:153], v246 offset:45056
    v_mfma_f32_16x16x32_bf16 v[84:87], v[120:123], a[236:239], v[84:87]
    ds_read_b64_tr_b16 v[154:155], v246 offset:47104
    v_mfma_f32_16x16x32_bf16 v[92:95], v[124:127], a[236:239], v[92:95]
    ds_read_b64_tr_b16 v[156:157], v247 offset:45056
    v_mfma_f32_16x16x32_bf16 v[88:91], v[124:127], a[232:235], v[88:91]
    ds_read_b64_tr_b16 v[158:159], v247 offset:47104
    s_waitcnt vmcnt(26) lgkmcnt(8)
    v_mfma_f32_16x16x32_bf16 v[64:67], v[128:131], a[240:243], v[64:67]
    ds_read_b64_tr_b16 v[96:97], v244 offset:49152
    ds_read_b64_tr_b16 v[98:99], v244 offset:51200
    v_mfma_f32_16x16x32_bf16 v[68:71], v[128:131], a[244:247], v[68:71]
    ds_read_b64_tr_b16 v[100:101], v245 offset:49152
    v_mfma_f32_16x16x32_bf16 v[76:79], v[132:135], a[244:247], v[76:79]
    ds_read_b64_tr_b16 v[102:103], v245 offset:51200
    v_mfma_f32_16x16x32_bf16 v[72:75], v[132:135], a[240:243], v[72:75]
    ds_read_b64_tr_b16 v[104:105], v246 offset:49152
    v_mfma_f32_16x16x32_bf16 v[80:83], v[136:139], a[240:243], v[80:83]
    ds_read_b64_tr_b16 v[106:107], v246 offset:51200
    v_mfma_f32_16x16x32_bf16 v[84:87], v[136:139], a[244:247], v[84:87]
    ds_read_b64_tr_b16 v[108:109], v247 offset:49152
    v_mfma_f32_16x16x32_bf16 v[92:95], v[140:143], a[244:247], v[92:95]
    ds_read_b64_tr_b16 v[110:111], v247 offset:51200
    v_mfma_f32_16x16x32_bf16 v[88:91], v[140:143], a[240:243], v[88:91]
    s_waitcnt lgkmcnt(8)
    v_mfma_f32_16x16x32_bf16 v[64:67], v[144:147], a[248:251], v[64:67]
    ds_read_b64_tr_b16 v[112:113], v244 offset:53248
    v_mfma_f32_16x16x32_bf16 v[68:71], v[144:147], a[252:255], v[68:71]
    ds_read_b64_tr_b16 v[114:115], v244 offset:55296
    v_mfma_f32_16x16x32_bf16 v[76:79], v[148:151], a[252:255], v[76:79]
    ds_read_b64_tr_b16 v[116:117], v245 offset:53248
    v_mfma_f32_16x16x32_bf16 v[72:75], v[148:151], a[248:251], v[72:75]
    ds_read_b64_tr_b16 v[118:119], v245 offset:55296
    v_mfma_f32_16x16x32_bf16 v[80:83], v[152:155], a[248:251], v[80:83]
    ds_read_b64_tr_b16 v[120:121], v246 offset:53248
    v_mfma_f32_16x16x32_bf16 v[84:87], v[152:155], a[252:255], v[84:87]
    ds_read_b64_tr_b16 v[122:123], v246 offset:55296
    v_mfma_f32_16x16x32_bf16 v[92:95], v[156:159], a[252:255], v[92:95]
    ds_read_b64_tr_b16 v[124:125], v247 offset:53248
    v_mfma_f32_16x16x32_bf16 v[88:91], v[156:159], a[248:251], v[88:91]
    ds_read_b64_tr_b16 v[126:127], v247 offset:55296
    s_waitcnt vmcnt(22) lgkmcnt(8)
    s_barrier
    v_mfma_f32_16x16x32_bf16 v[32:35], v[96:99], a[32:35], v[32:35]
    ds_read_b64_tr_b16 v[128:129], v244 offset:57344
    ds_read_b64_tr_b16 v[130:131], v244 offset:59392
    v_mfma_f32_16x16x32_bf16 v[36:39], v[96:99], a[36:39], v[36:39]
    ds_read_b64_tr_b16 v[132:133], v245 offset:57344
    buffer_store_dwordx4 v[64:67], v1, s[28:31], s97 offen offset:0 sc1
    v_mfma_f32_16x16x32_bf16 v[44:47], v[100:103], a[36:39], v[44:47]
    ds_read_b64_tr_b16 v[134:135], v245 offset:59392
    v_mfma_f32_16x16x32_bf16 v[40:43], v[100:103], a[32:35], v[40:43]
    ds_read_b64_tr_b16 v[136:137], v246 offset:57344
    buffer_store_dwordx4 v[68:71], v1, s[28:31], s97 offen offset:1024 sc1
    v_mfma_f32_16x16x32_bf16 v[48:51], v[104:107], a[32:35], v[48:51]
    ds_read_b64_tr_b16 v[138:139], v246 offset:59392
    v_mfma_f32_16x16x32_bf16 v[52:55], v[104:107], a[36:39], v[52:55]
    ds_read_b64_tr_b16 v[140:141], v247 offset:57344
    buffer_store_dwordx4 v[72:75], v1, s[28:31], s97 offen offset:2048 sc1
    v_mfma_f32_16x16x32_bf16 v[60:63], v[108:111], a[36:39], v[60:63]
    ds_read_b64_tr_b16 v[142:143], v247 offset:59392
    v_mfma_f32_16x16x32_bf16 v[56:59], v[108:111], a[32:35], v[56:59]
    s_waitcnt lgkmcnt(8)
    buffer_store_dwordx4 v[76:79], v1, s[28:31], s97 offen offset:3072 sc1
    v_mfma_f32_16x16x32_bf16 v[32:35], v[112:115], a[40:43], v[32:35]
    ds_read_b64_tr_b16 v[144:145], v244 offset:61440
    buffer_store_dwordx4 v[80:83], v1, s[28:31], s99 offen offset:0 sc1
    v_mfma_f32_16x16x32_bf16 v[36:39], v[112:115], a[44:47], v[36:39]
    ds_read_b64_tr_b16 v[146:147], v244 offset:63488
    v_mfma_f32_16x16x32_bf16 v[44:47], v[116:119], a[44:47], v[44:47]
    ds_read_b64_tr_b16 v[148:149], v245 offset:61440
    buffer_store_dwordx4 v[84:87], v1, s[28:31], s99 offen offset:1024 sc1
    v_mfma_f32_16x16x32_bf16 v[40:43], v[116:119], a[40:43], v[40:43]
    ds_read_b64_tr_b16 v[150:151], v245 offset:63488
    v_mfma_f32_16x16x32_bf16 v[48:51], v[120:123], a[40:43], v[48:51]
    ds_read_b64_tr_b16 v[152:153], v246 offset:61440
    buffer_store_dwordx4 v[88:91], v1, s[28:31], s99 offen offset:2048 sc1
    v_mfma_f32_16x16x32_bf16 v[52:55], v[120:123], a[44:47], v[52:55]
    ds_read_b64_tr_b16 v[154:155], v246 offset:63488
    v_mfma_f32_16x16x32_bf16 v[60:63], v[124:127], a[44:47], v[60:63]
    ds_read_b64_tr_b16 v[156:157], v247 offset:61440
    buffer_store_dwordx4 v[92:95], v1, s[28:31], s99 offen offset:3072 sc1
    v_mfma_f32_16x16x32_bf16 v[56:59], v[124:127], a[40:43], v[56:59]
    ds_read_b64_tr_b16 v[158:159], v247 offset:63488
    s_waitcnt vmcnt(63) lgkmcnt(8)
    v_mfma_f32_16x16x32_bf16 v[32:35], v[128:131], a[48:51], v[32:35]
    ds_read_b64_tr_b16 v[96:97], v248 offset:0
    ds_read_b64_tr_b16 v[98:99], v248 offset:2048
    v_mfma_f32_16x16x32_bf16 v[36:39], v[128:131], a[52:55], v[36:39]
    ds_read_b64_tr_b16 v[100:101], v249 offset:0
    v_mfma_f32_16x16x32_bf16 v[44:47], v[132:135], a[52:55], v[44:47]
    ds_read_b64_tr_b16 v[102:103], v249 offset:2048
    v_mfma_f32_16x16x32_bf16 v[40:43], v[132:135], a[48:51], v[40:43]
    ds_read_b64_tr_b16 v[104:105], v250 offset:0
    v_mfma_f32_16x16x32_bf16 v[48:51], v[136:139], a[48:51], v[48:51]
    ds_read_b64_tr_b16 v[106:107], v250 offset:2048
    v_mfma_f32_16x16x32_bf16 v[52:55], v[136:139], a[52:55], v[52:55]
    ds_read_b64_tr_b16 v[108:109], v251 offset:0
    v_mfma_f32_16x16x32_bf16 v[60:63], v[140:143], a[52:55], v[60:63]
    ds_read_b64_tr_b16 v[110:111], v251 offset:2048
    v_mfma_f32_16x16x32_bf16 v[56:59], v[140:143], a[48:51], v[56:59]
    s_waitcnt lgkmcnt(8)
    v_mfma_f32_16x16x32_bf16 v[32:35], v[144:147], a[56:59], v[32:35]
    ds_read_b64_tr_b16 v[112:113], v248 offset:4096
    v_mfma_f32_16x16x32_bf16 v[36:39], v[144:147], a[60:63], v[36:39]
    ds_read_b64_tr_b16 v[114:115], v248 offset:6144
    v_mfma_f32_16x16x32_bf16 v[44:47], v[148:151], a[60:63], v[44:47]
    ds_read_b64_tr_b16 v[116:117], v249 offset:4096
    v_mfma_f32_16x16x32_bf16 v[40:43], v[148:151], a[56:59], v[40:43]
    ds_read_b64_tr_b16 v[118:119], v249 offset:6144
    v_mfma_f32_16x16x32_bf16 v[48:51], v[152:155], a[56:59], v[48:51]
    ds_read_b64_tr_b16 v[120:121], v250 offset:4096
    v_mfma_f32_16x16x32_bf16 v[52:55], v[152:155], a[60:63], v[52:55]
    ds_read_b64_tr_b16 v[122:123], v250 offset:6144
    v_mfma_f32_16x16x32_bf16 v[60:63], v[156:159], a[60:63], v[60:63]
    ds_read_b64_tr_b16 v[124:125], v251 offset:4096
    v_mfma_f32_16x16x32_bf16 v[56:59], v[156:159], a[56:59], v[56:59]
    ds_read_b64_tr_b16 v[126:127], v251 offset:6144
    s_waitcnt vmcnt(26) lgkmcnt(8)
    s_barrier
    v_mfma_f32_16x16x32_bf16 v[32:35], v[96:99], a[64:67], v[32:35]
    ds_read_b64_tr_b16 v[128:129], v248 offset:8192
    ds_read_b64_tr_b16 v[130:131], v248 offset:10240
    v_mfma_f32_16x16x32_bf16 v[36:39], v[96:99], a[68:71], v[36:39]
    ds_read_b64_tr_b16 v[132:133], v249 offset:8192
    v_mfma_f32_16x16x32_bf16 v[44:47], v[100:103], a[68:71], v[44:47]
    ds_read_b64_tr_b16 v[134:135], v249 offset:10240
    v_mfma_f32_16x16x32_bf16 v[40:43], v[100:103], a[64:67], v[40:43]
    ds_read_b64_tr_b16 v[136:137], v250 offset:8192
    v_mfma_f32_16x16x32_bf16 v[48:51], v[104:107], a[64:67], v[48:51]
    ds_read_b64_tr_b16 v[138:139], v250 offset:10240
    v_mfma_f32_16x16x32_bf16 v[52:55], v[104:107], a[68:71], v[52:55]
    ds_read_b64_tr_b16 v[140:141], v251 offset:8192
    v_mfma_f32_16x16x32_bf16 v[60:63], v[108:111], a[68:71], v[60:63]
    ds_read_b64_tr_b16 v[142:143], v251 offset:10240
    v_mfma_f32_16x16x32_bf16 v[56:59], v[108:111], a[64:67], v[56:59]
    s_waitcnt lgkmcnt(8)
    v_mfma_f32_16x16x32_bf16 v[32:35], v[112:115], a[72:75], v[32:35]
    ds_read_b64_tr_b16 v[144:145], v248 offset:12288
    v_mfma_f32_16x16x32_bf16 v[36:39], v[112:115], a[76:79], v[36:39]
    ds_read_b64_tr_b16 v[146:147], v248 offset:14336
    v_mfma_f32_16x16x32_bf16 v[44:47], v[116:119], a[76:79], v[44:47]
    ds_read_b64_tr_b16 v[148:149], v249 offset:12288
    v_mfma_f32_16x16x32_bf16 v[40:43], v[116:119], a[72:75], v[40:43]
    ds_read_b64_tr_b16 v[150:151], v249 offset:14336
    v_mfma_f32_16x16x32_bf16 v[48:51], v[120:123], a[72:75], v[48:51]
    ds_read_b64_tr_b16 v[152:153], v250 offset:12288
    v_mfma_f32_16x16x32_bf16 v[52:55], v[120:123], a[76:79], v[52:55]
    ds_read_b64_tr_b16 v[154:155], v250 offset:14336
    v_mfma_f32_16x16x32_bf16 v[60:63], v[124:127], a[76:79], v[60:63]
    ds_read_b64_tr_b16 v[156:157], v251 offset:12288
    v_mfma_f32_16x16x32_bf16 v[56:59], v[124:127], a[72:75], v[56:59]
    ds_read_b64_tr_b16 v[158:159], v251 offset:14336
    s_waitcnt vmcnt(63) lgkmcnt(8)
    v_mfma_f32_16x16x32_bf16 v[32:35], v[128:131], a[80:83], v[32:35]
    ds_read_b64_tr_b16 v[96:97], v248 offset:16384
    ds_read_b64_tr_b16 v[98:99], v248 offset:18432
    v_mfma_f32_16x16x32_bf16 v[36:39], v[128:131], a[84:87], v[36:39]
    ds_read_b64_tr_b16 v[100:101], v249 offset:16384
    v_mfma_f32_16x16x32_bf16 v[44:47], v[132:135], a[84:87], v[44:47]
    ds_read_b64_tr_b16 v[102:103], v249 offset:18432
    v_mfma_f32_16x16x32_bf16 v[40:43], v[132:135], a[80:83], v[40:43]
    ds_read_b64_tr_b16 v[104:105], v250 offset:16384
    v_mfma_f32_16x16x32_bf16 v[48:51], v[136:139], a[80:83], v[48:51]
    ds_read_b64_tr_b16 v[106:107], v250 offset:18432
    v_mfma_f32_16x16x32_bf16 v[52:55], v[136:139], a[84:87], v[52:55]
    ds_read_b64_tr_b16 v[108:109], v251 offset:16384
    v_mfma_f32_16x16x32_bf16 v[60:63], v[140:143], a[84:87], v[60:63]
    ds_read_b64_tr_b16 v[110:111], v251 offset:18432
    v_mfma_f32_16x16x32_bf16 v[56:59], v[140:143], a[80:83], v[56:59]
    s_waitcnt lgkmcnt(8)
    v_mfma_f32_16x16x32_bf16 v[32:35], v[144:147], a[88:91], v[32:35]
    ds_read_b64_tr_b16 v[112:113], v248 offset:20480
    v_mfma_f32_16x16x32_bf16 v[36:39], v[144:147], a[92:95], v[36:39]
    ds_read_b64_tr_b16 v[114:115], v248 offset:22528
    v_mfma_f32_16x16x32_bf16 v[44:47], v[148:151], a[92:95], v[44:47]
    ds_read_b64_tr_b16 v[116:117], v249 offset:20480
    v_mfma_f32_16x16x32_bf16 v[40:43], v[148:151], a[88:91], v[40:43]
    ds_read_b64_tr_b16 v[118:119], v249 offset:22528
    v_mfma_f32_16x16x32_bf16 v[48:51], v[152:155], a[88:91], v[48:51]
    ds_read_b64_tr_b16 v[120:121], v250 offset:20480
    v_mfma_f32_16x16x32_bf16 v[52:55], v[152:155], a[92:95], v[52:55]
    ds_read_b64_tr_b16 v[122:123], v250 offset:22528
    v_mfma_f32_16x16x32_bf16 v[60:63], v[156:159], a[92:95], v[60:63]
    ds_read_b64_tr_b16 v[124:125], v251 offset:20480
    v_mfma_f32_16x16x32_bf16 v[56:59], v[156:159], a[88:91], v[56:59]
    ds_read_b64_tr_b16 v[126:127], v251 offset:22528
    s_waitcnt vmcnt(22) lgkmcnt(8)
    s_barrier
    v_mfma_f32_16x16x32_bf16 v[32:35], v[96:99], a[96:99], v[32:35]
    ds_read_b64_tr_b16 v[128:129], v248 offset:24576
    ds_read_b64_tr_b16 v[130:131], v248 offset:26624
    v_mfma_f32_16x16x32_bf16 v[36:39], v[96:99], a[100:103], v[36:39]
    ds_read_b64_tr_b16 v[132:133], v249 offset:24576
    v_mfma_f32_16x16x32_bf16 v[44:47], v[100:103], a[100:103], v[44:47]
    ds_read_b64_tr_b16 v[134:135], v249 offset:26624
    v_mfma_f32_16x16x32_bf16 v[40:43], v[100:103], a[96:99], v[40:43]
    ds_read_b64_tr_b16 v[136:137], v250 offset:24576
    v_mfma_f32_16x16x32_bf16 v[48:51], v[104:107], a[96:99], v[48:51]
    ds_read_b64_tr_b16 v[138:139], v250 offset:26624
    v_mfma_f32_16x16x32_bf16 v[52:55], v[104:107], a[100:103], v[52:55]
    ds_read_b64_tr_b16 v[140:141], v251 offset:24576
    v_mfma_f32_16x16x32_bf16 v[60:63], v[108:111], a[100:103], v[60:63]
    ds_read_b64_tr_b16 v[142:143], v251 offset:26624
    v_mfma_f32_16x16x32_bf16 v[56:59], v[108:111], a[96:99], v[56:59]
    s_waitcnt lgkmcnt(8)
    v_mfma_f32_16x16x32_bf16 v[32:35], v[112:115], a[104:107], v[32:35]
    ds_read_b64_tr_b16 v[144:145], v248 offset:28672
    v_mfma_f32_16x16x32_bf16 v[36:39], v[112:115], a[108:111], v[36:39]
    ds_read_b64_tr_b16 v[146:147], v248 offset:30720
    v_mfma_f32_16x16x32_bf16 v[44:47], v[116:119], a[108:111], v[44:47]
    ds_read_b64_tr_b16 v[148:149], v249 offset:28672
    v_mfma_f32_16x16x32_bf16 v[40:43], v[116:119], a[104:107], v[40:43]
    ds_read_b64_tr_b16 v[150:151], v249 offset:30720
    v_mfma_f32_16x16x32_bf16 v[48:51], v[120:123], a[104:107], v[48:51]
    ds_read_b64_tr_b16 v[152:153], v250 offset:28672
    v_mfma_f32_16x16x32_bf16 v[52:55], v[120:123], a[108:111], v[52:55]
    ds_read_b64_tr_b16 v[154:155], v250 offset:30720
    v_mfma_f32_16x16x32_bf16 v[60:63], v[124:127], a[108:111], v[60:63]
    ds_read_b64_tr_b16 v[156:157], v251 offset:28672
    v_mfma_f32_16x16x32_bf16 v[56:59], v[124:127], a[104:107], v[56:59]
    ds_read_b64_tr_b16 v[158:159], v251 offset:30720
    s_waitcnt vmcnt(0) lgkmcnt(8)
    s_mov_b64 exec, 1
    buffer_store_dword v9, v3, s[28:31], s82 offen sc1
    s_mov_b64 exec, -1
    v_mfma_f32_16x16x32_bf16 v[32:35], v[128:131], a[112:115], v[32:35]
    ds_read_b64_tr_b16 v[96:97], v244 offset:0
    ds_read_b64_tr_b16 v[98:99], v244 offset:2048
    v_mfma_f32_16x16x32_bf16 v[36:39], v[128:131], a[116:119], v[36:39]
    ds_read_b64_tr_b16 v[100:101], v245 offset:0
    v_mfma_f32_16x16x32_bf16 v[44:47], v[132:135], a[116:119], v[44:47]
    ds_read_b64_tr_b16 v[102:103], v245 offset:2048
    v_mfma_f32_16x16x32_bf16 v[40:43], v[132:135], a[112:115], v[40:43]
    ds_read_b64_tr_b16 v[104:105], v246 offset:0
    v_mfma_f32_16x16x32_bf16 v[48:51], v[136:139], a[112:115], v[48:51]
    ds_read_b64_tr_b16 v[106:107], v246 offset:2048
    v_mfma_f32_16x16x32_bf16 v[52:55], v[136:139], a[116:119], v[52:55]
    ds_read_b64_tr_b16 v[108:109], v247 offset:0
    v_mfma_f32_16x16x32_bf16 v[60:63], v[140:143], a[116:119], v[60:63]
    ds_read_b64_tr_b16 v[110:111], v247 offset:2048
    v_mfma_f32_16x16x32_bf16 v[56:59], v[140:143], a[112:115], v[56:59]
    s_waitcnt lgkmcnt(8)
    v_mfma_f32_16x16x32_bf16 v[32:35], v[144:147], a[120:123], v[32:35]
    ds_read_b64_tr_b16 v[112:113], v244 offset:4096
    v_mfma_f32_16x16x32_bf16 v[36:39], v[144:147], a[124:127], v[36:39]
    ds_read_b64_tr_b16 v[114:115], v244 offset:6144
    v_mfma_f32_16x16x32_bf16 v[44:47], v[148:151], a[124:127], v[44:47]
    ds_read_b64_tr_b16 v[116:117], v245 offset:4096
    v_mfma_f32_16x16x32_bf16 v[40:43], v[148:151], a[120:123], v[40:43]
    ds_read_b64_tr_b16 v[118:119], v245 offset:6144
    v_mfma_f32_16x16x32_bf16 v[48:51], v[152:155], a[120:123], v[48:51]
    ds_read_b64_tr_b16 v[120:121], v246 offset:4096
    v_mfma_f32_16x16x32_bf16 v[52:55], v[152:155], a[124:127], v[52:55]
    ds_read_b64_tr_b16 v[122:123], v246 offset:6144
    v_mfma_f32_16x16x32_bf16 v[60:63], v[156:159], a[124:127], v[60:63]
    ds_read_b64_tr_b16 v[124:125], v247 offset:4096
    v_mfma_f32_16x16x32_bf16 v[56:59], v[156:159], a[120:123], v[56:59]
    ds_read_b64_tr_b16 v[126:127], v247 offset:6144
    s_waitcnt vmcnt(19) lgkmcnt(8)
    s_barrier
    v_mfma_f32_16x16x32_bf16 v[32:35], v[96:99], a[128:131], v[32:35]
    ds_read_b64_tr_b16 v[128:129], v244 offset:8192
    ds_read_b64_tr_b16 v[130:131], v244 offset:10240
    v_mfma_f32_16x16x32_bf16 v[36:39], v[96:99], a[132:135], v[36:39]
    ds_read_b64_tr_b16 v[132:133], v245 offset:8192
    v_mfma_f32_16x16x32_bf16 v[44:47], v[100:103], a[132:135], v[44:47]
    ds_read_b64_tr_b16 v[134:135], v245 offset:10240
    v_mfma_f32_16x16x32_bf16 v[40:43], v[100:103], a[128:131], v[40:43]
    ds_read_b64_tr_b16 v[136:137], v246 offset:8192
    v_mfma_f32_16x16x32_bf16 v[48:51], v[104:107], a[128:131], v[48:51]
    ds_read_b64_tr_b16 v[138:139], v246 offset:10240
    v_mfma_f32_16x16x32_bf16 v[52:55], v[104:107], a[132:135], v[52:55]
    ds_read_b64_tr_b16 v[140:141], v247 offset:8192
    v_mfma_f32_16x16x32_bf16 v[60:63], v[108:111], a[132:135], v[60:63]
    ds_read_b64_tr_b16 v[142:143], v247 offset:10240
    v_mfma_f32_16x16x32_bf16 v[56:59], v[108:111], a[128:131], v[56:59]
    s_waitcnt lgkmcnt(8)
    v_mfma_f32_16x16x32_bf16 v[32:35], v[112:115], a[136:139], v[32:35]
    ds_read_b64_tr_b16 v[144:145], v244 offset:12288
    v_mfma_f32_16x16x32_bf16 v[36:39], v[112:115], a[140:143], v[36:39]
    ds_read_b64_tr_b16 v[146:147], v244 offset:14336
    v_mfma_f32_16x16x32_bf16 v[44:47], v[116:119], a[140:143], v[44:47]
    ds_read_b64_tr_b16 v[148:149], v245 offset:12288
    v_mfma_f32_16x16x32_bf16 v[40:43], v[116:119], a[136:139], v[40:43]
    ds_read_b64_tr_b16 v[150:151], v245 offset:14336
    v_mfma_f32_16x16x32_bf16 v[48:51], v[120:123], a[136:139], v[48:51]
    ds_read_b64_tr_b16 v[152:153], v246 offset:12288
    v_mfma_f32_16x16x32_bf16 v[52:55], v[120:123], a[140:143], v[52:55]
    ds_read_b64_tr_b16 v[154:155], v246 offset:14336
    v_mfma_f32_16x16x32_bf16 v[60:63], v[124:127], a[140:143], v[60:63]
    ds_read_b64_tr_b16 v[156:157], v247 offset:12288
    v_mfma_f32_16x16x32_bf16 v[56:59], v[124:127], a[136:139], v[56:59]
    ds_read_b64_tr_b16 v[158:159], v247 offset:14336
    s_waitcnt vmcnt(63) lgkmcnt(8)
    v_mfma_f32_16x16x32_bf16 v[32:35], v[128:131], a[144:147], v[32:35]
    ds_read_b64_tr_b16 v[96:97], v244 offset:16384
    ds_read_b64_tr_b16 v[98:99], v244 offset:18432
    v_mfma_f32_16x16x32_bf16 v[36:39], v[128:131], a[148:151], v[36:39]
    ds_read_b64_tr_b16 v[100:101], v245 offset:16384
    v_mfma_f32_16x16x32_bf16 v[44:47], v[132:135], a[148:151], v[44:47]
    ds_read_b64_tr_b16 v[102:103], v245 offset:18432
    v_mfma_f32_16x16x32_bf16 v[40:43], v[132:135], a[144:147], v[40:43]
    ds_read_b64_tr_b16 v[104:105], v246 offset:16384
    v_mfma_f32_16x16x32_bf16 v[48:51], v[136:139], a[144:147], v[48:51]
    ds_read_b64_tr_b16 v[106:107], v246 offset:18432
    v_mfma_f32_16x16x32_bf16 v[52:55], v[136:139], a[148:151], v[52:55]
    ds_read_b64_tr_b16 v[108:109], v247 offset:16384
    v_mfma_f32_16x16x32_bf16 v[60:63], v[140:143], a[148:151], v[60:63]
    ds_read_b64_tr_b16 v[110:111], v247 offset:18432
    v_mfma_f32_16x16x32_bf16 v[56:59], v[140:143], a[144:147], v[56:59]
    s_waitcnt lgkmcnt(8)
    buffer_load_dword v5, v3, s[28:31], s34 offen sc1
    v_mfma_f32_16x16x32_bf16 v[32:35], v[144:147], a[152:155], v[32:35]
    ds_read_b64_tr_b16 v[112:113], v244 offset:20480
    v_mfma_f32_16x16x32_bf16 v[36:39], v[144:147], a[156:159], v[36:39]
    ds_read_b64_tr_b16 v[114:115], v244 offset:22528
    v_mfma_f32_16x16x32_bf16 v[44:47], v[148:151], a[156:159], v[44:47]
    ds_read_b64_tr_b16 v[116:117], v245 offset:20480
    v_mfma_f32_16x16x32_bf16 v[40:43], v[148:151], a[152:155], v[40:43]
    ds_read_b64_tr_b16 v[118:119], v245 offset:22528
    v_mfma_f32_16x16x32_bf16 v[48:51], v[152:155], a[152:155], v[48:51]
    ds_read_b64_tr_b16 v[120:121], v246 offset:20480
    v_mfma_f32_16x16x32_bf16 v[52:55], v[152:155], a[156:159], v[52:55]
    ds_read_b64_tr_b16 v[122:123], v246 offset:22528
    v_mfma_f32_16x16x32_bf16 v[60:63], v[156:159], a[156:159], v[60:63]
    ds_read_b64_tr_b16 v[124:125], v247 offset:20480
    v_mfma_f32_16x16x32_bf16 v[56:59], v[156:159], a[152:155], v[56:59]
    ds_read_b64_tr_b16 v[126:127], v247 offset:22528
    s_waitcnt vmcnt(16) lgkmcnt(8)
    s_barrier
    v_mfma_f32_16x16x32_bf16 v[32:35], v[96:99], a[160:163], v[32:35]
    ds_read_b64_tr_b16 v[128:129], v244 offset:24576
    ds_read_b64_tr_b16 v[130:131], v244 offset:26624
    v_mfma_f32_16x16x32_bf16 v[36:39], v[96:99], a[164:167], v[36:39]
    ds_read_b64_tr_b16 v[132:133], v245 offset:24576
    v_mfma_f32_16x16x32_bf16 v[44:47], v[100:103], a[164:167], v[44:47]
    ds_read_b64_tr_b16 v[134:135], v245 offset:26624
    v_mfma_f32_16x16x32_bf16 v[40:43], v[100:103], a[160:163], v[40:43]
    ds_read_b64_tr_b16 v[136:137], v246 offset:24576
    v_mfma_f32_16x16x32_bf16 v[48:51], v[104:107], a[160:163], v[48:51]
    ds_read_b64_tr_b16 v[138:139], v246 offset:26624
    v_mfma_f32_16x16x32_bf16 v[52:55], v[104:107], a[164:167], v[52:55]
    ds_read_b64_tr_b16 v[140:141], v247 offset:24576
    v_mfma_f32_16x16x32_bf16 v[60:63], v[108:111], a[164:167], v[60:63]
    ds_read_b64_tr_b16 v[142:143], v247 offset:26624
    v_mfma_f32_16x16x32_bf16 v[56:59], v[108:111], a[160:163], v[56:59]
    s_waitcnt lgkmcnt(8)
    v_mfma_f32_16x16x32_bf16 v[32:35], v[112:115], a[168:171], v[32:35]
    ds_read_b64_tr_b16 v[144:145], v244 offset:28672
    v_mfma_f32_16x16x32_bf16 v[36:39], v[112:115], a[172:175], v[36:39]
    ds_read_b64_tr_b16 v[146:147], v244 offset:30720
    v_mfma_f32_16x16x32_bf16 v[44:47], v[116:119], a[172:175], v[44:47]
    ds_read_b64_tr_b16 v[148:149], v245 offset:28672
    v_mfma_f32_16x16x32_bf16 v[40:43], v[116:119], a[168:171], v[40:43]
    ds_read_b64_tr_b16 v[150:151], v245 offset:30720
    v_mfma_f32_16x16x32_bf16 v[48:51], v[120:123], a[168:171], v[48:51]
    ds_read_b64_tr_b16 v[152:153], v246 offset:28672
    v_mfma_f32_16x16x32_bf16 v[52:55], v[120:123], a[172:175], v[52:55]
    ds_read_b64_tr_b16 v[154:155], v246 offset:30720
    v_mfma_f32_16x16x32_bf16 v[60:63], v[124:127], a[172:175], v[60:63]
    ds_read_b64_tr_b16 v[156:157], v247 offset:28672
    v_mfma_f32_16x16x32_bf16 v[56:59], v[124:127], a[168:171], v[56:59]
    ds_read_b64_tr_b16 v[158:159], v247 offset:30720
    s_waitcnt vmcnt(60) lgkmcnt(8)
    v_mfma_f32_16x16x32_bf16 v[32:35], v[128:131], a[176:179], v[32:35]
    ds_read_b64_tr_b16 v[96:97], v240 offset:0
    ds_read_b64_tr_b16 v[98:99], v240 offset:2048
    v_mfma_f32_16x16x32_bf16 v[36:39], v[128:131], a[180:183], v[36:39]
    ds_read_b64_tr_b16 v[100:101], v241 offset:0
    v_mfma_f32_16x16x32_bf16 v[44:47], v[132:135], a[180:183], v[44:47]
    ds_read_b64_tr_b16 v[102:103], v241 offset:2048
    v_mfma_f32_16x16x32_bf16 v[40:43], v[132:135], a[176:179], v[40:43]
    ds_read_b64_tr_b16 v[104:105], v242 offset:0
    v_mfma_f32_16x16x32_bf16 v[48:51], v[136:139], a[176:179], v[48:51]
    ds_read_b64_tr_b16 v[106:107], v242 offset:2048
    v_mfma_f32_16x16x32_bf16 v[52:55], v[136:139], a[180:183], v[52:55]
    ds_read_b64_tr_b16 v[108:109], v243 offset:0
    v_mfma_f32_16x16x32_bf16 v[60:63], v[140:143], a[180:183], v[60:63]
    ds_read_b64_tr_b16 v[110:111], v243 offset:2048
    v_mfma_f32_16x16x32_bf16 v[56:59], v[140:143], a[176:179], v[56:59]
    s_waitcnt lgkmcnt(8)
    v_mfma_f32_16x16x32_bf16 v[32:35], v[144:147], a[184:187], v[32:35]
    ds_read_b64_tr_b16 v[112:113], v240 offset:4096
    v_mfma_f32_16x16x32_bf16 v[36:39], v[144:147], a[188:191], v[36:39]
    ds_read_b64_tr_b16 v[114:115], v240 offset:6144
    v_mfma_f32_16x16x32_bf16 v[44:47], v[148:151], a[188:191], v[44:47]
    ds_read_b64_tr_b16 v[116:117], v241 offset:4096
    v_mfma_f32_16x16x32_bf16 v[40:43], v[148:151], a[184:187], v[40:43]
    ds_read_b64_tr_b16 v[118:119], v241 offset:6144
    v_mfma_f32_16x16x32_bf16 v[48:51], v[152:155], a[184:187], v[48:51]
    ds_read_b64_tr_b16 v[120:121], v242 offset:4096
    v_mfma_f32_16x16x32_bf16 v[52:55], v[152:155], a[188:191], v[52:55]
    ds_read_b64_tr_b16 v[122:123], v242 offset:6144
    v_mfma_f32_16x16x32_bf16 v[60:63], v[156:159], a[188:191], v[60:63]
    ds_read_b64_tr_b16 v[124:125], v243 offset:4096
    v_mfma_f32_16x16x32_bf16 v[56:59], v[156:159], a[184:187], v[56:59]
    ds_read_b64_tr_b16 v[126:127], v243 offset:6144
    s_waitcnt vmcnt(0) lgkmcnt(8)
    v_cmp_gt_u32 vcc, 3, v5
    s_cbranch_vccz k_c_ok52
    s_mov_b32 s3, 0x20000
k_cpoll52:
    s_sub_u32 s3, s3, 1
    s_cbranch_scc1 k_c_ok52
    buffer_load_dword v5, v3, s[28:31], s34 offen sc1
    s_waitcnt vmcnt(0)
    v_cmp_gt_u32 vcc, 3, v5
    s_cbranch_vccnz k_cpoll52
k_c_ok52:
    s_barrier
    v_mfma_f32_16x16x32_bf16 v[32:35], v[96:99], a[192:195], v[32:35]
    ds_read_b64_tr_b16 v[128:129], v240 offset:8192
    ds_read_b64_tr_b16 v[130:131], v240 offset:10240
    v_mfma_f32_16x16x32_bf16 v[36:39], v[96:99], a[196:199], v[36:39]
    ds_read_b64_tr_b16 v[132:133], v241 offset:8192
    buffer_load_dwordx4 v[160:163], v1, s[28:31], s98 offen offset:0 sc1
    v_mfma_f32_16x16x32_bf16 v[44:47], v[100:103], a[196:199], v[44:47]
    ds_read_b64_tr_b16 v[134:135], v241 offset:10240
    v_mfma_f32_16x16x32_bf16 v[40:43], v[100:103], a[192:195], v[40:43]
    ds_read_b64_tr_b16 v[136:137], v242 offset:8192
    buffer_load_dwordx4 v[164:167], v1, s[28:31], s98 offen offset:1024 sc1
    v_mfma_f32_16x16x32_bf16 v[48:51], v[104:107], a[192:195], v[48:51]
    ds_read_b64_tr_b16 v[138:139], v242 offset:10240
    v_mfma_f32_16x16x32_bf16 v[52:55], v[104:107], a[196:199], v[52:55]
    ds_read_b64_tr_b16 v[140:141], v243 offset:8192
    buffer_load_dwordx4 v[168:171], v1, s[28:31], s98 offen offset:2048 sc1
    v_mfma_f32_16x16x32_bf16 v[60:63], v[108:111], a[196:199], v[60:63]
    ds_read_b64_tr_b16 v[142:143], v243 offset:10240
    v_mfma_f32_16x16x32_bf16 v[56:59], v[108:111], a[192:195], v[56:59]
    s_waitcnt lgkmcnt(8)
    buffer_load_dwordx4 v[172:175], v1, s[28:31], s98 offen offset:3072 sc1
    v_mfma_f32_16x16x32_bf16 v[32:35], v[112:115], a[200:203], v[32:35]
    ds_read_b64_tr_b16 v[144:145], v240 offset:12288
    buffer_load_dwordx4 v[176:179], v1, s[28:31], s100 offen offset:0 sc1
    v_mfma_f32_16x16x32_bf16 v[36:39], v[112:115], a[204:207], v[36:39]
    ds_read_b64_tr_b16 v[146:147], v240 offset:14336
    v_mfma_f32_16x16x32_bf16 v[44:47], v[116:119], a[204:207], v[44:47]
    ds_read_b64_tr_b16 v[148:149], v241 offset:12288
    buffer_load_dwordx4 v[180:183], v1, s[28:31], s100 offen offset:1024 sc1
    v_mfma_f32_16x16x32_bf16 v[40:43], v[116:119], a[200:203], v[40:43]
    ds_read_b64_tr_b16 v[150:151], v241 offset:14336
    v_mfma_f32_16x16x32_bf16 v[48:51], v[120:123], a[200:203], v[48:51]
    ds_read_b64_tr_b16 v[152:153], v242 offset:12288
    buffer_load_dwordx4 v[184:187], v1, s[28:31], s100 offen offset:2048 sc1
    v_mfma_f32_16x16x32_bf16 v[52:55], v[120:123], a[204:207], v[52:55]
    ds_read_b64_tr_b16 v[154:155], v242 offset:14336
    v_mfma_f32_16x16x32_bf16 v[60:63], v[124:127], a[204:207], v[60:63]
    ds_read_b64_tr_b16 v[156:157], v243 offset:12288
    buffer_load_dwordx4 v[188:191], v1, s[28:31], s100 offen offset:3072 sc1
    v_mfma_f32_16x16x32_bf16 v[56:59], v[124:127], a[200:203], v[56:59]
    ds_read_b64_tr_b16 v[158:159], v243 offset:14336
    s_waitcnt vmcnt(56) lgkmcnt(8)
    v_mfma_f32_16x16x32_bf16 v[32:35], v[128:131], a[208:211], v[32:35]
    ds_read_b64_tr_b16 v[96:97], v240 offset:16384
    ds_read_b64_tr_b16 v[98:99], v240 offset:18432
    v_mfma_f32_16x16x32_bf16 v[36:39], v[128:131], a[212:215], v[36:39]
    ds_read_b64_tr_b16 v[100:101], v241 offset:16384
    v_mfma_f32_16x16x32_bf16 v[44:47], v[132:135], a[212:215], v[44:47]
    ds_read_b64_tr_b16 v[102:103], v241 offset:18432
    v_mfma_f32_16x16x32_bf16 v[40:43], v[132:135], a[208:211], v[40:43]
    ds_read_b64_tr_b16 v[104:105], v242 offset:16384
    v_mfma_f32_16x16x32_bf16 v[48:51], v[136:139], a[208:211], v[48:51]
    ds_read_b64_tr_b16 v[106:107], v242 offset:18432
    v_mfma_f32_16x16x32_bf16 v[52:55], v[136:139], a[212:215], v[52:55]
    ds_read_b64_tr_b16 v[108:109], v243 offset:16384
    v_mfma_f32_16x16x32_bf16 v[60:63], v[140:143], a[212:215], v[60:63]
    ds_read_b64_tr_b16 v[110:111], v243 offset:18432
    v_mfma_f32_16x16x32_bf16 v[56:59], v[140:143], a[208:211], v[56:59]
    s_waitcnt lgkmcnt(8)
    v_mfma_f32_16x16x32_bf16 v[32:35], v[144:147], a[216:219], v[32:35]
    ds_read_b64_tr_b16 v[112:113], v240 offset:20480
    v_mfma_f32_16x16x32_bf16 v[36:39], v[144:147], a[220:223], v[36:39]
    ds_read_b64_tr_b16 v[114:115], v240 offset:22528
    v_mfma_f32_16x16x32_bf16 v[44:47], v[148:151], a[220:223], v[44:47]
    ds_read_b64_tr_b16 v[116:117], v241 offset:20480
    v_mfma_f32_16x16x32_bf16 v[40:43], v[148:151], a[216:219], v[40:43]
    ds_read_b64_tr_b16 v[118:119], v241 offset:22528
    v_mfma_f32_16x16x32_bf16 v[48:51], v[152:155], a[216:219], v[48:51]
    ds_read_b64_tr_b16 v[120:121], v242 offset:20480
    v_mfma_f32_16x16x32_bf16 v[52:55], v[152:155], a[220:223], v[52:55]
    ds_read_b64_tr_b16 v[122:123], v242 offset:22528
    v_mfma_f32_16x16x32_bf16 v[60:63], v[156:159], a[220:223], v[60:63]
    ds_read_b64_tr_b16 v[124:125], v243 offset:20480
    v_mfma_f32_16x16x32_bf16 v[56:59], v[156:159], a[216:219], v[56:59]
    ds_read_b64_tr_b16 v[126:127], v243 offset:22528
    s_waitcnt vmcnt(18) lgkmcnt(8)
    s_barrier
    v_mfma_f32_16x16x32_bf16 v[32:35], v[96:99], a[224:227], v[32:35]
    ds_read_b64_tr_b16 v[128:129], v240 offset:24576
    ds_read_b64_tr_b16 v[130:131], v240 offset:26624
    v_mfma_f32_16x16x32_bf16 v[36:39], v[96:99], a[228:231], v[36:39]
    ds_read_b64_tr_b16 v[132:133], v241 offset:24576
    v_mfma_f32_16x16x32_bf16 v[44:47], v[100:103], a[228:231], v[44:47]
    ds_read_b64_tr_b16 v[134:135], v241 offset:26624
    v_mfma_f32_16x16x32_bf16 v[40:43], v[100:103], a[224:227], v[40:43]
    ds_read_b64_tr_b16 v[136:137], v242 offset:24576
    v_mfma_f32_16x16x32_bf16 v[48:51], v[104:107], a[224:227], v[48:51]
    ds_read_b64_tr_b16 v[138:139], v242 offset:26624
    v_mfma_f32_16x16x32_bf16 v[52:55], v[104:107], a[228:231], v[52:55]
    ds_read_b64_tr_b16 v[140:141], v243 offset:24576
    v_mfma_f32_16x16x32_bf16 v[60:63], v[108:111], a[228:231], v[60:63]
    ds_read_b64_tr_b16 v[142:143], v243 offset:26624
    v_mfma_f32_16x16x32_bf16 v[56:59], v[108:111], a[224:227], v[56:59]
    s_waitcnt lgkmcnt(8)
    v_mfma_f32_16x16x32_bf16 v[32:35], v[112:115], a[232:235], v[32:35]
    ds_read_b64_tr_b16 v[144:145], v240 offset:28672
    v_mfma_f32_16x16x32_bf16 v[36:39], v[112:115], a[236:239], v[36:39]
    ds_read_b64_tr_b16 v[146:147], v240 offset:30720
    v_mfma_f32_16x16x32_bf16 v[44:47], v[116:119], a[236:239], v[44:47]
    ds_read_b64_tr_b16 v[148:149], v241 offset:28672
    v_mfma_f32_16x16x32_bf16 v[40:43], v[116:119], a[232:235], v[40:43]
    ds_read_b64_tr_b16 v[150:151], v241 offset:30720
    v_mfma_f32_16x16x32_bf16 v[48:51], v[120:123], a[232:235], v[48:51]
    ds_read_b64_tr_b16 v[152:153], v242 offset:28672
    v_mfma_f32_16x16x32_bf16 v[52:55], v[120:123], a[236:239], v[52:55]
    ds_read_b64_tr_b16 v[154:155], v242 offset:30720
    v_mfma_f32_16x16x32_bf16 v[60:63], v[124:127], a[236:239], v[60:63]
    ds_read_b64_tr_b16 v[156:157], v243 offset:28672
    v_mfma_f32_16x16x32_bf16 v[56:59], v[124:127], a[232:235], v[56:59]
    ds_read_b64_tr_b16 v[158:159], v243 offset:30720
    s_waitcnt vmcnt(44) lgkmcnt(8)
    v_mfma_f32_16x16x32_bf16 v[32:35], v[128:131], a[240:243], v[32:35]
    v_mfma_f32_16x16x32_bf16 v[36:39], v[128:131], a[244:247], v[36:39]
    v_mfma_f32_16x16x32_bf16 v[44:47], v[132:135], a[244:247], v[44:47]
    v_mfma_f32_16x16x32_bf16 v[40:43], v[132:135], a[240:243], v[40:43]
    v_mfma_f32_16x16x32_bf16 v[48:51], v[136:139], a[240:243], v[48:51]
    v_mfma_f32_16x16x32_bf16 v[52:55], v[136:139], a[244:247], v[52:55]
    v_mfma_f32_16x16x32_bf16 v[60:63], v[140:143], a[244:247], v[60:63]
    v_mfma_f32_16x16x32_bf16 v[56:59], v[140:143], a[240:243], v[56:59]
    s_waitcnt lgkmcnt(0)
    v_mfma_f32_16x16x32_bf16 v[32:35], v[144:147], a[248:251], v[32:35]
    v_mfma_f32_16x16x32_bf16 v[36:39], v[144:147], a[252:255], v[36:39]
    v_mfma_f32_16x16x32_bf16 v[44:47], v[148:151], a[252:255], v[44:47]
    v_mfma_f32_16x16x32_bf16 v[40:43], v[148:151], a[248:251], v[40:43]
    v_mfma_f32_16x16x32_bf16 v[48:51], v[152:155], a[248:251], v[48:51]
    v_mfma_f32_16x16x32_bf16 v[52:55], v[152:155], a[252:255], v[52:55]
    v_mfma_f32_16x16x32_bf16 v[60:63], v[156:159], a[252:255], v[60:63]
    v_mfma_f32_16x16x32_bf16 v[56:59], v[156:159], a[248:251], v[56:59]
    s_lshl_b32 s43, s14, 2
    s_add_u32 s43, s43, s32
    s_lshl_b32 s43, s43, 16
    s_lshl_b32 s3, s15, 8
    s_add_u32 s43, s43, s3
    s_lshl_b32 s3, s101, 7
    s_add_u32 s43, s43, s3
    s_add_u32 s3, s43, 32768
    v_and_b32 v28, 15, v15
    v_bfe_u32 v29, v15, 4, 1
    v_lshlrev_b32 v29, 5, v29
    v_lshl_add_u32 v28, v28, 11, v29
    v_lshrrev_b32 v29, 5, v15
    v_lshl_add_u32 v28, v29, 4, v28
    s_waitcnt vmcnt(0)
    v_pk_add_f32 v[32:33], v[32:33], v[160:161]
    v_pk_add_f32 v[34:35], v[34:35], v[162:163]
    v_pk_add_f32 v[36:37], v[36:37], v[164:165]
    v_pk_add_f32 v[38:39], v[38:39], v[166:167]
    v_pk_add_f32 v[40:41], v[40:41], v[168:169]
    v_pk_add_f32 v[42:43], v[42:43], v[170:171]
    v_pk_add_f32 v[44:45], v[44:45], v[172:173]
    v_pk_add_f32 v[46:47], v[46:47], v[174:175]
    v_pk_add_f32 v[48:49], v[48:49], v[176:177]
    v_pk_add_f32 v[50:51], v[50:51], v[178:179]
    v_pk_add_f32 v[52:53], v[52:53], v[180:181]
    v_pk_add_f32 v[54:55], v[54:55], v[182:183]
    v_pk_add_f32 v[56:57], v[56:57], v[184:185]
    v_pk_add_f32 v[58:59], v[58:59], v[186:187]
    v_pk_add_f32 v[60:61], v[60:61], v[188:189]
    v_pk_add_f32 v[62:63], v[62:63], v[190:191]
    v_cvt_pk_bf16_f32 v96, v32, v33
    v_cvt_pk_bf16_f32 v97, v34, v35
    v_cvt_pk_bf16_f32 v98, v40, v41
    v_cvt_pk_bf16_f32 v99, v42, v43
    v_cvt_pk_bf16_f32 v100, v48, v49
    v_cvt_pk_bf16_f32 v101, v50, v51
    v_cvt_pk_bf16_f32 v102, v56, v57
    v_cvt_pk_bf16_f32 v103, v58, v59
    v_cvt_pk_bf16_f32 v104, v36, v37
    v_cvt_pk_bf16_f32 v105, v38, v39
    v_cvt_pk_bf16_f32 v106, v44, v45
    v_cvt_pk_bf16_f32 v107, v46, v47
    v_cvt_pk_bf16_f32 v108, v52, v53
    v_cvt_pk_bf16_f32 v109, v54, v55
    v_cvt_pk_bf16_f32 v110, v60, v61
    v_cvt_pk_bf16_f32 v111, v62, v63
    s_nop 1
    v_permlane16_swap_b32 v96, v98
    v_permlane16_swap_b32 v97, v99
    buffer_store_dwordx4 v[96:99], v28, s[88:91], s43 offen offset:0
    v_permlane16_swap_b32 v100, v102
    v_permlane16_swap_b32 v101, v103
    buffer_store_dwordx4 v[100:103], v28, s[88:91], s43 offen offset:64
    v_permlane16_swap_b32 v104, v106
    v_permlane16_swap_b32 v105, v107
    buffer_store_dwordx4 v[104:107], v28, s[88:91], s3 offen offset:0
    v_permlane16_swap_b32 v108, v110
    v_permlane16_swap_b32 v109, v111
    buffer_store_dwordx4 v[108:111], v28, s[88:91], s3 offen offset:64
k_done:
    s_endpgm
.section .rodata,"a"
.p2align 6
.amdhsa_kernel standalone__glu_gated_swiglu__prompt_kernel
  .amdhsa_next_free_vgpr 512
  .amdhsa_next_free_sgpr 102
  .amdhsa_accum_offset 256
  .amdhsa_group_segment_fixed_size 0
  .amdhsa_kernarg_size 56
  .amdhsa_user_sgpr_count 2
  .amdhsa_user_sgpr_kernarg_segment_ptr 1
  .amdhsa_system_sgpr_workgroup_id_x 1
  .amdhsa_float_denorm_mode_32 3
.end_amdhsa_kernel
```
